```python
import torch

def _softmax(x, axis=-1):
    return torch.softmax(x, dim=axis)

def _gelu(x):
    return torch.nn.functional.gelu(x, approximate='tanh')

def _silu(x):
    return torch.nn.functional.silu(x)

def _sigmoid(x):
    return torch.sigmoid(x)

def _layernorm(x, axis=-1, eps=1e-05):
    m = x.mean(dim=axis, keepdim=True)
    v = x.var(dim=axis, keepdim=True, unbiased=False)
    return (x - m) / torch.sqrt(v + eps)

def _scatter_add(tgt, idx, src, axis=0):
    return tgt.clone().index_add_(axis, idx, src)

def _segment_sum(src, seg, n):
    out = torch.zeros((n,) + src.shape[1:], dtype=src.dtype)
    return out.index_add_(0, seg, src)

def _pad(x, pw):
    flat = tuple((v for pair in reversed(pw) for v in pair))
    return torch.nn.functional.pad(x, flat)
kernel_name = 'parallel_sum__spectral_fnet__mixer_gmlp__prompt'

def setup_inputs():

    _w = lambda a: (lambda t: t.to(torch.bfloat16) if t.is_floating_point() else t)(torch.as_tensor(a))

    def _A_setup():
        B, S, D = (1, 2048, 640)
        ns = torch.arange(S)[:, None] * torch.arange(S)[None, :]
        nd = torch.arange(D)[:, None] * torch.arange(D)[None, :]
        Ws_re = torch.cos(-2.0 * torch.pi * ns / S).to(float)
        Ws_im = torch.sin(-2.0 * torch.pi * ns / S).to(float)
        Wd_re = torch.cos(-2.0 * torch.pi * nd / D).to(float)
        Wd_im = torch.sin(-2.0 * torch.pi * nd / D).to(float)
        return {'x': _w((lambda *s: torch.randn(*s, dtype=torch.bfloat16) * 0.05)(B, S, D)), 'dft_seq_re': _w(Ws_re), 'dft_seq_im': _w(Ws_im), 'dft_hid_re': _w(Wd_re), 'dft_hid_im': _w(Wd_im)}
    _A_in = _A_setup()

    def _B_setup():
        B, S, D, F = (1, 2048, 640, 1728)
        Fh = F // 2
        return {'x': _w((lambda *s: torch.randn(*s, dtype=torch.bfloat16) * 0.05)(B, S, D)), 'w_in': _w((lambda *s: torch.randn(*s, dtype=torch.bfloat16) * 0.8)(D, 2 * Fh)), 'w_sp': _w(0.01 * (lambda *s: torch.randn(*s, dtype=torch.bfloat16) * 0.8)(S, S)), 'b_sp': _w(1.0 + 0.01 * (lambda *s: torch.randn(*s, dtype=torch.bfloat16) * 0.8)(S)), 'w_out': _w((lambda *s: torch.randn(*s, dtype=torch.bfloat16) * 0.8)(Fh, D))}
    _B_in = _B_setup()
    return {'A_x': _A_in['x'], 'A_dft_seq_re': _A_in['dft_seq_re'], 'A_dft_seq_im': _A_in['dft_seq_im'], 'A_dft_hid_re': _A_in['dft_hid_re'], 'A_dft_hid_im': _A_in['dft_hid_im'], 'B_x': _B_in['x'], 'B_w_in': _B_in['w_in'], 'B_w_sp': _B_in['w_sp'], 'B_b_sp': _B_in['b_sp'], 'B_w_out': _B_in['w_out']}

def reference(A_x, A_dft_seq_re, A_dft_seq_im, A_dft_hid_re, A_dft_hid_im, B_x, B_w_in, B_w_sp, B_b_sp, B_w_out):

    def _A_ref(x, dft_seq_re, dft_seq_im, dft_hid_re, dft_hid_im):
        a = torch.einsum('bsd,ed->bse', x, dft_hid_re)
        b = torch.einsum('bsd,ed->bse', x, dft_hid_im)
        y = torch.einsum('ts,bse->bte', dft_seq_re, a) - torch.einsum('ts,bse->bte', dft_seq_im, b)
        return y

    def _B_ref(x, w_in, w_sp, b_sp, w_out):
        B, S, D = x.shape
        F = w_in.shape[-1]
        Fh = F // 2
        z = _gelu(torch.einsum('bsd,df->bsf', x, w_in))
        z1 = z[..., :Fh].clone()
        z2 = _layernorm(z[..., Fh:], axis=-1)
        g = torch.einsum('ts,bsf->btf', w_sp, z2) + b_sp[None, :, None]
        return torch.einsum('bsf,fd->bsd', z1 * g, w_out)
    x = A_x
    xn = _layernorm(x, axis=-1)
    return x + _A_ref(xn, A_dft_seq_re, A_dft_seq_im, A_dft_hid_re, A_dft_hid_im) + _B_ref(xn, B_w_in, B_w_sp, B_b_sp, B_w_out)
```

```asm
; @launch grid=(256,1,1) block=(512,1,1) lds=163840
.amdgcn_target "amdgcn-amd-amdhsa--gfx950"
.text
.globl parallel_sum__spectral_fnet__mixer_gmlp__prompt_kernel
.p2align 8
.type parallel_sum__spectral_fnet__mixer_gmlp__prompt_kernel,@function
parallel_sum__spectral_fnet__mixer_gmlp__prompt_kernel:

  s_cmp_ge_u32 s2, 256
  s_cbranch_scc1 K_end
  s_load_dwordx16 s[68:83], s[0:1], 0
  s_load_dwordx8 s[84:91], s[0:1], 64
  s_load_dwordx2 s[92:93], s[0:1], 96
  s_getpc_b64 s[62:63]
P0_pc:
  v_lshrrev_b32 v2, 6, v0
  s_sub_u32 s62, s62, P0_pc-parallel_sum__spectral_fnet__mixer_gmlp__prompt_kernel
  s_subb_u32 s63, s63, 0
  s_lshr_b32 s59, s2, 3
  v_lshl_add_u32 v120, s59, 3, v2
  v_mul_u32_u24 v120, ((CODE_END-parallel_sum__spectral_fnet__mixer_gmlp__prompt_kernel+127)/128+255)/256, v120
  v_and_b32 v1, 63, v0
  v_min_u32 v121, ((CODE_END-parallel_sum__spectral_fnet__mixer_gmlp__prompt_kernel+127)/128+255)/256-1, v1
  v_add_u32 v120, v120, v121
  v_min_u32 v120, (CODE_END-parallel_sum__spectral_fnet__mixer_gmlp__prompt_kernel+127)/128-1, v120
  v_lshlrev_b32 v120, 7, v120
  global_load_dword v240, v120, s[62:63]
  v_and_b32 v1, 63, v0
  v_lshrrev_b32 v2, 6, v0
  v_lshlrev_b32 v3, 2, v1
  v_readfirstlane_b32 s20, v2
  s_nop 3
  s_lshr_b32 s21, s20, 2
  s_lshl_b32 s22, s2, 1
  s_add_u32 s22, s22, s21
  s_and_b32 s23, s20, 3
  s_sub_u32 s24, 2048, s22
  s_sub_u32 s25, 1024, s22
  s_add_u32 s26, 1024, s22
  s_cmp_eq_u32 s23, 1
  s_cselect_b32 s30, s24, s22
  s_cmp_eq_u32 s23, 2
  s_cselect_b32 s30, s25, s30
  s_cmp_eq_u32 s23, 3
  s_cselect_b32 s30, s26, s30
  s_lshl_b32 s27, s23, 9
  s_cmp_eq_u32 s22, 0
  s_cselect_b32 s30, s27, s30
  s_mul_i32 s30, s30, 1280
  s_waitcnt lgkmcnt(0)
  s_cmp_lg_u32 s2, 0
  s_cbranch_scc1 P0_nononce
  s_cmp_lg_u32 s20, 7
  s_cbranch_scc1 P0_nononce
  s_add_u32 s64, s92, 33030144
  s_addc_u32 s65, s93, 0
  s_mov_b32 s66, 20480
  s_mov_b32 s67, 0x20000
  v_mov_b32 v115, 0
  buffer_load_dword v116, v115, s[64:67], 0 offen sc1
  v_mov_b32 v117, 0x40000000
  v_cmp_eq_u32 vcc, 0, v1
  s_waitcnt vmcnt(0)
  v_and_b32 v116, -4, v116
  v_add_u32 v116, 4, v116
  v_max_u32 v116, 4, v116
  v_cndmask_b32 v115, v117, v115, vcc
  buffer_store_dword v116, v115, s[64:67], 0 offen sc1
  s_mov_b32 s64, s90
  s_mov_b32 s65, s91
  s_mov_b32 s66, 256
  s_mov_b32 s67, 0x20000
  buffer_store_dword v116, v115, s[64:67], 0 offen sc1
P0_nononce:
  s_mov_b32 s8, s68
  s_mov_b32 s9, s69
  s_mov_b32 s10, 2621440
  s_mov_b32 s11, 0x20000
  s_mov_b32 s6, s92
  s_mov_b32 s7, s93
  buffer_load_dword v10, v3, s[8:11], s30 offen offset:0
  buffer_load_dword v11, v3, s[8:11], s30 offen offset:256
  buffer_load_dword v12, v3, s[8:11], s30 offen offset:512
  buffer_load_dword v13, v3, s[8:11], s30 offen offset:768
  buffer_load_dword v14, v3, s[8:11], s30 offen offset:1024
  v_mov_b32 v109, 0x40000000
  v_mov_b32 v113, v109
  v_mov_b32 v114, v109
  s_barrier
  s_cmp_lt_u32 s20, 5
  s_cbranch_scc1 P0_nowo
  s_mov_b32 s32, s86
  s_mov_b32 s33, s87
  s_mov_b32 s34, 1105920
  s_mov_b32 s35, 0x20000
  s_mul_i32 s48, s2, 135
  v_subrev_u32 v110, 320, v0
  v_cmp_gt_u32 vcc, 135, v110
  v_add_u32 v110, s48, v110
  v_mul_u32_u24 v111, 52429, v110
  v_lshrrev_b32 v111, 24, v111
  v_mul_u32_u24 v112, 320, v111
  v_sub_u32 v112, v110, v112
  v_mul_u32_u24 v113, 10240, v111
  v_lshl_add_u32 v113, v112, 2, v113
  v_mul_u32_u24 v114, 10240, v111
  v_lshl_add_u32 v114, v112, 5, v114
  v_cndmask_b32 v113, v109, v113, vcc
  v_cndmask_b32 v114, v109, v114, vcc
  s_mov_b32 s48, 0
  buffer_load_dword v124, v113, s[32:35], s48 offen offset:0
  s_mov_b32 s48, 0
  buffer_load_dword v125, v113, s[32:35], s48 offen offset:1280
  s_mov_b32 s48, 2560
  buffer_load_dword v126, v113, s[32:35], s48 offen offset:0
  s_mov_b32 s48, 2560
  buffer_load_dword v127, v113, s[32:35], s48 offen offset:1280
  s_mov_b32 s48, 5120
  buffer_load_dword v128, v113, s[32:35], s48 offen offset:0
  s_mov_b32 s48, 5120
  buffer_load_dword v129, v113, s[32:35], s48 offen offset:1280
  s_mov_b32 s48, 7680
  buffer_load_dword v130, v113, s[32:35], s48 offen offset:0
  s_mov_b32 s48, 7680
  buffer_load_dword v131, v113, s[32:35], s48 offen offset:1280
P0_nowo:
  s_mov_b32 s12, s6
  s_mov_b32 s13, s7
  s_mov_b32 s14, 2621440
  s_mov_b32 s15, 0x20000
  s_add_u32 s16, s6, 3145728
  s_addc_u32 s17, s7, 0
  s_mov_b32 s18, 2097152
  s_mov_b32 s19, 0x20000
  s_add_u32 s40, s6, 32505856
  s_addc_u32 s41, s7, 0
  s_mov_b32 s42, 229376
  s_mov_b32 s43, 0x20000
  v_mov_b32 v20, -1
  v_mov_b32 v21, -1
  v_mov_b32 v22, -1
  v_mov_b32 v23, -1
  v_lshlrev_b32 v5, 4, v0
  s_mul_i32 s37, s2, 896
  v_cmp_gt_u32 vcc, 56, v0
  s_nop 1
  v_cndmask_b32 v108, v109, v5, vcc
  buffer_store_dwordx4 v[20:23], v108, s[40:43], s37 offen sc1
  s_nop 1
  v_mov_b32 v20, 0
  v_mov_b32 v21, 0
  v_mov_b32 v22, 0
  v_mov_b32 v23, 0
  v_add_u32 v5, 159744, v5
  v_cmp_gt_u32 vcc, 160, v0
  s_and_saveexec_b64 s[38:39], vcc
  ds_write_b128 v5, v[20:23]
  s_mov_b64 exec, s[38:39]
  v_cmp_le_u32 vcc, 192, v0
  s_nop 1
  v_cndmask_b32 v58, 0, 1, vcc
  v_mul_u32_u24 v59, 192, v58
  v_sub_u32 v59, v0, v59
  v_lshlrev_b32 v4, 1, v59
  v_add_u32 v5, 1, v4
  v_cmp_ge_u32 vcc, 320, v4
  s_nop 1
  v_cndmask_b32 v50, 0, 1.0, vcc
  v_cmp_ge_u32 vcc, 320, v5
  s_nop 1
  v_cndmask_b32 v51, 0, 1.0, vcc
  v_subrev_u32 v6, 1, v4
  v_cmp_ge_u32 vcc, 318, v6
  s_nop 1
  v_cndmask_b32 v52, 0, 1.0, vcc
  v_cmp_ge_u32 vcc, 318, v4
  s_nop 1
  v_cndmask_b32 v53, 0, 1.0, vcc
  v_lshlrev_b32 v54, 2, v4
  v_sub_u32 v55, 640, v4
  v_min_u32 v55, 639, v55
  v_lshlrev_b32 v55, 2, v55
  v_sub_u32 v56, 639, v4
  v_lshlrev_b32 v56, 2, v56
  v_mul_u32_u24 v60, 4*2560, v58
  v_add_u32 v64, 139264, v60
  v_add_u32 v65, 141824, v60
  v_add_u32 v66, 144384, v60
  v_add_u32 v67, 146944, v60
  s_cmp_eq_u32 s2, 0
  s_cselect_b32 s44, -1, 0
  v_cmp_eq_u32 vcc, 0, v58
  s_and_b32 vcc_lo, vcc_lo, s44
  s_and_b32 vcc_hi, vcc_hi, s44
  v_mov_b32 v61, 159744
  s_nop 0
  v_cndmask_b32 v65, v65, v61, vcc
  v_cndmask_b32 v67, v67, v61, vcc
  s_lshl_b32 s48, s2, 1
  v_add_u32 v57, s48, v58
  v_mul_u32_u24 v57, 768, v57
  v_lshl_add_u32 v57, v59, 2, v57
  s_cmp_ge_u32 s20, 5
  s_cbranch_scc1 P0_w3
  s_cmp_ge_u32 s20, 2
  s_cbranch_scc1 P0_w1
  s_waitcnt vmcnt(1)
  s_branch P0_w2
P0_w1:
  s_waitcnt vmcnt(1)
  s_branch P0_w2
P0_w3:
  s_waitcnt vmcnt(9)
P0_w2:
  v_lshlrev_b32 v30, 16, v10
  v_and_b32 v31, 0xffff0000, v10
  v_lshlrev_b32 v32, 16, v11
  v_and_b32 v33, 0xffff0000, v11
  v_lshlrev_b32 v34, 16, v12
  v_and_b32 v35, 0xffff0000, v12
  v_lshlrev_b32 v36, 16, v13
  v_and_b32 v37, 0xffff0000, v13
  v_lshlrev_b32 v38, 16, v14
  v_and_b32 v39, 0xffff0000, v14
  v_pk_add_f32 v[6:7], v[30:31], v[32:33]
  v_pk_add_f32 v[8:9], v[34:35], v[36:37]
  v_pk_add_f32 v[6:7], v[6:7], v[38:39]
  v_pk_add_f32 v[6:7], v[6:7], v[8:9]
  v_add_f32 v6, v6, v7
  s_nop 1
  v_add_f32_dpp v6, v6, v6 quad_perm:[1,0,3,2] row_mask:0xf bank_mask:0xf
  s_nop 1
  v_add_f32_dpp v6, v6, v6 quad_perm:[2,3,0,1] row_mask:0xf bank_mask:0xf
  s_nop 1
  v_add_f32_dpp v6, v6, v6 row_half_mirror row_mask:0xf bank_mask:0xf
  s_nop 1
  v_add_f32_dpp v6, v6, v6 row_mirror row_mask:0xf bank_mask:0xf
  s_nop 1
  v_mov_b32 v8, v6
  s_nop 1
  v_permlane16_swap_b32 v6, v8
  s_nop 0
  v_add_f32 v6, v6, v8
  v_mov_b32 v8, v6
  s_nop 1
  v_permlane32_swap_b32 v6, v8
  s_nop 0
  v_add_f32 v6, v6, v8
  v_mul_f32 v6, 0x3acccccd, v6
  v_mov_b32 v7, v6
  v_pk_add_f32 v[30:31], v[30:31], v[6:7] neg_lo:[0,1] neg_hi:[0,1]
  v_pk_add_f32 v[32:33], v[32:33], v[6:7] neg_lo:[0,1] neg_hi:[0,1]
  v_pk_add_f32 v[34:35], v[34:35], v[6:7] neg_lo:[0,1] neg_hi:[0,1]
  v_pk_add_f32 v[36:37], v[36:37], v[6:7] neg_lo:[0,1] neg_hi:[0,1]
  v_pk_add_f32 v[38:39], v[38:39], v[6:7] neg_lo:[0,1] neg_hi:[0,1]
  v_pk_mul_f32 v[6:7], v[30:31], v[30:31]
  v_pk_fma_f32 v[6:7], v[32:33], v[32:33], v[6:7]
  v_pk_fma_f32 v[6:7], v[34:35], v[34:35], v[6:7]
  v_pk_fma_f32 v[6:7], v[36:37], v[36:37], v[6:7]
  v_pk_fma_f32 v[6:7], v[38:39], v[38:39], v[6:7]
  v_add_f32 v6, v6, v7
  s_nop 1
  v_add_f32_dpp v6, v6, v6 quad_perm:[1,0,3,2] row_mask:0xf bank_mask:0xf
  s_nop 1
  v_add_f32_dpp v6, v6, v6 quad_perm:[2,3,0,1] row_mask:0xf bank_mask:0xf
  s_nop 1
  v_add_f32_dpp v6, v6, v6 row_half_mirror row_mask:0xf bank_mask:0xf
  s_nop 1
  v_add_f32_dpp v6, v6, v6 row_mirror row_mask:0xf bank_mask:0xf
  s_nop 1
  v_mov_b32 v8, v6
  s_nop 1
  v_permlane16_swap_b32 v6, v8
  s_nop 0
  v_add_f32 v6, v6, v8
  v_mov_b32 v8, v6
  s_nop 1
  v_permlane32_swap_b32 v6, v8
  s_nop 0
  v_add_f32 v6, v6, v8
  v_mov_b32 v8, 0x3727c5ac
  v_fmac_f32 v8, 0x3acccccd, v6
  v_rsq_f32 v8, v8
  s_nop 0
  v_mov_b32 v9, v8
  v_pk_mul_f32 v[30:31], v[30:31], v[8:9]
  v_pk_mul_f32 v[32:33], v[32:33], v[8:9]
  v_pk_mul_f32 v[34:35], v[34:35], v[8:9]
  v_pk_mul_f32 v[36:37], v[36:37], v[8:9]
  v_pk_mul_f32 v[38:39], v[38:39], v[8:9]
  v_lshlrev_b32 v4, 3, v1
  s_mul_i32 s33, s20, 2560
  s_add_u32 s33, s33, 139264
  v_add_u32 v4, s33, v4
  ds_write_b64 v4, v[30:31] offset:0
  ds_write_b64 v4, v[32:33] offset:512
  ds_write_b64 v4, v[34:35] offset:1024
  ds_write_b64 v4, v[36:37] offset:1536
  ds_write_b64 v4, v[38:39] offset:2048
  v_cvt_pk_bf16_f32 v10, v30, v31
  v_cvt_pk_bf16_f32 v11, v32, v33
  v_cvt_pk_bf16_f32 v12, v34, v35
  v_cvt_pk_bf16_f32 v13, v36, v37
  v_cvt_pk_bf16_f32 v14, v38, v39
  s_waitcnt lgkmcnt(0)
  s_barrier
  s_and_b32 s98, s20, 3
  s_cmp_lg_u32 s98, 0
  s_cbranch_scc1 P0_non1
  s_mov_b32 s64, s90
  s_mov_b32 s65, s91
  s_mov_b32 s66, 256
  s_mov_b32 s67, 0x20000
  v_mov_b32 v145, 0
  buffer_load_dword v146, v145, s[64:67], 0 offen sc1
P0_non1:
  s_cmp_lt_u32 s20, 5
  s_cbranch_scc1 P0_nowo2
  s_add_u32 s32, s6, 25165824
  s_addc_u32 s33, s7, 0
  s_mov_b32 s34, 1105920
  s_mov_b32 s35, 0x20000
  s_mov_b32 s48, 0x05040100
  s_mov_b32 s49, 0x07060302
  s_waitcnt vmcnt(1)
  v_perm_b32 v132, v125, v124, s48
  v_perm_b32 v136, v125, v124, s49
  v_perm_b32 v133, v127, v126, s48
  v_perm_b32 v137, v127, v126, s49
  v_perm_b32 v134, v129, v128, s48
  v_perm_b32 v138, v129, v128, s49
  v_perm_b32 v135, v131, v130, s48
  v_perm_b32 v139, v131, v130, s49
  buffer_store_dwordx4 v[132:135], v114, s[32:35], 0 offen sc1
  buffer_store_dwordx4 v[136:139], v114, s[32:35], 0 offen offset:16 sc1
P0_nowo2:
  v_cmp_gt_u32 vcc, 384, v0
  s_and_saveexec_b64 s[38:39], vcc
  s_cbranch_execz P0_done
  v_add_u32 v68, v64, v54
  ds_read_b64 v[70:71], v68
  v_add_u32 v68, v64, v55
  ds_read_b32 v78, v68
  v_add_u32 v68, v64, v56
  ds_read_b32 v79, v68
  v_add_u32 v68, v65, v54
  ds_read_b64 v[72:73], v68
  v_add_u32 v68, v65, v55
  ds_read_b32 v80, v68
  v_add_u32 v68, v65, v56
  ds_read_b32 v81, v68
  v_add_u32 v68, v66, v54
  ds_read_b64 v[74:75], v68
  v_add_u32 v68, v66, v55
  ds_read_b32 v82, v68
  v_add_u32 v68, v66, v56
  ds_read_b32 v83, v68
  v_add_u32 v68, v67, v54
  ds_read_b64 v[76:77], v68
  v_add_u32 v68, v67, v55
  ds_read_b32 v84, v68
  v_add_u32 v68, v67, v56
  ds_read_b32 v85, v68
  s_waitcnt lgkmcnt(0)
  v_pk_add_f32 v[102:103], v[70:71], v[72:73]
  v_pk_add_f32 v[104:105], v[74:75], v[76:77]
  v_pk_add_f32 v[106:107], v[70:71], v[72:73] neg_lo:[0,1] neg_hi:[0,1]
  v_pk_add_f32 v[110:111], v[74:75], v[76:77] neg_lo:[0,1] neg_hi:[0,1]
  v_pk_add_f32 v[86:87], v[102:103], v[104:105]
  v_pk_add_f32 v[88:89], v[102:103], v[104:105] neg_lo:[0,1] neg_hi:[0,1]
  v_pk_add_f32 v[90:91], v[106:107], v[110:111] neg_lo:[0,1] neg_hi:[0,1]
  v_pk_add_f32 v[92:93], v[106:107], v[110:111]
  v_pk_add_f32 v[102:103], v[78:79], v[80:81]
  v_pk_add_f32 v[104:105], v[82:83], v[84:85]
  v_pk_add_f32 v[106:107], v[78:79], v[80:81] neg_lo:[0,1] neg_hi:[0,1]
  v_pk_add_f32 v[110:111], v[82:83], v[84:85] neg_lo:[0,1] neg_hi:[0,1]
  v_pk_add_f32 v[94:95], v[102:103], v[104:105]
  v_pk_add_f32 v[96:97], v[102:103], v[104:105] neg_lo:[0,1] neg_hi:[0,1]
  v_pk_add_f32 v[98:99], v[106:107], v[110:111] neg_lo:[0,1] neg_hi:[0,1]
  v_pk_add_f32 v[100:101], v[106:107], v[110:111]
  v_pk_mul_f32 v[86:87], v[86:87], v[50:51]
  v_pk_fma_f32 v[86:87], v[94:95], v[52:53], v[86:87]
  v_pk_mul_f32 v[88:89], v[88:89], v[50:51]
  v_pk_fma_f32 v[88:89], v[96:97], v[52:53], v[88:89]
  v_pk_add_f32 v[90:91], v[90:91], v[98:99] neg_lo:[0,1] neg_hi:[0,1]
  v_pk_mul_f32 v[90:91], v[90:91], v[52:53]
  v_pk_add_f32 v[92:93], v[92:93], v[100:101] neg_lo:[0,1] neg_hi:[0,1]
  v_pk_mul_f32 v[92:93], v[92:93], v[52:53]
  v_cvt_pk_bf16_f32 v102, v86, v87
  v_cvt_pk_bf16_f32 v103, v88, v89
  v_cvt_pk_bf16_f32 v104, v90, v91
  v_cvt_pk_bf16_f32 v105, v92, v93
  s_mov_b32 s51, 0
  buffer_store_dword v102, v57, s[16:19], s51 offen sc1
  s_mov_b32 s51, 524288
  buffer_store_dword v103, v57, s[16:19], s51 offen sc1
  s_mov_b32 s51, 1048576
  buffer_store_dword v104, v57, s[16:19], s51 offen sc1
  s_mov_b32 s51, 1572864
  buffer_store_dword v105, v57, s[16:19], s51 offen sc1
  s_cmp_lg_u32 s2, 0
  s_cbranch_scc1 P0_done
  v_cmp_gt_u32 vcc, 192, v0
  s_and_b64 exec, exec, vcc
  s_cbranch_execz P0_done
  v_mov_b32 v64, 141824
  v_mov_b32 v65, 146944
  v_mov_b32 v66, 159744
  v_mov_b32 v67, 159744
  v_lshlrev_b32 v57, 2, v59
  v_add_u32 v57, 393216, v57
  s_nop 1
  v_add_u32 v68, v64, v54
  ds_read_b64 v[70:71], v68
  v_add_u32 v68, v64, v55
  ds_read_b32 v78, v68
  v_add_u32 v68, v64, v56
  ds_read_b32 v79, v68
  v_add_u32 v68, v65, v54
  ds_read_b64 v[72:73], v68
  v_add_u32 v68, v65, v55
  ds_read_b32 v80, v68
  v_add_u32 v68, v65, v56
  ds_read_b32 v81, v68
  v_add_u32 v68, v66, v54
  ds_read_b64 v[74:75], v68
  v_add_u32 v68, v66, v55
  ds_read_b32 v82, v68
  v_add_u32 v68, v66, v56
  ds_read_b32 v83, v68
  v_add_u32 v68, v67, v54
  ds_read_b64 v[76:77], v68
  v_add_u32 v68, v67, v55
  ds_read_b32 v84, v68
  v_add_u32 v68, v67, v56
  ds_read_b32 v85, v68
  s_waitcnt lgkmcnt(0)
  v_pk_add_f32 v[102:103], v[70:71], v[72:73]
  v_pk_add_f32 v[104:105], v[74:75], v[76:77]
  v_pk_add_f32 v[106:107], v[70:71], v[72:73] neg_lo:[0,1] neg_hi:[0,1]
  v_pk_add_f32 v[110:111], v[74:75], v[76:77] neg_lo:[0,1] neg_hi:[0,1]
  v_pk_add_f32 v[86:87], v[102:103], v[104:105]
  v_pk_add_f32 v[88:89], v[102:103], v[104:105] neg_lo:[0,1] neg_hi:[0,1]
  v_pk_add_f32 v[90:91], v[106:107], v[110:111] neg_lo:[0,1] neg_hi:[0,1]
  v_pk_add_f32 v[92:93], v[106:107], v[110:111]
  v_pk_add_f32 v[102:103], v[78:79], v[80:81]
  v_pk_add_f32 v[104:105], v[82:83], v[84:85]
  v_pk_add_f32 v[106:107], v[78:79], v[80:81] neg_lo:[0,1] neg_hi:[0,1]
  v_pk_add_f32 v[110:111], v[82:83], v[84:85] neg_lo:[0,1] neg_hi:[0,1]
  v_pk_add_f32 v[94:95], v[102:103], v[104:105]
  v_pk_add_f32 v[96:97], v[102:103], v[104:105] neg_lo:[0,1] neg_hi:[0,1]
  v_pk_add_f32 v[98:99], v[106:107], v[110:111] neg_lo:[0,1] neg_hi:[0,1]
  v_pk_add_f32 v[100:101], v[106:107], v[110:111]
  v_pk_mul_f32 v[86:87], v[86:87], v[50:51]
  v_pk_fma_f32 v[86:87], v[94:95], v[52:53], v[86:87]
  v_pk_mul_f32 v[88:89], v[88:89], v[50:51]
  v_pk_fma_f32 v[88:89], v[96:97], v[52:53], v[88:89]
  v_pk_add_f32 v[90:91], v[90:91], v[98:99] neg_lo:[0,1] neg_hi:[0,1]
  v_pk_mul_f32 v[90:91], v[90:91], v[52:53]
  v_pk_add_f32 v[92:93], v[92:93], v[100:101] neg_lo:[0,1] neg_hi:[0,1]
  v_pk_mul_f32 v[92:93], v[92:93], v[52:53]
  v_cvt_pk_bf16_f32 v102, v86, v87
  v_cvt_pk_bf16_f32 v103, v88, v89
  v_cvt_pk_bf16_f32 v104, v90, v91
  v_cvt_pk_bf16_f32 v105, v92, v93
  s_mov_b32 s51, 0
  buffer_store_dword v102, v57, s[16:19], s51 offen sc1
  s_mov_b32 s51, 524288
  buffer_store_dword v103, v57, s[16:19], s51 offen sc1
  s_mov_b32 s51, 1048576
  buffer_store_dword v104, v57, s[16:19], s51 offen sc1
  s_mov_b32 s51, 1572864
  buffer_store_dword v105, v57, s[16:19], s51 offen sc1
P0_done:
  s_mov_b64 exec, -1
  s_mov_b32 s12, s6
  s_mov_b32 s13, s7
  s_mov_b32 s14, 2621440
  s_mov_b32 s15, 0x20000
  buffer_store_dword v10, v3, s[12:15], s30 offen offset:0 sc1
  buffer_store_dword v11, v3, s[12:15], s30 offen offset:256 sc1
  buffer_store_dword v12, v3, s[12:15], s30 offen offset:512 sc1
  buffer_store_dword v13, v3, s[12:15], s30 offen offset:768 sc1
  buffer_store_dword v14, v3, s[12:15], s30 offen offset:1024 sc1
  s_and_b32 s98, s20, 3
  s_cmp_lg_u32 s98, 0
  s_cbranch_scc1 P0_gotn
  s_waitcnt vmcnt(0)
  v_readfirstlane_b32 s94, v146
  s_nop 3
  s_cmp_lg_u32 s94, 0
  s_cbranch_scc1 P0_gotn
  s_mov_b32 s64, s90
  s_mov_b32 s65, s91
  s_mov_b32 s66, 256
  s_mov_b32 s67, 0x20000
  v_mov_b32 v115, 0
  s_mov_b32 s99, 0
P0_pn:
  buffer_load_dword v116, v115, s[64:67], 0 offen sc1
  s_waitcnt vmcnt(0)
  v_readfirstlane_b32 s94, v116
  s_add_u32 s99, s99, 1
  s_cmp_lg_u32 s94, 0
  s_cbranch_scc1 P0_gotn
  s_cmp_lt_u32 s99, 40000
  s_cbranch_scc1 P0_pn
P0_gotn:
  s_cmp_ge_u32 s20, 4
  s_cbranch_scc1 PH1
  s_add_u32 s64, s92, 33030144
  s_addc_u32 s65, s93, 0
  s_mov_b32 s66, 20480
  s_mov_b32 s67, 0x20000
  s_add_u32 s98, s94, 1
  v_mov_b32 v115, s98
  v_mov_b32 v116, 0x40000000
  v_cmp_gt_u32 vcc, 16, v0
  s_lshl_b32 s98, s2, 2
  v_mul_u32_u24 v117, 1280, v0
  v_cndmask_b32 v116, v116, v117, vcc
  v_readfirstlane_b32 s99, v0
  s_waitcnt vmcnt(0)
  s_barrier
  s_cmp_lg_u32 s99, 0
  s_cbranch_scc1 noflag_1
  buffer_store_dword v115, v116, s[64:67], s98 offen sc1
noflag_1:
  s_cmp_ge_u32 s20, 2
  s_cbranch_scc1 P0_nopf
  s_mov_b32 s32, s80
  s_mov_b32 s33, s81
  s_mov_b32 s34, 2211840
  s_mov_b32 s35, 0x20000
  s_mul_i32 s36, s2, 68*128
  v_lshlrev_b32 v4, 7, v0
  v_cmp_gt_u32 vcc, 68, v0
  s_nop 1
  v_cndmask_b32 v4, v109, v4, vcc
  buffer_load_dword v241, v4, s[32:35], s36 offen
  s_mul_i32 s48, s2, 9
  v_add_u32 v110, s48, v0
  v_mul_u32_u24 v111, 10923, v110
  v_lshrrev_b32 v111, 16, v111
  v_mul_u32_u24 v112, 6, v111
  v_sub_u32 v112, v110, v112
  v_mul_u32_u24 v111, 1280, v111
  v_lshl_add_u32 v111, v112, 7, v111
  v_cmp_gt_u32 vcc, 9, v0
  s_nop 1
  v_cndmask_b32 v111, v109, v111, vcc
  s_mov_b32 s32, s74
  s_mov_b32 s33, s75
  s_mov_b32 s34, 450560
  s_mov_b32 s35, 0x20000
  buffer_load_dword v242, v111, s[32:35], 0 offen
  s_mov_b32 s32, s76
  s_mov_b32 s33, s77
  s_mov_b32 s34, 450560
  s_mov_b32 s35, 0x20000
  buffer_load_dword v243, v111, s[32:35], 0 offen
P0_nopf:
PH1:
  s_mov_b32 s4, s80
  s_mov_b32 s5, s81
  s_mov_b32 s6, s92
  s_mov_b32 s7, s93
  s_mov_b32 s8, s74
  s_mov_b32 s9, s75
  s_mov_b32 s10, s76
  s_mov_b32 s11, s77
  s_and_b32 s14, s2, 7
  s_lshr_b32 s15, s2, 3
  s_lshr_b32 s59, s14, 1
  s_and_b32 s60, s14, 1
  s_cmp_ge_u32 s15, 28
  s_cbranch_scc1 P1_dft
  s_cmp_ge_u32 s15, 26
  s_cbranch_scc1 P1_dbl
  s_mul_i32 s19, s60, 26
  s_add_u32 s19, s19, s15
  s_and_b32 s17, s19, 3
  s_lshl_b32 s18, s59, 2
  s_add_u32 s17, s17, s18
  s_lshr_b32 s18, s19, 2
  s_lshl_b32 s19, s17, 7
  s_lshl_b32 s20, s18, 1
  s_add_u32 s50, s20, 1
  v_readfirstlane_b32 s98, v0
  s_nop 3
  s_cmp_ge_u32 s98, 256
  s_cbranch_scc1 P1_std_ld
  v_and_b32 v1, 63, v0
  v_bfe_u32 v2, v0, 6, 2
  s_nop 0
  v_readfirstlane_b32 s16, v2
  v_lshrrev_b32 v9, 1, v2
  v_lshlrev_b32 v9, 2, v9
  v_and_b32 v10, 1, v2
  v_lshlrev_b32 v10, 6, v10
  v_lshrrev_b32 v3, 4, v1
  v_bfe_u32 v5, v1, 2, 2
  v_lshl_add_u32 v4, v3, 3, v5
  v_mul_u32_u24 v4, 256, v4
  v_and_b32 v6, 1, v1
  v_lshl_add_u32 v4, v6, 3, v4
  v_bfe_u32 v6, v1, 1, 1
  v_and_b32 v3, 1, v3
  v_lshlrev_b32 v3, 1, v3
  v_lshlrev_b32 v5, 2, v5
  v_xor_b32 v3, v3, v5
  v_add_u32 v7, 0, v9
  v_lshl_add_u32 v7, v7, 1, v6
  v_xor_b32 v7, v7, v3
  v_lshl_add_u32 v11, v7, 4, v4
  v_add_u32 v7, 1, v9
  v_lshl_add_u32 v7, v7, 1, v6
  v_xor_b32 v7, v7, v3
  v_lshl_add_u32 v12, v7, 4, v4
  v_add_u32 v7, 2, v9
  v_lshl_add_u32 v7, v7, 1, v6
  v_xor_b32 v7, v7, v3
  v_lshl_add_u32 v13, v7, 4, v4
  v_add_u32 v7, 3, v9
  v_lshl_add_u32 v7, v7, 1, v6
  v_xor_b32 v7, v7, v3
  v_lshl_add_u32 v14, v7, 4, v4
  v_add_u32 v15, 65536, v11
  v_add_u32 v16, 65536, v12
  v_add_u32 v17, 65536, v13
  v_add_u32 v18, 65536, v14
  v_and_b32 v3, 15, v1
  v_add_u32 v3, v3, v10
  v_bfe_u32 v4, v3, 1, 3
  v_lshrrev_b32 v5, 4, v1
  v_xor_b32 v4, v4, v5
  v_lshlrev_b32 v4, 4, v4
  v_lshl_add_u32 v4, v3, 7, v4
  v_xor_b32 v19, 0, v4
  v_add_u32 v19, 16384, v19
  v_xor_b32 v20, 64, v4
  v_add_u32 v20, 16384, v20
  v_add_u32 v21, 65536, v19
  v_add_u32 v22, 65536, v20
  v_lshrrev_b32 v3, 5, v1
  v_add_u32 v3, v3, v9
  v_mul_u32_u24 v23, 34816, v3
  v_and_b32 v3, 31, v1
  v_add_u32 v3, v3, v10
  v_lshl_add_u32 v23, v3, 4, v23
  v_mov_b32 v24, 0xc0135761
  v_mov_b32 v25, 0xc0135761
  s_mov_b32 s36, 0xbdd2d3e8
  s_mov_b32 s37, 0xbdd2d3e8
  s_mov_b32 s38, 1.0
  s_mov_b32 s39, 1.0
  s_mul_i32 s45, s20, 139264
  s_lshl_b32 s48, s19, 4
  s_add_u32 s45, s45, s48
  s_mul_i32 s51, s50, 139264
  s_add_u32 s51, s51, s48
  s_waitcnt lgkmcnt(0)
  s_add_u32 s24, s6, 32505856
  s_addc_u32 s25, s7, 0
  s_mov_b32 s26, 229376
  s_mov_b32 s27, 0x20000
  s_add_u32 s28, s6, 8388608
  s_addc_u32 s29, s7, 0
  s_mov_b32 s30, 3760128
  s_mov_b32 s31, 0x20000
  s_add_u32 s40, s6, 12582912
  s_addc_u32 s41, s7, 0
  s_mov_b32 s42, 3760128
  s_mov_b32 s43, 0x20000
  s_barrier
  s_barrier
  ds_read_b64_tr_b16 v[92:93], v11 offset:0
  ds_read_b64_tr_b16 v[94:95], v11 offset:1024
  ds_read_b128 v[96:99], v19 offset:0
  ds_read_b128 v[100:103], v19 offset:2048
  ds_read_b64_tr_b16 v[104:105], v12 offset:0
  ds_read_b64_tr_b16 v[106:107], v12 offset:1024
  ds_read_b128 v[108:111], v19 offset:4096
  ds_read_b128 v[112:115], v19 offset:6144
  ds_read_b64_tr_b16 v[116:117], v13 offset:0
  ds_read_b64_tr_b16 v[118:119], v13 offset:1024
  ds_read_b64_tr_b16 v[120:121], v14 offset:0
  ds_read_b64_tr_b16 v[122:123], v14 offset:1024
  s_waitcnt lgkmcnt(9)
  v_mfma_f32_16x16x32_bf16 v[28:31], v[92:95], v[96:99], 0
  ds_read_b64_tr_b16 v[124:125], v11 offset:8192
  s_waitcnt lgkmcnt(9)
  v_mfma_f32_16x16x32_bf16 v[32:35], v[92:95], v[100:103], 0
  ds_read_b64_tr_b16 v[126:127], v11 offset:9216
  s_waitcnt lgkmcnt(8)
  v_mfma_f32_16x16x32_bf16 v[44:47], v[104:107], v[96:99], 0
  ds_read_b128 v[128:131], v20 offset:0
  v_mfma_f32_16x16x32_bf16 v[48:51], v[104:107], v[100:103], 0
  ds_read_b128 v[132:135], v20 offset:2048
  s_waitcnt lgkmcnt(9)
  v_mfma_f32_16x16x32_bf16 v[36:39], v[92:95], v[108:111], 0
  ds_read_b64_tr_b16 v[136:137], v12 offset:8192
  s_waitcnt lgkmcnt(9)
  v_mfma_f32_16x16x32_bf16 v[40:43], v[92:95], v[112:115], 0
  ds_read_b64_tr_b16 v[138:139], v12 offset:9216
  v_mfma_f32_16x16x32_bf16 v[52:55], v[104:107], v[108:111], 0
  ds_read_b128 v[140:143], v20 offset:4096
  v_mfma_f32_16x16x32_bf16 v[56:59], v[104:107], v[112:115], 0
  ds_read_b128 v[144:147], v20 offset:6144
  s_waitcnt lgkmcnt(10)
  v_mfma_f32_16x16x32_bf16 v[60:63], v[116:119], v[96:99], 0
  ds_read_b64_tr_b16 v[148:149], v13 offset:8192
  v_mfma_f32_16x16x32_bf16 v[64:67], v[116:119], v[100:103], 0
  ds_read_b64_tr_b16 v[150:151], v13 offset:9216
  s_waitcnt lgkmcnt(10)
  v_mfma_f32_16x16x32_bf16 v[76:79], v[120:123], v[96:99], 0
  ds_read_b64_tr_b16 v[152:153], v14 offset:8192
  v_mfma_f32_16x16x32_bf16 v[80:83], v[120:123], v[100:103], 0
  ds_read_b64_tr_b16 v[154:155], v14 offset:9216
  v_mfma_f32_16x16x32_bf16 v[68:71], v[116:119], v[108:111], 0
  v_mfma_f32_16x16x32_bf16 v[72:75], v[116:119], v[112:115], 0
  v_mfma_f32_16x16x32_bf16 v[84:87], v[120:123], v[108:111], 0
  v_mfma_f32_16x16x32_bf16 v[88:91], v[120:123], v[112:115], 0
  s_waitcnt lgkmcnt(9)
  v_mfma_f32_16x16x32_bf16 v[28:31], v[124:127], v[128:131], v[28:31]
  s_waitcnt lgkmcnt(8)
  v_mfma_f32_16x16x32_bf16 v[32:35], v[124:127], v[132:135], v[32:35]
  s_waitcnt lgkmcnt(0)
  s_barrier
  ds_read_b64_tr_b16 v[92:93], v11 offset:32768
  v_mfma_f32_16x16x32_bf16 v[44:47], v[136:139], v[128:131], v[44:47]
  ds_read_b64_tr_b16 v[94:95], v11 offset:33792
  v_mfma_f32_16x16x32_bf16 v[48:51], v[136:139], v[132:135], v[48:51]
  ds_read_b128 v[96:99], v19 offset:32768
  v_mfma_f32_16x16x32_bf16 v[36:39], v[124:127], v[140:143], v[36:39]
  ds_read_b128 v[100:103], v19 offset:34816
  v_mfma_f32_16x16x32_bf16 v[40:43], v[124:127], v[144:147], v[40:43]
  ds_read_b64_tr_b16 v[104:105], v12 offset:32768
  v_mfma_f32_16x16x32_bf16 v[52:55], v[136:139], v[140:143], v[52:55]
  ds_read_b64_tr_b16 v[106:107], v12 offset:33792
  v_mfma_f32_16x16x32_bf16 v[56:59], v[136:139], v[144:147], v[56:59]
  ds_read_b128 v[108:111], v19 offset:36864
  v_mfma_f32_16x16x32_bf16 v[60:63], v[148:151], v[128:131], v[60:63]
  ds_read_b128 v[112:115], v19 offset:38912
  v_mfma_f32_16x16x32_bf16 v[64:67], v[148:151], v[132:135], v[64:67]
  ds_read_b64_tr_b16 v[116:117], v13 offset:32768
  v_mfma_f32_16x16x32_bf16 v[76:79], v[152:155], v[128:131], v[76:79]
  ds_read_b64_tr_b16 v[118:119], v13 offset:33792
  v_mfma_f32_16x16x32_bf16 v[80:83], v[152:155], v[132:135], v[80:83]
  ds_read_b64_tr_b16 v[120:121], v14 offset:32768
  v_mfma_f32_16x16x32_bf16 v[68:71], v[148:151], v[140:143], v[68:71]
  ds_read_b64_tr_b16 v[122:123], v14 offset:33792
  v_mfma_f32_16x16x32_bf16 v[72:75], v[148:151], v[144:147], v[72:75]
  v_mfma_f32_16x16x32_bf16 v[84:87], v[152:155], v[140:143], v[84:87]
  v_mfma_f32_16x16x32_bf16 v[88:91], v[152:155], v[144:147], v[88:91]
  s_waitcnt lgkmcnt(9)
  v_mfma_f32_16x16x32_bf16 v[28:31], v[92:95], v[96:99], v[28:31]
  ds_read_b64_tr_b16 v[124:125], v11 offset:40960
  s_waitcnt lgkmcnt(9)
  v_mfma_f32_16x16x32_bf16 v[32:35], v[92:95], v[100:103], v[32:35]
  ds_read_b64_tr_b16 v[126:127], v11 offset:41984
  s_waitcnt lgkmcnt(8)
  v_mfma_f32_16x16x32_bf16 v[44:47], v[104:107], v[96:99], v[44:47]
  ds_read_b128 v[128:131], v20 offset:32768
  v_mfma_f32_16x16x32_bf16 v[48:51], v[104:107], v[100:103], v[48:51]
  ds_read_b128 v[132:135], v20 offset:34816
  s_waitcnt lgkmcnt(9)
  v_mfma_f32_16x16x32_bf16 v[36:39], v[92:95], v[108:111], v[36:39]
  ds_read_b64_tr_b16 v[136:137], v12 offset:40960
  s_waitcnt lgkmcnt(9)
  v_mfma_f32_16x16x32_bf16 v[40:43], v[92:95], v[112:115], v[40:43]
  ds_read_b64_tr_b16 v[138:139], v12 offset:41984
  v_mfma_f32_16x16x32_bf16 v[52:55], v[104:107], v[108:111], v[52:55]
  ds_read_b128 v[140:143], v20 offset:36864
  v_mfma_f32_16x16x32_bf16 v[56:59], v[104:107], v[112:115], v[56:59]
  ds_read_b128 v[144:147], v20 offset:38912
  s_waitcnt lgkmcnt(10)
  v_mfma_f32_16x16x32_bf16 v[60:63], v[116:119], v[96:99], v[60:63]
  ds_read_b64_tr_b16 v[148:149], v13 offset:40960
  v_mfma_f32_16x16x32_bf16 v[64:67], v[116:119], v[100:103], v[64:67]
  ds_read_b64_tr_b16 v[150:151], v13 offset:41984
  s_waitcnt lgkmcnt(10)
  v_mfma_f32_16x16x32_bf16 v[76:79], v[120:123], v[96:99], v[76:79]
  ds_read_b64_tr_b16 v[152:153], v14 offset:40960
  v_mfma_f32_16x16x32_bf16 v[80:83], v[120:123], v[100:103], v[80:83]
  ds_read_b64_tr_b16 v[154:155], v14 offset:41984
  v_mfma_f32_16x16x32_bf16 v[68:71], v[116:119], v[108:111], v[68:71]
  v_mfma_f32_16x16x32_bf16 v[72:75], v[116:119], v[112:115], v[72:75]
  v_mfma_f32_16x16x32_bf16 v[84:87], v[120:123], v[108:111], v[84:87]
  v_mfma_f32_16x16x32_bf16 v[88:91], v[120:123], v[112:115], v[88:91]
  s_waitcnt lgkmcnt(9)
  v_mfma_f32_16x16x32_bf16 v[28:31], v[124:127], v[128:131], v[28:31]
  s_waitcnt lgkmcnt(8)
  v_mfma_f32_16x16x32_bf16 v[32:35], v[124:127], v[132:135], v[32:35]
  s_waitcnt lgkmcnt(0)
  s_barrier
  ds_read_b64_tr_b16 v[92:93], v15 offset:0
  v_mfma_f32_16x16x32_bf16 v[44:47], v[136:139], v[128:131], v[44:47]
  ds_read_b64_tr_b16 v[94:95], v15 offset:1024
  v_mfma_f32_16x16x32_bf16 v[48:51], v[136:139], v[132:135], v[48:51]
  ds_read_b128 v[96:99], v21 offset:0
  v_mfma_f32_16x16x32_bf16 v[36:39], v[124:127], v[140:143], v[36:39]
  ds_read_b128 v[100:103], v21 offset:2048
  v_mfma_f32_16x16x32_bf16 v[40:43], v[124:127], v[144:147], v[40:43]
  ds_read_b64_tr_b16 v[104:105], v16 offset:0
  v_mfma_f32_16x16x32_bf16 v[52:55], v[136:139], v[140:143], v[52:55]
  ds_read_b64_tr_b16 v[106:107], v16 offset:1024
  v_mfma_f32_16x16x32_bf16 v[56:59], v[136:139], v[144:147], v[56:59]
  ds_read_b128 v[108:111], v21 offset:4096
  v_mfma_f32_16x16x32_bf16 v[60:63], v[148:151], v[128:131], v[60:63]
  ds_read_b128 v[112:115], v21 offset:6144
  v_mfma_f32_16x16x32_bf16 v[64:67], v[148:151], v[132:135], v[64:67]
  ds_read_b64_tr_b16 v[116:117], v17 offset:0
  v_mfma_f32_16x16x32_bf16 v[76:79], v[152:155], v[128:131], v[76:79]
  ds_read_b64_tr_b16 v[118:119], v17 offset:1024
  v_mfma_f32_16x16x32_bf16 v[80:83], v[152:155], v[132:135], v[80:83]
  ds_read_b64_tr_b16 v[120:121], v18 offset:0
  v_mfma_f32_16x16x32_bf16 v[68:71], v[148:151], v[140:143], v[68:71]
  ds_read_b64_tr_b16 v[122:123], v18 offset:1024
  v_mfma_f32_16x16x32_bf16 v[72:75], v[148:151], v[144:147], v[72:75]
  v_mfma_f32_16x16x32_bf16 v[84:87], v[152:155], v[140:143], v[84:87]
  v_mfma_f32_16x16x32_bf16 v[88:91], v[152:155], v[144:147], v[88:91]
  s_waitcnt lgkmcnt(9)
  v_mfma_f32_16x16x32_bf16 v[28:31], v[92:95], v[96:99], v[28:31]
  ds_read_b64_tr_b16 v[124:125], v15 offset:8192
  s_waitcnt lgkmcnt(9)
  v_mfma_f32_16x16x32_bf16 v[32:35], v[92:95], v[100:103], v[32:35]
  ds_read_b64_tr_b16 v[126:127], v15 offset:9216
  s_waitcnt lgkmcnt(8)
  v_mfma_f32_16x16x32_bf16 v[44:47], v[104:107], v[96:99], v[44:47]
  ds_read_b128 v[128:131], v22 offset:0
  v_mfma_f32_16x16x32_bf16 v[48:51], v[104:107], v[100:103], v[48:51]
  ds_read_b128 v[132:135], v22 offset:2048
  s_waitcnt lgkmcnt(9)
  v_mfma_f32_16x16x32_bf16 v[36:39], v[92:95], v[108:111], v[36:39]
  ds_read_b64_tr_b16 v[136:137], v16 offset:8192
  s_waitcnt lgkmcnt(9)
  v_mfma_f32_16x16x32_bf16 v[40:43], v[92:95], v[112:115], v[40:43]
  ds_read_b64_tr_b16 v[138:139], v16 offset:9216
  v_mfma_f32_16x16x32_bf16 v[52:55], v[104:107], v[108:111], v[52:55]
  ds_read_b128 v[140:143], v22 offset:4096
  v_mfma_f32_16x16x32_bf16 v[56:59], v[104:107], v[112:115], v[56:59]
  ds_read_b128 v[144:147], v22 offset:6144
  s_waitcnt lgkmcnt(10)
  v_mfma_f32_16x16x32_bf16 v[60:63], v[116:119], v[96:99], v[60:63]
  ds_read_b64_tr_b16 v[148:149], v17 offset:8192
  v_mfma_f32_16x16x32_bf16 v[64:67], v[116:119], v[100:103], v[64:67]
  ds_read_b64_tr_b16 v[150:151], v17 offset:9216
  s_waitcnt lgkmcnt(10)
  v_mfma_f32_16x16x32_bf16 v[76:79], v[120:123], v[96:99], v[76:79]
  ds_read_b64_tr_b16 v[152:153], v18 offset:8192
  v_mfma_f32_16x16x32_bf16 v[80:83], v[120:123], v[100:103], v[80:83]
  ds_read_b64_tr_b16 v[154:155], v18 offset:9216
  v_mfma_f32_16x16x32_bf16 v[68:71], v[116:119], v[108:111], v[68:71]
  v_mfma_f32_16x16x32_bf16 v[72:75], v[116:119], v[112:115], v[72:75]
  v_mfma_f32_16x16x32_bf16 v[84:87], v[120:123], v[108:111], v[84:87]
  v_mfma_f32_16x16x32_bf16 v[88:91], v[120:123], v[112:115], v[88:91]
  s_waitcnt lgkmcnt(9)
  v_mfma_f32_16x16x32_bf16 v[28:31], v[124:127], v[128:131], v[28:31]
  s_waitcnt lgkmcnt(8)
  v_mfma_f32_16x16x32_bf16 v[32:35], v[124:127], v[132:135], v[32:35]
  s_waitcnt lgkmcnt(0)
  s_barrier
  ds_read_b64_tr_b16 v[92:93], v15 offset:32768
  v_mfma_f32_16x16x32_bf16 v[44:47], v[136:139], v[128:131], v[44:47]
  ds_read_b64_tr_b16 v[94:95], v15 offset:33792
  v_mfma_f32_16x16x32_bf16 v[48:51], v[136:139], v[132:135], v[48:51]
  ds_read_b128 v[96:99], v21 offset:32768
  v_mfma_f32_16x16x32_bf16 v[36:39], v[124:127], v[140:143], v[36:39]
  ds_read_b128 v[100:103], v21 offset:34816
  v_mfma_f32_16x16x32_bf16 v[40:43], v[124:127], v[144:147], v[40:43]
  ds_read_b64_tr_b16 v[104:105], v16 offset:32768
  v_mfma_f32_16x16x32_bf16 v[52:55], v[136:139], v[140:143], v[52:55]
  ds_read_b64_tr_b16 v[106:107], v16 offset:33792
  v_mfma_f32_16x16x32_bf16 v[56:59], v[136:139], v[144:147], v[56:59]
  ds_read_b128 v[108:111], v21 offset:36864
  v_mfma_f32_16x16x32_bf16 v[60:63], v[148:151], v[128:131], v[60:63]
  ds_read_b128 v[112:115], v21 offset:38912
  v_mfma_f32_16x16x32_bf16 v[64:67], v[148:151], v[132:135], v[64:67]
  ds_read_b64_tr_b16 v[116:117], v17 offset:32768
  v_mfma_f32_16x16x32_bf16 v[76:79], v[152:155], v[128:131], v[76:79]
  ds_read_b64_tr_b16 v[118:119], v17 offset:33792
  v_mfma_f32_16x16x32_bf16 v[80:83], v[152:155], v[132:135], v[80:83]
  ds_read_b64_tr_b16 v[120:121], v18 offset:32768
  v_mfma_f32_16x16x32_bf16 v[68:71], v[148:151], v[140:143], v[68:71]
  ds_read_b64_tr_b16 v[122:123], v18 offset:33792
  v_mfma_f32_16x16x32_bf16 v[72:75], v[148:151], v[144:147], v[72:75]
  v_mfma_f32_16x16x32_bf16 v[84:87], v[152:155], v[140:143], v[84:87]
  v_mfma_f32_16x16x32_bf16 v[88:91], v[152:155], v[144:147], v[88:91]
  s_waitcnt lgkmcnt(9)
  v_mfma_f32_16x16x32_bf16 v[28:31], v[92:95], v[96:99], v[28:31]
  ds_read_b64_tr_b16 v[124:125], v15 offset:40960
  s_waitcnt lgkmcnt(9)
  v_mfma_f32_16x16x32_bf16 v[32:35], v[92:95], v[100:103], v[32:35]
  ds_read_b64_tr_b16 v[126:127], v15 offset:41984
  s_waitcnt lgkmcnt(8)
  v_mfma_f32_16x16x32_bf16 v[44:47], v[104:107], v[96:99], v[44:47]
  ds_read_b128 v[128:131], v22 offset:32768
  v_mfma_f32_16x16x32_bf16 v[48:51], v[104:107], v[100:103], v[48:51]
  ds_read_b128 v[132:135], v22 offset:34816
  s_waitcnt lgkmcnt(9)
  v_mfma_f32_16x16x32_bf16 v[36:39], v[92:95], v[108:111], v[36:39]
  ds_read_b64_tr_b16 v[136:137], v16 offset:40960
  s_waitcnt lgkmcnt(9)
  v_mfma_f32_16x16x32_bf16 v[40:43], v[92:95], v[112:115], v[40:43]
  ds_read_b64_tr_b16 v[138:139], v16 offset:41984
  v_mfma_f32_16x16x32_bf16 v[52:55], v[104:107], v[108:111], v[52:55]
  ds_read_b128 v[140:143], v22 offset:36864
  v_mfma_f32_16x16x32_bf16 v[56:59], v[104:107], v[112:115], v[56:59]
  ds_read_b128 v[144:147], v22 offset:38912
  s_waitcnt lgkmcnt(10)
  v_mfma_f32_16x16x32_bf16 v[60:63], v[116:119], v[96:99], v[60:63]
  ds_read_b64_tr_b16 v[148:149], v17 offset:40960
  v_mfma_f32_16x16x32_bf16 v[64:67], v[116:119], v[100:103], v[64:67]
  ds_read_b64_tr_b16 v[150:151], v17 offset:41984
  s_waitcnt lgkmcnt(10)
  v_mfma_f32_16x16x32_bf16 v[76:79], v[120:123], v[96:99], v[76:79]
  ds_read_b64_tr_b16 v[152:153], v18 offset:40960
  v_mfma_f32_16x16x32_bf16 v[80:83], v[120:123], v[100:103], v[80:83]
  ds_read_b64_tr_b16 v[154:155], v18 offset:41984
  v_mfma_f32_16x16x32_bf16 v[68:71], v[116:119], v[108:111], v[68:71]
  v_mfma_f32_16x16x32_bf16 v[72:75], v[116:119], v[112:115], v[72:75]
  v_mfma_f32_16x16x32_bf16 v[84:87], v[120:123], v[108:111], v[84:87]
  v_mfma_f32_16x16x32_bf16 v[88:91], v[120:123], v[112:115], v[88:91]
  s_waitcnt lgkmcnt(9)
  v_mfma_f32_16x16x32_bf16 v[28:31], v[124:127], v[128:131], v[28:31]
  s_waitcnt lgkmcnt(8)
  v_mfma_f32_16x16x32_bf16 v[32:35], v[124:127], v[132:135], v[32:35]
  s_waitcnt lgkmcnt(0)
  s_barrier
  ds_read_b64_tr_b16 v[92:93], v11 offset:0
  v_mfma_f32_16x16x32_bf16 v[44:47], v[136:139], v[128:131], v[44:47]
  ds_read_b64_tr_b16 v[94:95], v11 offset:1024
  v_mfma_f32_16x16x32_bf16 v[48:51], v[136:139], v[132:135], v[48:51]
  ds_read_b128 v[96:99], v19 offset:0
  v_mfma_f32_16x16x32_bf16 v[36:39], v[124:127], v[140:143], v[36:39]
  ds_read_b128 v[100:103], v19 offset:2048
  v_mfma_f32_16x16x32_bf16 v[40:43], v[124:127], v[144:147], v[40:43]
  ds_read_b64_tr_b16 v[104:105], v12 offset:0
  v_mfma_f32_16x16x32_bf16 v[52:55], v[136:139], v[140:143], v[52:55]
  ds_read_b64_tr_b16 v[106:107], v12 offset:1024
  v_mfma_f32_16x16x32_bf16 v[56:59], v[136:139], v[144:147], v[56:59]
  ds_read_b128 v[108:111], v19 offset:4096
  v_mfma_f32_16x16x32_bf16 v[60:63], v[148:151], v[128:131], v[60:63]
  ds_read_b128 v[112:115], v19 offset:6144
  v_mfma_f32_16x16x32_bf16 v[64:67], v[148:151], v[132:135], v[64:67]
  ds_read_b64_tr_b16 v[116:117], v13 offset:0
  v_mfma_f32_16x16x32_bf16 v[76:79], v[152:155], v[128:131], v[76:79]
  ds_read_b64_tr_b16 v[118:119], v13 offset:1024
  v_mfma_f32_16x16x32_bf16 v[80:83], v[152:155], v[132:135], v[80:83]
  ds_read_b64_tr_b16 v[120:121], v14 offset:0
  v_mfma_f32_16x16x32_bf16 v[68:71], v[148:151], v[140:143], v[68:71]
  ds_read_b64_tr_b16 v[122:123], v14 offset:1024
  v_mfma_f32_16x16x32_bf16 v[72:75], v[148:151], v[144:147], v[72:75]
  v_mfma_f32_16x16x32_bf16 v[84:87], v[152:155], v[140:143], v[84:87]
  v_mfma_f32_16x16x32_bf16 v[88:91], v[152:155], v[144:147], v[88:91]
  s_waitcnt lgkmcnt(9)
  v_mfma_f32_16x16x32_bf16 v[28:31], v[92:95], v[96:99], v[28:31]
  ds_read_b64_tr_b16 v[124:125], v11 offset:8192
  s_waitcnt lgkmcnt(9)
  v_mfma_f32_16x16x32_bf16 v[32:35], v[92:95], v[100:103], v[32:35]
  ds_read_b64_tr_b16 v[126:127], v11 offset:9216
  s_waitcnt lgkmcnt(8)
  v_mfma_f32_16x16x32_bf16 v[44:47], v[104:107], v[96:99], v[44:47]
  ds_read_b128 v[128:131], v20 offset:0
  v_mfma_f32_16x16x32_bf16 v[48:51], v[104:107], v[100:103], v[48:51]
  ds_read_b128 v[132:135], v20 offset:2048
  s_waitcnt lgkmcnt(9)
  v_mfma_f32_16x16x32_bf16 v[36:39], v[92:95], v[108:111], v[36:39]
  ds_read_b64_tr_b16 v[136:137], v12 offset:8192
  s_waitcnt lgkmcnt(9)
  v_mfma_f32_16x16x32_bf16 v[40:43], v[92:95], v[112:115], v[40:43]
  ds_read_b64_tr_b16 v[138:139], v12 offset:9216
  v_mfma_f32_16x16x32_bf16 v[52:55], v[104:107], v[108:111], v[52:55]
  ds_read_b128 v[140:143], v20 offset:4096
  v_mfma_f32_16x16x32_bf16 v[56:59], v[104:107], v[112:115], v[56:59]
  ds_read_b128 v[144:147], v20 offset:6144
  s_waitcnt lgkmcnt(10)
  v_mfma_f32_16x16x32_bf16 v[60:63], v[116:119], v[96:99], v[60:63]
  ds_read_b64_tr_b16 v[148:149], v13 offset:8192
  v_mfma_f32_16x16x32_bf16 v[64:67], v[116:119], v[100:103], v[64:67]
  ds_read_b64_tr_b16 v[150:151], v13 offset:9216
  s_waitcnt lgkmcnt(10)
  v_mfma_f32_16x16x32_bf16 v[76:79], v[120:123], v[96:99], v[76:79]
  ds_read_b64_tr_b16 v[152:153], v14 offset:8192
  v_mfma_f32_16x16x32_bf16 v[80:83], v[120:123], v[100:103], v[80:83]
  ds_read_b64_tr_b16 v[154:155], v14 offset:9216
  v_mfma_f32_16x16x32_bf16 v[68:71], v[116:119], v[108:111], v[68:71]
  v_mfma_f32_16x16x32_bf16 v[72:75], v[116:119], v[112:115], v[72:75]
  v_mfma_f32_16x16x32_bf16 v[84:87], v[120:123], v[108:111], v[84:87]
  v_mfma_f32_16x16x32_bf16 v[88:91], v[120:123], v[112:115], v[88:91]
  s_waitcnt lgkmcnt(9)
  v_mfma_f32_16x16x32_bf16 v[28:31], v[124:127], v[128:131], v[28:31]
  s_waitcnt lgkmcnt(8)
  v_mfma_f32_16x16x32_bf16 v[32:35], v[124:127], v[132:135], v[32:35]
  s_waitcnt lgkmcnt(0)
  s_barrier
  ds_read_b64_tr_b16 v[92:93], v11 offset:32768
  v_mfma_f32_16x16x32_bf16 v[44:47], v[136:139], v[128:131], v[44:47]
  ds_read_b64_tr_b16 v[94:95], v11 offset:33792
  v_mfma_f32_16x16x32_bf16 v[48:51], v[136:139], v[132:135], v[48:51]
  ds_read_b128 v[96:99], v19 offset:32768
  v_mfma_f32_16x16x32_bf16 v[36:39], v[124:127], v[140:143], v[36:39]
  ds_read_b128 v[100:103], v19 offset:34816
  v_mfma_f32_16x16x32_bf16 v[40:43], v[124:127], v[144:147], v[40:43]
  ds_read_b64_tr_b16 v[104:105], v12 offset:32768
  v_mfma_f32_16x16x32_bf16 v[52:55], v[136:139], v[140:143], v[52:55]
  ds_read_b64_tr_b16 v[106:107], v12 offset:33792
  v_mfma_f32_16x16x32_bf16 v[56:59], v[136:139], v[144:147], v[56:59]
  ds_read_b128 v[108:111], v19 offset:36864
  v_mfma_f32_16x16x32_bf16 v[60:63], v[148:151], v[128:131], v[60:63]
  ds_read_b128 v[112:115], v19 offset:38912
  v_mfma_f32_16x16x32_bf16 v[64:67], v[148:151], v[132:135], v[64:67]
  ds_read_b64_tr_b16 v[116:117], v13 offset:32768
  v_mfma_f32_16x16x32_bf16 v[76:79], v[152:155], v[128:131], v[76:79]
  ds_read_b64_tr_b16 v[118:119], v13 offset:33792
  v_mfma_f32_16x16x32_bf16 v[80:83], v[152:155], v[132:135], v[80:83]
  ds_read_b64_tr_b16 v[120:121], v14 offset:32768
  v_mfma_f32_16x16x32_bf16 v[68:71], v[148:151], v[140:143], v[68:71]
  ds_read_b64_tr_b16 v[122:123], v14 offset:33792
  v_mfma_f32_16x16x32_bf16 v[72:75], v[148:151], v[144:147], v[72:75]
  v_mfma_f32_16x16x32_bf16 v[84:87], v[152:155], v[140:143], v[84:87]
  v_mfma_f32_16x16x32_bf16 v[88:91], v[152:155], v[144:147], v[88:91]
  s_waitcnt lgkmcnt(9)
  v_mfma_f32_16x16x32_bf16 v[28:31], v[92:95], v[96:99], v[28:31]
  ds_read_b64_tr_b16 v[124:125], v11 offset:40960
  s_waitcnt lgkmcnt(9)
  v_mfma_f32_16x16x32_bf16 v[32:35], v[92:95], v[100:103], v[32:35]
  ds_read_b64_tr_b16 v[126:127], v11 offset:41984
  s_waitcnt lgkmcnt(8)
  v_mfma_f32_16x16x32_bf16 v[44:47], v[104:107], v[96:99], v[44:47]
  ds_read_b128 v[128:131], v20 offset:32768
  v_mfma_f32_16x16x32_bf16 v[48:51], v[104:107], v[100:103], v[48:51]
  ds_read_b128 v[132:135], v20 offset:34816
  s_waitcnt lgkmcnt(9)
  v_mfma_f32_16x16x32_bf16 v[36:39], v[92:95], v[108:111], v[36:39]
  ds_read_b64_tr_b16 v[136:137], v12 offset:40960
  s_waitcnt lgkmcnt(9)
  v_mfma_f32_16x16x32_bf16 v[40:43], v[92:95], v[112:115], v[40:43]
  ds_read_b64_tr_b16 v[138:139], v12 offset:41984
  v_mfma_f32_16x16x32_bf16 v[52:55], v[104:107], v[108:111], v[52:55]
  ds_read_b128 v[140:143], v20 offset:36864
  v_mfma_f32_16x16x32_bf16 v[56:59], v[104:107], v[112:115], v[56:59]
  ds_read_b128 v[144:147], v20 offset:38912
  s_waitcnt lgkmcnt(10)
  v_mfma_f32_16x16x32_bf16 v[60:63], v[116:119], v[96:99], v[60:63]
  ds_read_b64_tr_b16 v[148:149], v13 offset:40960
  v_mfma_f32_16x16x32_bf16 v[64:67], v[116:119], v[100:103], v[64:67]
  ds_read_b64_tr_b16 v[150:151], v13 offset:41984
  s_waitcnt lgkmcnt(10)
  v_mfma_f32_16x16x32_bf16 v[76:79], v[120:123], v[96:99], v[76:79]
  ds_read_b64_tr_b16 v[152:153], v14 offset:40960
  v_mfma_f32_16x16x32_bf16 v[80:83], v[120:123], v[100:103], v[80:83]
  ds_read_b64_tr_b16 v[154:155], v14 offset:41984
  v_mfma_f32_16x16x32_bf16 v[68:71], v[116:119], v[108:111], v[68:71]
  v_mfma_f32_16x16x32_bf16 v[72:75], v[116:119], v[112:115], v[72:75]
  v_mfma_f32_16x16x32_bf16 v[84:87], v[120:123], v[108:111], v[84:87]
  v_mfma_f32_16x16x32_bf16 v[88:91], v[120:123], v[112:115], v[88:91]
  s_waitcnt lgkmcnt(9)
  v_mfma_f32_16x16x32_bf16 v[28:31], v[124:127], v[128:131], v[28:31]
  s_waitcnt lgkmcnt(8)
  v_mfma_f32_16x16x32_bf16 v[32:35], v[124:127], v[132:135], v[32:35]
  s_waitcnt lgkmcnt(0)
  s_barrier
  ds_read_b64_tr_b16 v[92:93], v15 offset:0
  v_mfma_f32_16x16x32_bf16 v[44:47], v[136:139], v[128:131], v[44:47]
  ds_read_b64_tr_b16 v[94:95], v15 offset:1024
  v_mfma_f32_16x16x32_bf16 v[48:51], v[136:139], v[132:135], v[48:51]
  ds_read_b128 v[96:99], v21 offset:0
  v_mfma_f32_16x16x32_bf16 v[36:39], v[124:127], v[140:143], v[36:39]
  ds_read_b128 v[100:103], v21 offset:2048
  v_mfma_f32_16x16x32_bf16 v[40:43], v[124:127], v[144:147], v[40:43]
  ds_read_b64_tr_b16 v[104:105], v16 offset:0
  v_mfma_f32_16x16x32_bf16 v[52:55], v[136:139], v[140:143], v[52:55]
  ds_read_b64_tr_b16 v[106:107], v16 offset:1024
  v_mfma_f32_16x16x32_bf16 v[56:59], v[136:139], v[144:147], v[56:59]
  ds_read_b128 v[108:111], v21 offset:4096
  v_mfma_f32_16x16x32_bf16 v[60:63], v[148:151], v[128:131], v[60:63]
  ds_read_b128 v[112:115], v21 offset:6144
  v_mfma_f32_16x16x32_bf16 v[64:67], v[148:151], v[132:135], v[64:67]
  ds_read_b64_tr_b16 v[116:117], v17 offset:0
  v_mfma_f32_16x16x32_bf16 v[76:79], v[152:155], v[128:131], v[76:79]
  ds_read_b64_tr_b16 v[118:119], v17 offset:1024
  v_mfma_f32_16x16x32_bf16 v[80:83], v[152:155], v[132:135], v[80:83]
  ds_read_b64_tr_b16 v[120:121], v18 offset:0
  v_mfma_f32_16x16x32_bf16 v[68:71], v[148:151], v[140:143], v[68:71]
  ds_read_b64_tr_b16 v[122:123], v18 offset:1024
  v_mfma_f32_16x16x32_bf16 v[72:75], v[148:151], v[144:147], v[72:75]
  v_mfma_f32_16x16x32_bf16 v[84:87], v[152:155], v[140:143], v[84:87]
  v_mfma_f32_16x16x32_bf16 v[88:91], v[152:155], v[144:147], v[88:91]
  s_waitcnt lgkmcnt(9)
  v_mfma_f32_16x16x32_bf16 v[28:31], v[92:95], v[96:99], v[28:31]
  ds_read_b64_tr_b16 v[124:125], v15 offset:8192
  s_waitcnt lgkmcnt(9)
  v_mfma_f32_16x16x32_bf16 v[32:35], v[92:95], v[100:103], v[32:35]
  ds_read_b64_tr_b16 v[126:127], v15 offset:9216
  s_waitcnt lgkmcnt(8)
  v_mfma_f32_16x16x32_bf16 v[44:47], v[104:107], v[96:99], v[44:47]
  ds_read_b128 v[128:131], v22 offset:0
  v_mfma_f32_16x16x32_bf16 v[48:51], v[104:107], v[100:103], v[48:51]
  ds_read_b128 v[132:135], v22 offset:2048
  s_waitcnt lgkmcnt(9)
  v_mfma_f32_16x16x32_bf16 v[36:39], v[92:95], v[108:111], v[36:39]
  ds_read_b64_tr_b16 v[136:137], v16 offset:8192
  s_waitcnt lgkmcnt(9)
  v_mfma_f32_16x16x32_bf16 v[40:43], v[92:95], v[112:115], v[40:43]
  ds_read_b64_tr_b16 v[138:139], v16 offset:9216
  v_mfma_f32_16x16x32_bf16 v[52:55], v[104:107], v[108:111], v[52:55]
  ds_read_b128 v[140:143], v22 offset:4096
  v_mfma_f32_16x16x32_bf16 v[56:59], v[104:107], v[112:115], v[56:59]
  ds_read_b128 v[144:147], v22 offset:6144
  s_waitcnt lgkmcnt(10)
  v_mfma_f32_16x16x32_bf16 v[60:63], v[116:119], v[96:99], v[60:63]
  ds_read_b64_tr_b16 v[148:149], v17 offset:8192
  v_mfma_f32_16x16x32_bf16 v[64:67], v[116:119], v[100:103], v[64:67]
  ds_read_b64_tr_b16 v[150:151], v17 offset:9216
  s_waitcnt lgkmcnt(10)
  v_mfma_f32_16x16x32_bf16 v[76:79], v[120:123], v[96:99], v[76:79]
  ds_read_b64_tr_b16 v[152:153], v18 offset:8192
  v_mfma_f32_16x16x32_bf16 v[80:83], v[120:123], v[100:103], v[80:83]
  ds_read_b64_tr_b16 v[154:155], v18 offset:9216
  v_mfma_f32_16x16x32_bf16 v[68:71], v[116:119], v[108:111], v[68:71]
  v_mfma_f32_16x16x32_bf16 v[72:75], v[116:119], v[112:115], v[72:75]
  v_mfma_f32_16x16x32_bf16 v[84:87], v[120:123], v[108:111], v[84:87]
  v_mfma_f32_16x16x32_bf16 v[88:91], v[120:123], v[112:115], v[88:91]
  s_waitcnt lgkmcnt(9)
  v_mfma_f32_16x16x32_bf16 v[28:31], v[124:127], v[128:131], v[28:31]
  s_waitcnt lgkmcnt(8)
  v_mfma_f32_16x16x32_bf16 v[32:35], v[124:127], v[132:135], v[32:35]
  s_waitcnt lgkmcnt(0)
  s_barrier
  ds_read_b64_tr_b16 v[92:93], v15 offset:32768
  v_mfma_f32_16x16x32_bf16 v[44:47], v[136:139], v[128:131], v[44:47]
  ds_read_b64_tr_b16 v[94:95], v15 offset:33792
  v_mfma_f32_16x16x32_bf16 v[48:51], v[136:139], v[132:135], v[48:51]
  ds_read_b128 v[96:99], v21 offset:32768
  v_mfma_f32_16x16x32_bf16 v[36:39], v[124:127], v[140:143], v[36:39]
  ds_read_b128 v[100:103], v21 offset:34816
  v_mfma_f32_16x16x32_bf16 v[40:43], v[124:127], v[144:147], v[40:43]
  ds_read_b64_tr_b16 v[104:105], v16 offset:32768
  v_mfma_f32_16x16x32_bf16 v[52:55], v[136:139], v[140:143], v[52:55]
  ds_read_b64_tr_b16 v[106:107], v16 offset:33792
  v_mfma_f32_16x16x32_bf16 v[56:59], v[136:139], v[144:147], v[56:59]
  ds_read_b128 v[108:111], v21 offset:36864
  v_mfma_f32_16x16x32_bf16 v[60:63], v[148:151], v[128:131], v[60:63]
  ds_read_b128 v[112:115], v21 offset:38912
  v_mfma_f32_16x16x32_bf16 v[64:67], v[148:151], v[132:135], v[64:67]
  ds_read_b64_tr_b16 v[116:117], v17 offset:32768
  v_mfma_f32_16x16x32_bf16 v[76:79], v[152:155], v[128:131], v[76:79]
  ds_read_b64_tr_b16 v[118:119], v17 offset:33792
  v_mfma_f32_16x16x32_bf16 v[80:83], v[152:155], v[132:135], v[80:83]
  ds_read_b64_tr_b16 v[120:121], v18 offset:32768
  v_mfma_f32_16x16x32_bf16 v[68:71], v[148:151], v[140:143], v[68:71]
  ds_read_b64_tr_b16 v[122:123], v18 offset:33792
  v_mfma_f32_16x16x32_bf16 v[72:75], v[148:151], v[144:147], v[72:75]
  v_mfma_f32_16x16x32_bf16 v[84:87], v[152:155], v[140:143], v[84:87]
  v_mfma_f32_16x16x32_bf16 v[88:91], v[152:155], v[144:147], v[88:91]
  s_and_b32 s58, s2, 7
  s_lshr_b32 s61, s2, 3
  s_mov_b32 s64, s82
  s_mov_b32 s65, s83
  s_mov_b32 s66, 8388608
  s_mov_b32 s67, 0x20000
  s_lshl_b32 s48, s61, 8
  v_add_u32 v3, s48, v0
  v_lshrrev_b32 v4, 4, v3
  v_and_b32 v3, 15, v3
  v_lshlrev_b32 v4, 12, v4
  v_lshl_add_u32 v4, v3, 7, v4
  s_lshr_b32 s48, s58, 1
  s_lshl_b32 s48, s48, 21
  s_and_b32 s49, s58, 1
  s_lshl_b32 s49, s49, 11
  s_add_u32 s48, s48, s49
  buffer_load_dword v246, v4, s[64:67], s48 offen
  s_mul_i32 s48, s61, 72
  v_add_u32 v3, s48, v0
  v_mul_u32_u24 v4, 7282, v3
  v_lshrrev_b32 v4, 16, v4
  v_mul_u32_u24 v5, 9, v4
  v_sub_u32 v5, v3, v5
  v_and_b32 v6, 127, v4
  v_lshlrev_b32 v6, 13, v6
  v_lshl_add_u32 v6, v5, 7, v6
  v_lshrrev_b32 v4, 7, v4
  s_and_b32 s48, s58, 3
  s_lshl_b32 s48, s48, 8
  s_lshr_b32 s49, s58, 2
  s_add_u32 s48, s48, s49
  s_lshl_b32 s48, s48, 12
  v_mov_b32 v5, 0x40000000
  v_cmp_gt_u32 vcc, 72, v0
  s_nop 1
  v_cndmask_b32 v6, v5, v6, vcc
  v_cmp_eq_u32 vcc, 0, v4
  s_nop 1
  v_cndmask_b32 v7, v5, v6, vcc
  v_cndmask_b32 v8, v6, v5, vcc
  s_mov_b32 s64, s70
  s_mov_b32 s65, s71
  s_mov_b32 s66, 8388608
  s_mov_b32 s67, 0x20000
  buffer_load_dword v244, v7, s[64:67], s48 offen
  s_mov_b32 s64, s72
  s_mov_b32 s65, s73
  s_mov_b32 s66, 8388608
  s_mov_b32 s67, 0x20000
  buffer_load_dword v245, v8, s[64:67], s48 offen
  s_waitcnt lgkmcnt(9)
  v_mfma_f32_16x16x32_bf16 v[28:31], v[92:95], v[96:99], v[28:31]
  ds_read_b64_tr_b16 v[124:125], v15 offset:40960
  s_waitcnt lgkmcnt(9)
  v_mfma_f32_16x16x32_bf16 v[32:35], v[92:95], v[100:103], v[32:35]
  ds_read_b64_tr_b16 v[126:127], v15 offset:41984
  s_waitcnt lgkmcnt(8)
  v_mfma_f32_16x16x32_bf16 v[44:47], v[104:107], v[96:99], v[44:47]
  ds_read_b128 v[128:131], v22 offset:32768
  v_mfma_f32_16x16x32_bf16 v[48:51], v[104:107], v[100:103], v[48:51]
  ds_read_b128 v[132:135], v22 offset:34816
  s_waitcnt lgkmcnt(9)
  v_mfma_f32_16x16x32_bf16 v[36:39], v[92:95], v[108:111], v[36:39]
  ds_read_b64_tr_b16 v[136:137], v16 offset:40960
  s_waitcnt lgkmcnt(9)
  v_mfma_f32_16x16x32_bf16 v[40:43], v[92:95], v[112:115], v[40:43]
  ds_read_b64_tr_b16 v[138:139], v16 offset:41984
  v_mfma_f32_16x16x32_bf16 v[52:55], v[104:107], v[108:111], v[52:55]
  ds_read_b128 v[140:143], v22 offset:36864
  v_mfma_f32_16x16x32_bf16 v[56:59], v[104:107], v[112:115], v[56:59]
  ds_read_b128 v[144:147], v22 offset:38912
  s_waitcnt lgkmcnt(10)
  v_mfma_f32_16x16x32_bf16 v[60:63], v[116:119], v[96:99], v[60:63]
  ds_read_b64_tr_b16 v[148:149], v17 offset:40960
  v_mfma_f32_16x16x32_bf16 v[64:67], v[116:119], v[100:103], v[64:67]
  ds_read_b64_tr_b16 v[150:151], v17 offset:41984
  s_waitcnt lgkmcnt(10)
  v_mfma_f32_16x16x32_bf16 v[76:79], v[120:123], v[96:99], v[76:79]
  ds_read_b64_tr_b16 v[152:153], v18 offset:40960
  v_mfma_f32_16x16x32_bf16 v[80:83], v[120:123], v[100:103], v[80:83]
  ds_read_b64_tr_b16 v[154:155], v18 offset:41984
  v_mfma_f32_16x16x32_bf16 v[68:71], v[116:119], v[108:111], v[68:71]
  v_mfma_f32_16x16x32_bf16 v[72:75], v[116:119], v[112:115], v[72:75]
  v_mfma_f32_16x16x32_bf16 v[84:87], v[120:123], v[108:111], v[84:87]
  v_mfma_f32_16x16x32_bf16 v[88:91], v[120:123], v[112:115], v[88:91]
  s_waitcnt lgkmcnt(9)
  v_mfma_f32_16x16x32_bf16 v[28:31], v[124:127], v[128:131], v[28:31]
  s_waitcnt lgkmcnt(8)
  v_mfma_f32_16x16x32_bf16 v[32:35], v[124:127], v[132:135], v[32:35]
  s_waitcnt lgkmcnt(0)
  s_barrier
  ds_read_b64_tr_b16 v[92:93], v11 offset:0
  v_mfma_f32_16x16x32_bf16 v[44:47], v[136:139], v[128:131], v[44:47]
  ds_read_b64_tr_b16 v[94:95], v11 offset:1024
  v_mfma_f32_16x16x32_bf16 v[48:51], v[136:139], v[132:135], v[48:51]
  ds_read_b128 v[96:99], v19 offset:0
  v_mfma_f32_16x16x32_bf16 v[36:39], v[124:127], v[140:143], v[36:39]
  ds_read_b128 v[100:103], v19 offset:2048
  v_mfma_f32_16x16x32_bf16 v[40:43], v[124:127], v[144:147], v[40:43]
  ds_read_b64_tr_b16 v[104:105], v12 offset:0
  v_mfma_f32_16x16x32_bf16 v[52:55], v[136:139], v[140:143], v[52:55]
  ds_read_b64_tr_b16 v[106:107], v12 offset:1024
  v_mfma_f32_16x16x32_bf16 v[56:59], v[136:139], v[144:147], v[56:59]
  ds_read_b128 v[108:111], v19 offset:4096
  v_mfma_f32_16x16x32_bf16 v[60:63], v[148:151], v[128:131], v[60:63]
  ds_read_b128 v[112:115], v19 offset:6144
  v_mfma_f32_16x16x32_bf16 v[64:67], v[148:151], v[132:135], v[64:67]
  ds_read_b64_tr_b16 v[116:117], v13 offset:0
  v_mfma_f32_16x16x32_bf16 v[76:79], v[152:155], v[128:131], v[76:79]
  ds_read_b64_tr_b16 v[118:119], v13 offset:1024
  v_mfma_f32_16x16x32_bf16 v[80:83], v[152:155], v[132:135], v[80:83]
  ds_read_b64_tr_b16 v[120:121], v14 offset:0
  v_mfma_f32_16x16x32_bf16 v[68:71], v[148:151], v[140:143], v[68:71]
  ds_read_b64_tr_b16 v[122:123], v14 offset:1024
  v_mfma_f32_16x16x32_bf16 v[72:75], v[148:151], v[144:147], v[72:75]
  v_mfma_f32_16x16x32_bf16 v[84:87], v[152:155], v[140:143], v[84:87]
  v_mfma_f32_16x16x32_bf16 v[88:91], v[152:155], v[144:147], v[88:91]
  s_waitcnt lgkmcnt(9)
  v_mfma_f32_16x16x32_bf16 v[28:31], v[92:95], v[96:99], v[28:31]
  ds_read_b64_tr_b16 v[124:125], v11 offset:8192
  s_waitcnt lgkmcnt(9)
  v_mfma_f32_16x16x32_bf16 v[32:35], v[92:95], v[100:103], v[32:35]
  ds_read_b64_tr_b16 v[126:127], v11 offset:9216
  s_waitcnt lgkmcnt(8)
  v_mfma_f32_16x16x32_bf16 v[44:47], v[104:107], v[96:99], v[44:47]
  ds_read_b128 v[128:131], v20 offset:0
  v_mfma_f32_16x16x32_bf16 v[48:51], v[104:107], v[100:103], v[48:51]
  ds_read_b128 v[132:135], v20 offset:2048
  s_waitcnt lgkmcnt(9)
  v_mfma_f32_16x16x32_bf16 v[36:39], v[92:95], v[108:111], v[36:39]
  ds_read_b64_tr_b16 v[136:137], v12 offset:8192
  s_waitcnt lgkmcnt(9)
  v_mfma_f32_16x16x32_bf16 v[40:43], v[92:95], v[112:115], v[40:43]
  ds_read_b64_tr_b16 v[138:139], v12 offset:9216
  v_mfma_f32_16x16x32_bf16 v[52:55], v[104:107], v[108:111], v[52:55]
  ds_read_b128 v[140:143], v20 offset:4096
  v_mfma_f32_16x16x32_bf16 v[56:59], v[104:107], v[112:115], v[56:59]
  ds_read_b128 v[144:147], v20 offset:6144
  s_waitcnt lgkmcnt(10)
  v_mfma_f32_16x16x32_bf16 v[60:63], v[116:119], v[96:99], v[60:63]
  ds_read_b64_tr_b16 v[148:149], v13 offset:8192
  v_mfma_f32_16x16x32_bf16 v[64:67], v[116:119], v[100:103], v[64:67]
  ds_read_b64_tr_b16 v[150:151], v13 offset:9216
  s_waitcnt lgkmcnt(10)
  v_mfma_f32_16x16x32_bf16 v[76:79], v[120:123], v[96:99], v[76:79]
  ds_read_b64_tr_b16 v[152:153], v14 offset:8192
  v_mfma_f32_16x16x32_bf16 v[80:83], v[120:123], v[100:103], v[80:83]
  ds_read_b64_tr_b16 v[154:155], v14 offset:9216
  v_mfma_f32_16x16x32_bf16 v[68:71], v[116:119], v[108:111], v[68:71]
  v_mfma_f32_16x16x32_bf16 v[72:75], v[116:119], v[112:115], v[72:75]
  v_mfma_f32_16x16x32_bf16 v[84:87], v[120:123], v[108:111], v[84:87]
  v_mfma_f32_16x16x32_bf16 v[88:91], v[120:123], v[112:115], v[88:91]
  s_waitcnt lgkmcnt(9)
  v_mfma_f32_16x16x32_bf16 v[28:31], v[124:127], v[128:131], v[28:31]
  s_waitcnt lgkmcnt(8)
  v_mfma_f32_16x16x32_bf16 v[32:35], v[124:127], v[132:135], v[32:35]
  s_waitcnt lgkmcnt(0)
  s_barrier
  ds_read_b64_tr_b16 v[92:93], v11 offset:32768
  v_mfma_f32_16x16x32_bf16 v[44:47], v[136:139], v[128:131], v[44:47]
  ds_read_b64_tr_b16 v[94:95], v11 offset:33792
  v_mfma_f32_16x16x32_bf16 v[48:51], v[136:139], v[132:135], v[48:51]
  ds_read_b128 v[96:99], v19 offset:32768
  v_mfma_f32_16x16x32_bf16 v[36:39], v[124:127], v[140:143], v[36:39]
  ds_read_b128 v[100:103], v19 offset:34816
  v_mfma_f32_16x16x32_bf16 v[40:43], v[124:127], v[144:147], v[40:43]
  ds_read_b64_tr_b16 v[104:105], v12 offset:32768
  v_mfma_f32_16x16x32_bf16 v[52:55], v[136:139], v[140:143], v[52:55]
  ds_read_b64_tr_b16 v[106:107], v12 offset:33792
  v_mfma_f32_16x16x32_bf16 v[56:59], v[136:139], v[144:147], v[56:59]
  ds_read_b128 v[108:111], v19 offset:36864
  v_mfma_f32_16x16x32_bf16 v[60:63], v[148:151], v[128:131], v[60:63]
  ds_read_b128 v[112:115], v19 offset:38912
  v_mfma_f32_16x16x32_bf16 v[64:67], v[148:151], v[132:135], v[64:67]
  ds_read_b64_tr_b16 v[116:117], v13 offset:32768
  v_mfma_f32_16x16x32_bf16 v[76:79], v[152:155], v[128:131], v[76:79]
  ds_read_b64_tr_b16 v[118:119], v13 offset:33792
  v_mfma_f32_16x16x32_bf16 v[80:83], v[152:155], v[132:135], v[80:83]
  ds_read_b64_tr_b16 v[120:121], v14 offset:32768
  v_mfma_f32_16x16x32_bf16 v[68:71], v[148:151], v[140:143], v[68:71]
  ds_read_b64_tr_b16 v[122:123], v14 offset:33792
  v_mfma_f32_16x16x32_bf16 v[72:75], v[148:151], v[144:147], v[72:75]
  v_mfma_f32_16x16x32_bf16 v[84:87], v[152:155], v[140:143], v[84:87]
  v_mfma_f32_16x16x32_bf16 v[88:91], v[152:155], v[144:147], v[88:91]
  s_waitcnt lgkmcnt(9)
  v_mfma_f32_16x16x32_bf16 v[28:31], v[92:95], v[96:99], v[28:31]
  ds_read_b64_tr_b16 v[124:125], v11 offset:40960
  s_waitcnt lgkmcnt(9)
  v_mfma_f32_16x16x32_bf16 v[32:35], v[92:95], v[100:103], v[32:35]
  ds_read_b64_tr_b16 v[126:127], v11 offset:41984
  s_waitcnt lgkmcnt(8)
  v_mfma_f32_16x16x32_bf16 v[44:47], v[104:107], v[96:99], v[44:47]
  ds_read_b128 v[128:131], v20 offset:32768
  v_mfma_f32_16x16x32_bf16 v[48:51], v[104:107], v[100:103], v[48:51]
  ds_read_b128 v[132:135], v20 offset:34816
  s_waitcnt lgkmcnt(9)
  v_mfma_f32_16x16x32_bf16 v[36:39], v[92:95], v[108:111], v[36:39]
  ds_read_b64_tr_b16 v[136:137], v12 offset:40960
  s_waitcnt lgkmcnt(9)
  v_mfma_f32_16x16x32_bf16 v[40:43], v[92:95], v[112:115], v[40:43]
  ds_read_b64_tr_b16 v[138:139], v12 offset:41984
  v_mfma_f32_16x16x32_bf16 v[52:55], v[104:107], v[108:111], v[52:55]
  ds_read_b128 v[140:143], v20 offset:36864
  v_mfma_f32_16x16x32_bf16 v[56:59], v[104:107], v[112:115], v[56:59]
  ds_read_b128 v[144:147], v20 offset:38912
  s_waitcnt lgkmcnt(10)
  v_mfma_f32_16x16x32_bf16 v[60:63], v[116:119], v[96:99], v[60:63]
  ds_read_b64_tr_b16 v[148:149], v13 offset:40960
  v_mfma_f32_16x16x32_bf16 v[64:67], v[116:119], v[100:103], v[64:67]
  ds_read_b64_tr_b16 v[150:151], v13 offset:41984
  s_waitcnt lgkmcnt(10)
  v_mfma_f32_16x16x32_bf16 v[76:79], v[120:123], v[96:99], v[76:79]
  ds_read_b64_tr_b16 v[152:153], v14 offset:40960
  v_mfma_f32_16x16x32_bf16 v[80:83], v[120:123], v[100:103], v[80:83]
  ds_read_b64_tr_b16 v[154:155], v14 offset:41984
  v_mfma_f32_16x16x32_bf16 v[68:71], v[116:119], v[108:111], v[68:71]
  v_mfma_f32_16x16x32_bf16 v[72:75], v[116:119], v[112:115], v[72:75]
  v_mfma_f32_16x16x32_bf16 v[84:87], v[120:123], v[108:111], v[84:87]
  v_mfma_f32_16x16x32_bf16 v[88:91], v[120:123], v[112:115], v[88:91]
  s_waitcnt lgkmcnt(9)
  v_mfma_f32_16x16x32_bf16 v[28:31], v[124:127], v[128:131], v[28:31]
  s_waitcnt lgkmcnt(8)
  v_mfma_f32_16x16x32_bf16 v[32:35], v[124:127], v[132:135], v[32:35]
  s_waitcnt lgkmcnt(6)
  v_mfma_f32_16x16x32_bf16 v[44:47], v[136:139], v[128:131], v[44:47]
  v_mfma_f32_16x16x32_bf16 v[48:51], v[136:139], v[132:135], v[48:51]
  s_waitcnt lgkmcnt(5)
  v_mfma_f32_16x16x32_bf16 v[36:39], v[124:127], v[140:143], v[36:39]
  s_waitcnt lgkmcnt(4)
  v_mfma_f32_16x16x32_bf16 v[40:43], v[124:127], v[144:147], v[40:43]
  v_mfma_f32_16x16x32_bf16 v[52:55], v[136:139], v[140:143], v[52:55]
  v_mfma_f32_16x16x32_bf16 v[56:59], v[136:139], v[144:147], v[56:59]
  s_waitcnt lgkmcnt(2)
  v_mfma_f32_16x16x32_bf16 v[60:63], v[148:151], v[128:131], v[60:63]
  v_mfma_f32_16x16x32_bf16 v[64:67], v[148:151], v[132:135], v[64:67]
  s_waitcnt lgkmcnt(0)
  v_mfma_f32_16x16x32_bf16 v[76:79], v[152:155], v[128:131], v[76:79]
  v_mfma_f32_16x16x32_bf16 v[80:83], v[152:155], v[132:135], v[80:83]
  v_mfma_f32_16x16x32_bf16 v[68:71], v[148:151], v[140:143], v[68:71]
  v_mfma_f32_16x16x32_bf16 v[72:75], v[148:151], v[144:147], v[72:75]
  v_mfma_f32_16x16x32_bf16 v[84:87], v[152:155], v[140:143], v[84:87]
  v_mfma_f32_16x16x32_bf16 v[88:91], v[152:155], v[144:147], v[88:91]
  s_nop 4
  v_pk_mul_f32 v[156:157], v[28:29], v[28:29]
  v_pk_mul_f32 v[158:159], v[30:31], v[30:31]
  v_pk_mul_f32 v[160:161], v[32:33], v[32:33]
  v_pk_mul_f32 v[162:163], v[34:35], v[34:35]
  v_pk_mul_f32 v[164:165], v[36:37], v[36:37]
  v_pk_mul_f32 v[166:167], v[38:39], v[38:39]
  v_pk_mul_f32 v[168:169], v[40:41], v[40:41]
  v_pk_mul_f32 v[170:171], v[42:43], v[42:43]
  v_pk_fma_f32 v[156:157], v[156:157], s[36:37], v[24:25]
  v_pk_fma_f32 v[158:159], v[158:159], s[36:37], v[24:25]
  v_pk_fma_f32 v[160:161], v[160:161], s[36:37], v[24:25]
  v_pk_fma_f32 v[162:163], v[162:163], s[36:37], v[24:25]
  v_pk_fma_f32 v[164:165], v[164:165], s[36:37], v[24:25]
  v_pk_fma_f32 v[166:167], v[166:167], s[36:37], v[24:25]
  v_pk_fma_f32 v[168:169], v[168:169], s[36:37], v[24:25]
  v_pk_fma_f32 v[170:171], v[170:171], s[36:37], v[24:25]
  v_pk_mul_f32 v[156:157], v[28:29], v[156:157]
  v_pk_mul_f32 v[158:159], v[30:31], v[158:159]
  v_pk_mul_f32 v[160:161], v[32:33], v[160:161]
  v_pk_mul_f32 v[162:163], v[34:35], v[162:163]
  v_pk_mul_f32 v[164:165], v[36:37], v[164:165]
  v_pk_mul_f32 v[166:167], v[38:39], v[166:167]
  v_pk_mul_f32 v[168:169], v[40:41], v[168:169]
  v_pk_mul_f32 v[170:171], v[42:43], v[170:171]
  v_exp_f32 v156, v156
  v_exp_f32 v157, v157
  v_exp_f32 v158, v158
  v_exp_f32 v159, v159
  v_exp_f32 v160, v160
  v_exp_f32 v161, v161
  v_exp_f32 v162, v162
  v_exp_f32 v163, v163
  v_exp_f32 v164, v164
  v_exp_f32 v165, v165
  v_exp_f32 v166, v166
  v_exp_f32 v167, v167
  v_exp_f32 v168, v168
  v_exp_f32 v169, v169
  v_exp_f32 v170, v170
  v_exp_f32 v171, v171
  v_pk_add_f32 v[156:157], v[156:157], s[38:39]
  v_pk_add_f32 v[158:159], v[158:159], s[38:39]
  v_pk_add_f32 v[160:161], v[160:161], s[38:39]
  v_pk_add_f32 v[162:163], v[162:163], s[38:39]
  v_pk_add_f32 v[164:165], v[164:165], s[38:39]
  v_pk_add_f32 v[166:167], v[166:167], s[38:39]
  v_pk_add_f32 v[168:169], v[168:169], s[38:39]
  v_pk_add_f32 v[170:171], v[170:171], s[38:39]
  v_rcp_f32 v156, v156
  v_rcp_f32 v157, v157
  v_rcp_f32 v158, v158
  v_rcp_f32 v159, v159
  v_rcp_f32 v160, v160
  v_rcp_f32 v161, v161
  v_rcp_f32 v162, v162
  v_rcp_f32 v163, v163
  v_rcp_f32 v164, v164
  v_rcp_f32 v165, v165
  v_rcp_f32 v166, v166
  v_rcp_f32 v167, v167
  v_rcp_f32 v168, v168
  v_rcp_f32 v169, v169
  v_rcp_f32 v170, v170
  v_rcp_f32 v171, v171
  v_pk_mul_f32 v[28:29], v[28:29], v[156:157]
  v_pk_mul_f32 v[30:31], v[30:31], v[158:159]
  v_pk_mul_f32 v[32:33], v[32:33], v[160:161]
  v_pk_mul_f32 v[34:35], v[34:35], v[162:163]
  v_pk_mul_f32 v[36:37], v[36:37], v[164:165]
  v_pk_mul_f32 v[38:39], v[38:39], v[166:167]
  v_pk_mul_f32 v[40:41], v[40:41], v[168:169]
  v_pk_mul_f32 v[42:43], v[42:43], v[170:171]
  v_pk_mul_f32 v[156:157], v[44:45], v[44:45]
  v_pk_mul_f32 v[158:159], v[46:47], v[46:47]
  v_pk_mul_f32 v[160:161], v[48:49], v[48:49]
  v_pk_mul_f32 v[162:163], v[50:51], v[50:51]
  v_pk_mul_f32 v[164:165], v[52:53], v[52:53]
  v_pk_mul_f32 v[166:167], v[54:55], v[54:55]
  v_pk_mul_f32 v[168:169], v[56:57], v[56:57]
  v_pk_mul_f32 v[170:171], v[58:59], v[58:59]
  v_pk_fma_f32 v[156:157], v[156:157], s[36:37], v[24:25]
  v_pk_fma_f32 v[158:159], v[158:159], s[36:37], v[24:25]
  v_pk_fma_f32 v[160:161], v[160:161], s[36:37], v[24:25]
  v_pk_fma_f32 v[162:163], v[162:163], s[36:37], v[24:25]
  v_pk_fma_f32 v[164:165], v[164:165], s[36:37], v[24:25]
  v_pk_fma_f32 v[166:167], v[166:167], s[36:37], v[24:25]
  v_pk_fma_f32 v[168:169], v[168:169], s[36:37], v[24:25]
  v_pk_fma_f32 v[170:171], v[170:171], s[36:37], v[24:25]
  v_pk_mul_f32 v[156:157], v[44:45], v[156:157]
  v_pk_mul_f32 v[158:159], v[46:47], v[158:159]
  v_pk_mul_f32 v[160:161], v[48:49], v[160:161]
  v_pk_mul_f32 v[162:163], v[50:51], v[162:163]
  v_pk_mul_f32 v[164:165], v[52:53], v[164:165]
  v_pk_mul_f32 v[166:167], v[54:55], v[166:167]
  v_pk_mul_f32 v[168:169], v[56:57], v[168:169]
  v_pk_mul_f32 v[170:171], v[58:59], v[170:171]
  v_exp_f32 v156, v156
  v_exp_f32 v157, v157
  v_exp_f32 v158, v158
  v_exp_f32 v159, v159
  v_exp_f32 v160, v160
  v_exp_f32 v161, v161
  v_exp_f32 v162, v162
  v_exp_f32 v163, v163
  v_exp_f32 v164, v164
  v_exp_f32 v165, v165
  v_exp_f32 v166, v166
  v_exp_f32 v167, v167
  v_exp_f32 v168, v168
  v_exp_f32 v169, v169
  v_exp_f32 v170, v170
  v_exp_f32 v171, v171
  v_pk_add_f32 v[156:157], v[156:157], s[38:39]
  v_pk_add_f32 v[158:159], v[158:159], s[38:39]
  v_pk_add_f32 v[160:161], v[160:161], s[38:39]
  v_pk_add_f32 v[162:163], v[162:163], s[38:39]
  v_pk_add_f32 v[164:165], v[164:165], s[38:39]
  v_pk_add_f32 v[166:167], v[166:167], s[38:39]
  v_pk_add_f32 v[168:169], v[168:169], s[38:39]
  v_pk_add_f32 v[170:171], v[170:171], s[38:39]
  v_rcp_f32 v156, v156
  v_rcp_f32 v157, v157
  v_rcp_f32 v158, v158
  v_rcp_f32 v159, v159
  v_rcp_f32 v160, v160
  v_rcp_f32 v161, v161
  v_rcp_f32 v162, v162
  v_rcp_f32 v163, v163
  v_rcp_f32 v164, v164
  v_rcp_f32 v165, v165
  v_rcp_f32 v166, v166
  v_rcp_f32 v167, v167
  v_rcp_f32 v168, v168
  v_rcp_f32 v169, v169
  v_rcp_f32 v170, v170
  v_rcp_f32 v171, v171
  v_pk_mul_f32 v[44:45], v[44:45], v[156:157]
  v_pk_mul_f32 v[46:47], v[46:47], v[158:159]
  v_pk_mul_f32 v[48:49], v[48:49], v[160:161]
  v_pk_mul_f32 v[50:51], v[50:51], v[162:163]
  v_pk_mul_f32 v[52:53], v[52:53], v[164:165]
  v_pk_mul_f32 v[54:55], v[54:55], v[166:167]
  v_pk_mul_f32 v[56:57], v[56:57], v[168:169]
  v_pk_mul_f32 v[58:59], v[58:59], v[170:171]
  v_pk_add_f32 v[172:173], v[28:29], v[30:31]
  v_pk_mul_f32 v[180:181], v[28:29], v[28:29]
  v_pk_add_f32 v[174:175], v[32:33], v[34:35]
  v_pk_mul_f32 v[182:183], v[32:33], v[32:33]
  v_pk_add_f32 v[176:177], v[36:37], v[38:39]
  v_pk_mul_f32 v[184:185], v[36:37], v[36:37]
  v_pk_add_f32 v[178:179], v[40:41], v[42:43]
  v_pk_mul_f32 v[186:187], v[40:41], v[40:41]
  v_pk_add_f32 v[172:173], v[172:173], v[44:45]
  v_pk_fma_f32 v[180:181], v[30:31], v[30:31], v[180:181]
  v_pk_add_f32 v[174:175], v[174:175], v[48:49]
  v_pk_fma_f32 v[182:183], v[34:35], v[34:35], v[182:183]
  v_pk_add_f32 v[176:177], v[176:177], v[52:53]
  v_pk_fma_f32 v[184:185], v[38:39], v[38:39], v[184:185]
  v_pk_add_f32 v[178:179], v[178:179], v[56:57]
  v_pk_fma_f32 v[186:187], v[42:43], v[42:43], v[186:187]
  v_pk_add_f32 v[172:173], v[172:173], v[46:47]
  v_pk_fma_f32 v[180:181], v[44:45], v[44:45], v[180:181]
  v_pk_add_f32 v[174:175], v[174:175], v[50:51]
  v_pk_fma_f32 v[182:183], v[48:49], v[48:49], v[182:183]
  v_pk_add_f32 v[176:177], v[176:177], v[54:55]
  v_pk_fma_f32 v[184:185], v[52:53], v[52:53], v[184:185]
  v_pk_add_f32 v[178:179], v[178:179], v[58:59]
  v_pk_fma_f32 v[186:187], v[56:57], v[56:57], v[186:187]
  v_pk_fma_f32 v[180:181], v[46:47], v[46:47], v[180:181]
  v_add_f32 v172, v172, v173
  v_pk_fma_f32 v[182:183], v[50:51], v[50:51], v[182:183]
  v_add_f32 v174, v174, v175
  v_pk_fma_f32 v[184:185], v[54:55], v[54:55], v[184:185]
  v_add_f32 v176, v176, v177
  v_pk_fma_f32 v[186:187], v[58:59], v[58:59], v[186:187]
  v_add_f32 v178, v178, v179
  v_add_f32 v180, v180, v181
  v_add_f32 v182, v182, v183
  v_add_f32 v184, v184, v185
  v_add_f32 v186, v186, v187
  s_nop 1
  v_permlane16_swap_b32 v172, v174
  v_permlane16_swap_b32 v176, v178
  v_permlane16_swap_b32 v180, v182
  v_permlane16_swap_b32 v184, v186
  s_nop 0
  v_add_f32 v172, v172, v174
  v_add_f32 v176, v176, v178
  v_add_f32 v180, v180, v182
  v_add_f32 v184, v184, v186
  s_nop 1
  v_permlane32_swap_b32 v172, v176
  v_permlane32_swap_b32 v180, v184
  s_nop 0
  v_add_f32 v156, v172, v176
  v_add_f32 v157, v180, v184
  v_add_u32 v3, v1, v10
  v_lshlrev_b32 v3, 3, v3
  v_lshrrev_b32 v4, 1, v2
  v_lshl_add_u32 v4, v4, 10, v3
  v_add_u32 v4, 131072, v4
  ds_write_b64 v4, v[156:157]
  v_lshlrev_b32 v5, 3, v0
  v_add_u32 v6, 131072, v5
  s_waitcnt lgkmcnt(0)
  s_barrier
  ds_read_b64 v[156:157], v6
  ds_read_b64 v[158:159], v6 offset:1024
  s_mul_i32 s44, s17, 14
  s_add_u32 s44, s44, s18
  s_lshl_b32 s44, s44, 10
  s_waitcnt lgkmcnt(0)
  v_pk_add_f32 v[156:157], v[156:157], v[158:159]
  v_cmp_gt_u32 vcc, 128, v0
  s_and_saveexec_b64 s[46:47], vcc
  s_cbranch_execz nopub_2
  buffer_store_dwordx2 v[156:157], v5, s[24:27], s44 offen sc1
nopub_2:
  s_mov_b64 exec, s[46:47]
  v_pk_mul_f32 v[156:157], v[60:61], v[60:61]
  v_pk_mul_f32 v[158:159], v[62:63], v[62:63]
  v_pk_mul_f32 v[160:161], v[64:65], v[64:65]
  v_pk_mul_f32 v[162:163], v[66:67], v[66:67]
  v_pk_mul_f32 v[164:165], v[68:69], v[68:69]
  v_pk_mul_f32 v[166:167], v[70:71], v[70:71]
  v_pk_mul_f32 v[168:169], v[72:73], v[72:73]
  v_pk_mul_f32 v[170:171], v[74:75], v[74:75]
  v_pk_fma_f32 v[156:157], v[156:157], s[36:37], v[24:25]
  v_pk_fma_f32 v[158:159], v[158:159], s[36:37], v[24:25]
  v_pk_fma_f32 v[160:161], v[160:161], s[36:37], v[24:25]
  v_pk_fma_f32 v[162:163], v[162:163], s[36:37], v[24:25]
  v_pk_fma_f32 v[164:165], v[164:165], s[36:37], v[24:25]
  v_pk_fma_f32 v[166:167], v[166:167], s[36:37], v[24:25]
  v_pk_fma_f32 v[168:169], v[168:169], s[36:37], v[24:25]
  v_pk_fma_f32 v[170:171], v[170:171], s[36:37], v[24:25]
  v_pk_mul_f32 v[156:157], v[60:61], v[156:157]
  v_pk_mul_f32 v[158:159], v[62:63], v[158:159]
  v_pk_mul_f32 v[160:161], v[64:65], v[160:161]
  v_pk_mul_f32 v[162:163], v[66:67], v[162:163]
  v_pk_mul_f32 v[164:165], v[68:69], v[164:165]
  v_pk_mul_f32 v[166:167], v[70:71], v[166:167]
  v_pk_mul_f32 v[168:169], v[72:73], v[168:169]
  v_pk_mul_f32 v[170:171], v[74:75], v[170:171]
  v_exp_f32 v156, v156
  v_exp_f32 v157, v157
  v_exp_f32 v158, v158
  v_exp_f32 v159, v159
  v_exp_f32 v160, v160
  v_exp_f32 v161, v161
  v_exp_f32 v162, v162
  v_exp_f32 v163, v163
  v_exp_f32 v164, v164
  v_exp_f32 v165, v165
  v_exp_f32 v166, v166
  v_exp_f32 v167, v167
  v_exp_f32 v168, v168
  v_exp_f32 v169, v169
  v_exp_f32 v170, v170
  v_exp_f32 v171, v171
  v_pk_add_f32 v[156:157], v[156:157], s[38:39]
  v_pk_add_f32 v[158:159], v[158:159], s[38:39]
  v_pk_add_f32 v[160:161], v[160:161], s[38:39]
  v_pk_add_f32 v[162:163], v[162:163], s[38:39]
  v_pk_add_f32 v[164:165], v[164:165], s[38:39]
  v_pk_add_f32 v[166:167], v[166:167], s[38:39]
  v_pk_add_f32 v[168:169], v[168:169], s[38:39]
  v_pk_add_f32 v[170:171], v[170:171], s[38:39]
  v_rcp_f32 v156, v156
  v_rcp_f32 v157, v157
  v_rcp_f32 v158, v158
  v_rcp_f32 v159, v159
  v_rcp_f32 v160, v160
  v_rcp_f32 v161, v161
  v_rcp_f32 v162, v162
  v_rcp_f32 v163, v163
  v_rcp_f32 v164, v164
  v_rcp_f32 v165, v165
  v_rcp_f32 v166, v166
  v_rcp_f32 v167, v167
  v_rcp_f32 v168, v168
  v_rcp_f32 v169, v169
  v_rcp_f32 v170, v170
  v_rcp_f32 v171, v171
  v_pk_mul_f32 v[60:61], v[60:61], v[156:157]
  v_pk_mul_f32 v[62:63], v[62:63], v[158:159]
  v_pk_mul_f32 v[64:65], v[64:65], v[160:161]
  v_pk_mul_f32 v[66:67], v[66:67], v[162:163]
  v_pk_mul_f32 v[68:69], v[68:69], v[164:165]
  v_pk_mul_f32 v[70:71], v[70:71], v[166:167]
  v_pk_mul_f32 v[72:73], v[72:73], v[168:169]
  v_pk_mul_f32 v[74:75], v[74:75], v[170:171]
  v_pk_mul_f32 v[156:157], v[76:77], v[76:77]
  v_pk_mul_f32 v[158:159], v[78:79], v[78:79]
  v_pk_mul_f32 v[160:161], v[80:81], v[80:81]
  v_pk_mul_f32 v[162:163], v[82:83], v[82:83]
  v_pk_mul_f32 v[164:165], v[84:85], v[84:85]
  v_pk_mul_f32 v[166:167], v[86:87], v[86:87]
  v_pk_mul_f32 v[168:169], v[88:89], v[88:89]
  v_pk_mul_f32 v[170:171], v[90:91], v[90:91]
  v_pk_fma_f32 v[156:157], v[156:157], s[36:37], v[24:25]
  v_pk_fma_f32 v[158:159], v[158:159], s[36:37], v[24:25]
  v_pk_fma_f32 v[160:161], v[160:161], s[36:37], v[24:25]
  v_pk_fma_f32 v[162:163], v[162:163], s[36:37], v[24:25]
  v_pk_fma_f32 v[164:165], v[164:165], s[36:37], v[24:25]
  v_pk_fma_f32 v[166:167], v[166:167], s[36:37], v[24:25]
  v_pk_fma_f32 v[168:169], v[168:169], s[36:37], v[24:25]
  v_pk_fma_f32 v[170:171], v[170:171], s[36:37], v[24:25]
  v_pk_mul_f32 v[156:157], v[76:77], v[156:157]
  v_pk_mul_f32 v[158:159], v[78:79], v[158:159]
  v_pk_mul_f32 v[160:161], v[80:81], v[160:161]
  v_pk_mul_f32 v[162:163], v[82:83], v[162:163]
  v_pk_mul_f32 v[164:165], v[84:85], v[164:165]
  v_pk_mul_f32 v[166:167], v[86:87], v[166:167]
  v_pk_mul_f32 v[168:169], v[88:89], v[168:169]
  v_pk_mul_f32 v[170:171], v[90:91], v[170:171]
  v_exp_f32 v156, v156
  v_exp_f32 v157, v157
  v_exp_f32 v158, v158
  v_exp_f32 v159, v159
  v_exp_f32 v160, v160
  v_exp_f32 v161, v161
  v_exp_f32 v162, v162
  v_exp_f32 v163, v163
  v_exp_f32 v164, v164
  v_exp_f32 v165, v165
  v_exp_f32 v166, v166
  v_exp_f32 v167, v167
  v_exp_f32 v168, v168
  v_exp_f32 v169, v169
  v_exp_f32 v170, v170
  v_exp_f32 v171, v171
  v_pk_add_f32 v[156:157], v[156:157], s[38:39]
  v_pk_add_f32 v[158:159], v[158:159], s[38:39]
  v_pk_add_f32 v[160:161], v[160:161], s[38:39]
  v_pk_add_f32 v[162:163], v[162:163], s[38:39]
  v_pk_add_f32 v[164:165], v[164:165], s[38:39]
  v_pk_add_f32 v[166:167], v[166:167], s[38:39]
  v_pk_add_f32 v[168:169], v[168:169], s[38:39]
  v_pk_add_f32 v[170:171], v[170:171], s[38:39]
  v_rcp_f32 v156, v156
  v_rcp_f32 v157, v157
  v_rcp_f32 v158, v158
  v_rcp_f32 v159, v159
  v_rcp_f32 v160, v160
  v_rcp_f32 v161, v161
  v_rcp_f32 v162, v162
  v_rcp_f32 v163, v163
  v_rcp_f32 v164, v164
  v_rcp_f32 v165, v165
  v_rcp_f32 v166, v166
  v_rcp_f32 v167, v167
  v_rcp_f32 v168, v168
  v_rcp_f32 v169, v169
  v_rcp_f32 v170, v170
  v_rcp_f32 v171, v171
  v_pk_mul_f32 v[76:77], v[76:77], v[156:157]
  v_pk_mul_f32 v[78:79], v[78:79], v[158:159]
  v_pk_mul_f32 v[80:81], v[80:81], v[160:161]
  v_pk_mul_f32 v[82:83], v[82:83], v[162:163]
  v_pk_mul_f32 v[84:85], v[84:85], v[164:165]
  v_pk_mul_f32 v[86:87], v[86:87], v[166:167]
  v_pk_mul_f32 v[88:89], v[88:89], v[168:169]
  v_pk_mul_f32 v[90:91], v[90:91], v[170:171]
  v_cvt_pk_bf16_f32 v188, v60, v61
  v_cvt_pk_bf16_f32 v189, v62, v63
  v_cvt_pk_bf16_f32 v190, v64, v65
  v_cvt_pk_bf16_f32 v191, v66, v67
  v_cvt_pk_bf16_f32 v192, v68, v69
  v_cvt_pk_bf16_f32 v193, v70, v71
  v_cvt_pk_bf16_f32 v194, v72, v73
  v_cvt_pk_bf16_f32 v195, v74, v75
  v_permlane16_swap_b32 v188, v190
  v_permlane16_swap_b32 v189, v191
  v_permlane16_swap_b32 v192, v194
  v_permlane16_swap_b32 v193, v195
  s_add_u32 s48, s45, 0
  buffer_store_dwordx4 v[188:191], v23, s[28:31], s48 offen offset:0 sc1
  buffer_store_dwordx4 v[192:195], v23, s[28:31], s48 offen offset:512 sc1
  s_nop 1
  v_cvt_pk_bf16_f32 v188, v76, v77
  v_cvt_pk_bf16_f32 v189, v78, v79
  v_cvt_pk_bf16_f32 v190, v80, v81
  v_cvt_pk_bf16_f32 v191, v82, v83
  v_cvt_pk_bf16_f32 v192, v84, v85
  v_cvt_pk_bf16_f32 v193, v86, v87
  v_cvt_pk_bf16_f32 v194, v88, v89
  v_cvt_pk_bf16_f32 v195, v90, v91
  v_permlane16_swap_b32 v188, v190
  v_permlane16_swap_b32 v189, v191
  v_permlane16_swap_b32 v192, v194
  v_permlane16_swap_b32 v193, v195
  s_add_u32 s48, s45, 69632
  buffer_store_dwordx4 v[188:191], v23, s[28:31], s48 offen offset:0 sc1
  buffer_store_dwordx4 v[192:195], v23, s[28:31], s48 offen offset:512 sc1
  s_nop 1
  v_and_b32 v3, 127, v0
  v_lshlrev_b32 v3, 3, v3
  v_lshrrev_b32 v4, 7, v0
  v_mul_u32_u24 v4, 7168, v4
  v_add_u32 v3, v3, v4
  s_mul_i32 s44, s17, 14336
  s_mov_b32 s49, 0
poll_3:
  buffer_load_dwordx2 v[156:157], v3, s[24:27], s44 offen offset:0 sc1
  buffer_load_dwordx2 v[158:159], v3, s[24:27], s44 offen offset:1024 sc1
  buffer_load_dwordx2 v[160:161], v3, s[24:27], s44 offen offset:2048 sc1
  buffer_load_dwordx2 v[162:163], v3, s[24:27], s44 offen offset:3072 sc1
  s_add_u32 s48, s44, 4096
  buffer_load_dwordx2 v[164:165], v3, s[24:27], s48 offen offset:0 sc1
  s_add_u32 s48, s44, 4096
  buffer_load_dwordx2 v[166:167], v3, s[24:27], s48 offen offset:1024 sc1
  s_add_u32 s48, s44, 4096
  buffer_load_dwordx2 v[168:169], v3, s[24:27], s48 offen offset:2048 sc1
  s_waitcnt vmcnt(0)
  v_cmp_ne_u32 vcc, -1, v156
  v_cmp_ne_u32 s[46:47], -1, v158
  s_and_b64 vcc, vcc, s[46:47]
  v_cmp_ne_u32 s[46:47], -1, v160
  s_and_b64 vcc, vcc, s[46:47]
  v_cmp_ne_u32 s[46:47], -1, v162
  s_and_b64 vcc, vcc, s[46:47]
  v_cmp_ne_u32 s[46:47], -1, v164
  s_and_b64 vcc, vcc, s[46:47]
  v_cmp_ne_u32 s[46:47], -1, v166
  s_and_b64 vcc, vcc, s[46:47]
  v_cmp_ne_u32 s[46:47], -1, v168
  s_and_b64 vcc, vcc, s[46:47]
  s_add_u32 s49, s49, 1
  s_cmp_eq_u64 vcc, exec
  s_cbranch_scc1 polldone_4
  s_cmp_lt_u32 s49, 20000
  s_cbranch_scc1 poll_3
polldone_4:
  v_pk_add_f32 v[156:157], v[156:157], v[158:159]
  v_pk_add_f32 v[156:157], v[156:157], v[160:161]
  v_pk_add_f32 v[156:157], v[156:157], v[162:163]
  v_pk_add_f32 v[156:157], v[156:157], v[164:165]
  v_pk_add_f32 v[156:157], v[156:157], v[166:167]
  v_pk_add_f32 v[156:157], v[156:157], v[168:169]
  v_lshlrev_b32 v4, 3, v0
  v_add_u32 v4, 131072, v4
  ds_write_b64 v4, v[156:157] offset:4096
  s_waitcnt lgkmcnt(0)
  s_barrier
  v_and_b32 v3, 15, v1
  v_add_u32 v3, v3, v10
  v_lshlrev_b32 v3, 3, v3
  v_add_u32 v3, 131072, v3
  ds_read_b64 v[156:157], v3 offset:4096
  ds_read_b64 v[158:159], v3 offset:5120
  ds_read_b64 v[160:161], v3 offset:4224
  ds_read_b64 v[162:163], v3 offset:5248
  ds_read_b64 v[164:165], v3 offset:4352
  ds_read_b64 v[166:167], v3 offset:5376
  ds_read_b64 v[168:169], v3 offset:4480
  ds_read_b64 v[170:171], v3 offset:5504
  s_waitcnt lgkmcnt(0)
  v_pk_add_f32 v[156:157], v[156:157], v[158:159]
  v_pk_add_f32 v[160:161], v[160:161], v[162:163]
  v_pk_add_f32 v[164:165], v[164:165], v[166:167]
  v_pk_add_f32 v[168:169], v[168:169], v[170:171]
  v_mul_f32 v156, 0x3a97b426, v156
  v_mul_f32 v157, 0x3a97b426, v157
  v_mul_f32 v160, 0x3a97b426, v160
  v_mul_f32 v161, 0x3a97b426, v161
  v_mul_f32 v164, 0x3a97b426, v164
  v_mul_f32 v165, 0x3a97b426, v165
  v_mul_f32 v168, 0x3a97b426, v168
  v_mul_f32 v169, 0x3a97b426, v169
  v_fma_f32 v157, -v156, v156, v157
  v_fma_f32 v161, -v160, v160, v161
  v_fma_f32 v165, -v164, v164, v165
  v_fma_f32 v169, -v168, v168, v169
  v_max_f32 v157, 0, v157
  v_max_f32 v161, 0, v161
  v_max_f32 v165, 0, v165
  v_max_f32 v169, 0, v169
  v_add_f32 v157, 0x3727c5ac, v157
  v_add_f32 v161, 0x3727c5ac, v161
  v_add_f32 v165, 0x3727c5ac, v165
  v_add_f32 v169, 0x3727c5ac, v169
  v_rsq_f32 v172, v157
  v_rsq_f32 v174, v161
  v_rsq_f32 v176, v165
  v_rsq_f32 v178, v169
  s_nop 0
  v_mov_b32 v173, v172
  v_mul_f32 v180, v156, v172
  v_sub_f32 v180, 0, v180
  v_mov_b32 v181, v180
  v_mov_b32 v175, v174
  v_mul_f32 v182, v160, v174
  v_sub_f32 v182, 0, v182
  v_mov_b32 v183, v182
  v_mov_b32 v177, v176
  v_mul_f32 v184, v164, v176
  v_sub_f32 v184, 0, v184
  v_mov_b32 v185, v184
  v_mov_b32 v179, v178
  v_mul_f32 v186, v168, v178
  v_sub_f32 v186, 0, v186
  v_mov_b32 v187, v186
  v_pk_fma_f32 v[28:29], v[28:29], v[172:173], v[180:181]
  v_pk_fma_f32 v[30:31], v[30:31], v[172:173], v[180:181]
  v_pk_fma_f32 v[32:33], v[32:33], v[174:175], v[182:183]
  v_pk_fma_f32 v[34:35], v[34:35], v[174:175], v[182:183]
  v_pk_fma_f32 v[36:37], v[36:37], v[176:177], v[184:185]
  v_pk_fma_f32 v[38:39], v[38:39], v[176:177], v[184:185]
  v_pk_fma_f32 v[40:41], v[40:41], v[178:179], v[186:187]
  v_pk_fma_f32 v[42:43], v[42:43], v[178:179], v[186:187]
  v_cvt_pk_bf16_f32 v188, v28, v29
  v_cvt_pk_bf16_f32 v189, v30, v31
  v_cvt_pk_bf16_f32 v190, v32, v33
  v_cvt_pk_bf16_f32 v191, v34, v35
  v_cvt_pk_bf16_f32 v192, v36, v37
  v_cvt_pk_bf16_f32 v193, v38, v39
  v_cvt_pk_bf16_f32 v194, v40, v41
  v_cvt_pk_bf16_f32 v195, v42, v43
  v_permlane16_swap_b32 v188, v190
  v_permlane16_swap_b32 v189, v191
  v_permlane16_swap_b32 v192, v194
  v_permlane16_swap_b32 v193, v195
  s_add_u32 s48, s51, 0
  buffer_store_dwordx4 v[188:191], v23, s[40:43], s48 offen offset:0 sc1
  buffer_store_dwordx4 v[192:195], v23, s[40:43], s48 offen offset:512 sc1
  s_nop 1
  v_pk_fma_f32 v[44:45], v[44:45], v[172:173], v[180:181]
  v_pk_fma_f32 v[46:47], v[46:47], v[172:173], v[180:181]
  v_pk_fma_f32 v[48:49], v[48:49], v[174:175], v[182:183]
  v_pk_fma_f32 v[50:51], v[50:51], v[174:175], v[182:183]
  v_pk_fma_f32 v[52:53], v[52:53], v[176:177], v[184:185]
  v_pk_fma_f32 v[54:55], v[54:55], v[176:177], v[184:185]
  v_pk_fma_f32 v[56:57], v[56:57], v[178:179], v[186:187]
  v_pk_fma_f32 v[58:59], v[58:59], v[178:179], v[186:187]
  v_cvt_pk_bf16_f32 v188, v44, v45
  v_cvt_pk_bf16_f32 v189, v46, v47
  v_cvt_pk_bf16_f32 v190, v48, v49
  v_cvt_pk_bf16_f32 v191, v50, v51
  v_cvt_pk_bf16_f32 v192, v52, v53
  v_cvt_pk_bf16_f32 v193, v54, v55
  v_cvt_pk_bf16_f32 v194, v56, v57
  v_cvt_pk_bf16_f32 v195, v58, v59
  v_permlane16_swap_b32 v188, v190
  v_permlane16_swap_b32 v189, v191
  v_permlane16_swap_b32 v192, v194
  v_permlane16_swap_b32 v193, v195
  s_add_u32 s48, s51, 69632
  buffer_store_dwordx4 v[188:191], v23, s[40:43], s48 offen offset:0 sc1
  buffer_store_dwordx4 v[192:195], v23, s[40:43], s48 offen offset:512 sc1
  s_nop 1
  s_add_u32 s64, s92, 33030144
  s_addc_u32 s65, s93, 0
  s_mov_b32 s66, 20480
  s_mov_b32 s67, 0x20000
  s_add_u32 s98, s94, 2
  v_mov_b32 v156, s98
  v_mov_b32 v157, 0x40000000
  v_cmp_gt_u32 vcc, 16, v0
  s_lshl_b32 s98, s2, 2
  v_mul_u32_u24 v158, 1280, v0
  v_cndmask_b32 v157, v157, v158, vcc
  v_readfirstlane_b32 s99, v0
  s_waitcnt vmcnt(0)
  s_barrier
  s_cmp_lg_u32 s99, 0
  s_cbranch_scc1 noflag_5
  buffer_store_dword v156, v157, s[64:67], s98 offen sc1
noflag_5:
  s_branch PH2
P1_std_ld:
  v_and_b32 v1, 63, v0
  v_bfe_u32 v2, v0, 6, 2
  s_nop 0
  v_readfirstlane_b32 s16, v2
  s_lshl_b32 s21, s20, 6
  s_lshl_b32 s23, s50, 6
  s_add_u32 s23, s23, 1728
  v_mul_u32_u24 v3, 256, v2
  v_add_u32 v3, v3, v1
  v_and_b32 v4, 15, v3
  v_lshrrev_b32 v3, 4, v3
  v_and_b32 v8, 3, v3
  v_lshlrev_b32 v8, 2, v8
  v_xor_b32 v4, v4, v8
  v_bfe_u32 v8, v3, 3, 1
  v_lshlrev_b32 v8, 1, v8
  v_xor_b32 v4, v4, v8
  v_mul_u32_u24 v9, 3456, v3
  v_lshrrev_b32 v6, 3, v4
  v_lshl_add_u32 v9, v6, 6, v9
  v_and_b32 v6, 3, v4
  v_lshl_add_u32 v9, v6, 4, v9
  v_bfe_u32 v6, v4, 2, 1
  v_cmp_eq_u32 vcc, 1, v6
  v_mov_b32 v6, s23
  v_mov_b32 v7, s21
  v_cndmask_b32 v6, v6, v7, vcc
  v_add_u32 v9, v9, v6
  v_mul_u32_u24 v3, 256, v2
  v_add_u32 v3, v3, v1
  v_add_u32 v3, 64, v3
  v_and_b32 v4, 15, v3
  v_lshrrev_b32 v3, 4, v3
  v_and_b32 v8, 3, v3
  v_lshlrev_b32 v8, 2, v8
  v_xor_b32 v4, v4, v8
  v_bfe_u32 v8, v3, 3, 1
  v_lshlrev_b32 v8, 1, v8
  v_xor_b32 v4, v4, v8
  v_mul_u32_u24 v10, 3456, v3
  v_lshrrev_b32 v6, 3, v4
  v_lshl_add_u32 v10, v6, 6, v10
  v_and_b32 v6, 3, v4
  v_lshl_add_u32 v10, v6, 4, v10
  v_bfe_u32 v6, v4, 2, 1
  v_cmp_eq_u32 vcc, 1, v6
  v_mov_b32 v6, s23
  v_mov_b32 v7, s21
  v_cndmask_b32 v6, v6, v7, vcc
  v_add_u32 v10, v10, v6
  v_mul_u32_u24 v3, 256, v2
  v_add_u32 v3, v3, v1
  v_add_u32 v3, 128, v3
  v_and_b32 v4, 15, v3
  v_lshrrev_b32 v3, 4, v3
  v_and_b32 v8, 3, v3
  v_lshlrev_b32 v8, 2, v8
  v_xor_b32 v4, v4, v8
  v_bfe_u32 v8, v3, 3, 1
  v_lshlrev_b32 v8, 1, v8
  v_xor_b32 v4, v4, v8
  v_mul_u32_u24 v11, 3456, v3
  v_lshrrev_b32 v6, 3, v4
  v_lshl_add_u32 v11, v6, 6, v11
  v_and_b32 v6, 3, v4
  v_lshl_add_u32 v11, v6, 4, v11
  v_bfe_u32 v6, v4, 2, 1
  v_cmp_eq_u32 vcc, 1, v6
  v_mov_b32 v6, s23
  v_mov_b32 v7, s21
  v_cndmask_b32 v6, v6, v7, vcc
  v_add_u32 v11, v11, v6
  v_mul_u32_u24 v3, 256, v2
  v_add_u32 v3, v3, v1
  v_add_u32 v3, 192, v3
  v_and_b32 v4, 15, v3
  v_lshrrev_b32 v3, 4, v3
  v_and_b32 v8, 3, v3
  v_lshlrev_b32 v8, 2, v8
  v_xor_b32 v4, v4, v8
  v_bfe_u32 v8, v3, 3, 1
  v_lshlrev_b32 v8, 1, v8
  v_xor_b32 v4, v4, v8
  v_mul_u32_u24 v12, 3456, v3
  v_lshrrev_b32 v6, 3, v4
  v_lshl_add_u32 v12, v6, 6, v12
  v_and_b32 v6, 3, v4
  v_lshl_add_u32 v12, v6, 4, v12
  v_bfe_u32 v6, v4, 2, 1
  v_cmp_eq_u32 vcc, 1, v6
  v_mov_b32 v6, s23
  v_mov_b32 v7, s21
  v_cndmask_b32 v6, v6, v7, vcc
  v_add_u32 v12, v12, v6
  s_mul_i32 s22, s19, 1280
  v_mul_u32_u24 v3, 32, v2
  v_lshrrev_b32 v4, 3, v1
  v_add3_u32 v3, v3, v4, 0
  v_bfe_u32 v4, v3, 1, 3
  v_and_b32 v8, 7, v1
  v_xor_b32 v4, v4, v8
  v_mul_u32_u24 v13, 1280, v3
  v_lshl_add_u32 v13, v4, 4, v13
  v_add_u32 v13, s22, v13
  v_mul_u32_u24 v3, 32, v2
  v_lshrrev_b32 v4, 3, v1
  v_add3_u32 v3, v3, v4, 8
  v_bfe_u32 v4, v3, 1, 3
  v_and_b32 v8, 7, v1
  v_xor_b32 v4, v4, v8
  v_mul_u32_u24 v14, 1280, v3
  v_lshl_add_u32 v14, v4, 4, v14
  v_add_u32 v14, s22, v14
  v_mul_u32_u24 v3, 32, v2
  v_lshrrev_b32 v4, 3, v1
  v_add3_u32 v3, v3, v4, 16
  v_bfe_u32 v4, v3, 1, 3
  v_and_b32 v8, 7, v1
  v_xor_b32 v4, v4, v8
  v_mul_u32_u24 v15, 1280, v3
  v_lshl_add_u32 v15, v4, 4, v15
  v_add_u32 v15, s22, v15
  v_mul_u32_u24 v3, 32, v2
  v_lshrrev_b32 v4, 3, v1
  v_add3_u32 v3, v3, v4, 24
  v_bfe_u32 v4, v3, 1, 3
  v_and_b32 v8, 7, v1
  v_xor_b32 v4, v4, v8
  v_mul_u32_u24 v16, 1280, v3
  v_lshl_add_u32 v16, v4, 4, v16
  v_add_u32 v16, s22, v16
  s_mul_i32 s34, s16, 4096
  s_mul_i32 s35, s16, 4096
  s_mov_b32 s32, 0
  s_mov_b32 s33, 0
  s_waitcnt lgkmcnt(0)
  s_mov_b32 s24, s4
  s_mov_b32 s25, s5
  s_mov_b32 s26, 2211840
  s_mov_b32 s27, 0x20000
  s_mov_b32 s28, s6
  s_mov_b32 s29, s7
  s_mov_b32 s30, 2621440
  s_mov_b32 s31, 0x20000
  s_mov_b32 s97, 1
  s_cmp_lg_u32 s16, 0
  s_cbranch_scc1 pre_6
  s_add_u32 s64, s92, 33030144
  s_addc_u32 s65, s93, 0
  s_mov_b32 s66, 20480
  s_mov_b32 s67, 0x20000
  v_lshlrev_b32 v24, 4, v1
  s_and_b32 s98, s2, 15
  s_mul_i32 s98, s98, 1280
  v_add_u32 v24, s98, v24
  s_add_u32 s98, s94, 1
  s_mov_b32 s97, 0
pre_6:
  s_waitcnt vmcnt(0)
  s_barrier
  s_add_u32 m0, s34, 0
  s_nop 0
  buffer_load_dwordx4 v9, s[24:27], s32 offen  lds
  s_add_u32 m0, s34, 1024
  s_nop 0
  buffer_load_dwordx4 v10, s[24:27], s32 offen  lds
  s_add_u32 m0, s34, 2048
  s_nop 0
  buffer_load_dwordx4 v11, s[24:27], s32 offen  lds
  s_add_u32 m0, s34, 3072
  s_nop 0
  buffer_load_dwordx4 v12, s[24:27], s32 offen  lds
  s_add_u32 s32, s32, 221184
  s_add_u32 m0, s34, 32768
  s_nop 0
  buffer_load_dwordx4 v9, s[24:27], s32 offen  lds
  s_add_u32 m0, s34, 33792
  s_nop 0
  buffer_load_dwordx4 v10, s[24:27], s32 offen  lds
  s_add_u32 m0, s34, 34816
  s_nop 0
  buffer_load_dwordx4 v11, s[24:27], s32 offen  lds
  s_add_u32 m0, s34, 35840
  s_nop 0
  buffer_load_dwordx4 v12, s[24:27], s32 offen  lds
  s_add_u32 s32, s32, 221184
  s_add_u32 m0, s34, 65536
  s_nop 0
  buffer_load_dwordx4 v9, s[24:27], s32 offen  lds
  s_add_u32 m0, s34, 66560
  s_nop 0
  buffer_load_dwordx4 v10, s[24:27], s32 offen  lds
  s_add_u32 m0, s34, 67584
  s_nop 0
  buffer_load_dwordx4 v11, s[24:27], s32 offen  lds
  s_add_u32 m0, s34, 68608
  s_nop 0
  buffer_load_dwordx4 v12, s[24:27], s32 offen  lds
  s_add_u32 s32, s32, 221184
  s_add_u32 m0, s34, 98304
  s_nop 0
  buffer_load_dwordx4 v9, s[24:27], s32 offen  lds
  s_add_u32 m0, s34, 99328
  s_nop 0
  buffer_load_dwordx4 v10, s[24:27], s32 offen  lds
  s_add_u32 m0, s34, 100352
  s_nop 0
  buffer_load_dwordx4 v11, s[24:27], s32 offen  lds
  s_add_u32 m0, s34, 101376
  s_nop 0
  buffer_load_dwordx4 v12, s[24:27], s32 offen  lds
  s_add_u32 s32, s32, 221184
  s_cmp_eq_u32 s97, 1
  s_cbranch_scc1 pollskip_8
  s_mov_b32 s99, 0
poll_7:
  buffer_load_dwordx4 v[20:23], v24, s[64:67], 0 offen sc1
  s_waitcnt vmcnt(0)
  v_subrev_u32 v20, s98, v20
  v_subrev_u32 v21, s98, v21
  v_subrev_u32 v22, s98, v22
  v_subrev_u32 v23, s98, v23
  v_max_u32 v20, v20, v21
  v_max_u32 v22, v22, v23
  v_max_u32 v20, v20, v22
  v_cmp_ge_u32 vcc, 2, v20
  s_add_u32 s99, s99, 1
  s_cmp_eq_u64 vcc, exec
  s_cbranch_scc1 pollskip_8
  s_cmp_lt_u32 s99, 40000
  s_cbranch_scc1 poll_7
pollskip_8:
  s_barrier
  s_add_u32 m0, s35, 16384
  s_nop 0
  buffer_load_dwordx4 v13, s[28:31], s33 offen sc1 lds
  s_add_u32 m0, s35, 17408
  s_nop 0
  buffer_load_dwordx4 v14, s[28:31], s33 offen sc1 lds
  s_add_u32 m0, s35, 18432
  s_nop 0
  buffer_load_dwordx4 v15, s[28:31], s33 offen sc1 lds
  s_add_u32 m0, s35, 19456
  s_nop 0
  buffer_load_dwordx4 v16, s[28:31], s33 offen sc1 lds
  s_add_u32 s33, s33, 128
  s_add_u32 m0, s35, 49152
  s_nop 0
  buffer_load_dwordx4 v13, s[28:31], s33 offen sc1 lds
  s_add_u32 m0, s35, 50176
  s_nop 0
  buffer_load_dwordx4 v14, s[28:31], s33 offen sc1 lds
  s_add_u32 m0, s35, 51200
  s_nop 0
  buffer_load_dwordx4 v15, s[28:31], s33 offen sc1 lds
  s_add_u32 m0, s35, 52224
  s_nop 0
  buffer_load_dwordx4 v16, s[28:31], s33 offen sc1 lds
  s_add_u32 s33, s33, 128
  s_waitcnt vmcnt(4)
  s_barrier
  s_add_u32 m0, s35, 81920
  s_nop 0
  buffer_load_dwordx4 v13, s[28:31], s33 offen sc1 lds
  s_add_u32 m0, s35, 82944
  s_nop 0
  buffer_load_dwordx4 v14, s[28:31], s33 offen sc1 lds
  s_add_u32 m0, s35, 83968
  s_nop 0
  buffer_load_dwordx4 v15, s[28:31], s33 offen sc1 lds
  s_add_u32 m0, s35, 84992
  s_nop 0
  buffer_load_dwordx4 v16, s[28:31], s33 offen sc1 lds
  s_add_u32 s33, s33, 128
  s_add_u32 m0, s35, 114688
  s_nop 0
  buffer_load_dwordx4 v13, s[28:31], s33 offen sc1 lds
  s_add_u32 m0, s35, 115712
  s_nop 0
  buffer_load_dwordx4 v14, s[28:31], s33 offen sc1 lds
  s_add_u32 m0, s35, 116736
  s_nop 0
  buffer_load_dwordx4 v15, s[28:31], s33 offen sc1 lds
  s_add_u32 m0, s35, 117760
  s_nop 0
  buffer_load_dwordx4 v16, s[28:31], s33 offen sc1 lds
  s_add_u32 s33, s33, 128
  s_waitcnt vmcnt(8)
  s_barrier
  s_add_u32 m0, s34, 0
  s_nop 0
  buffer_load_dwordx4 v9, s[24:27], s32 offen  lds
  s_add_u32 m0, s34, 1024
  s_nop 0
  buffer_load_dwordx4 v10, s[24:27], s32 offen  lds
  s_add_u32 m0, s34, 2048
  s_nop 0
  buffer_load_dwordx4 v11, s[24:27], s32 offen  lds
  s_add_u32 m0, s34, 3072
  s_nop 0
  buffer_load_dwordx4 v12, s[24:27], s32 offen  lds
  s_add_u32 s32, s32, 221184
  s_add_u32 m0, s35, 16384
  s_nop 0
  buffer_load_dwordx4 v13, s[28:31], s33 offen sc1 lds
  s_add_u32 m0, s35, 17408
  s_nop 0
  buffer_load_dwordx4 v14, s[28:31], s33 offen sc1 lds
  s_add_u32 m0, s35, 18432
  s_nop 0
  buffer_load_dwordx4 v15, s[28:31], s33 offen sc1 lds
  s_add_u32 m0, s35, 19456
  s_nop 0
  buffer_load_dwordx4 v16, s[28:31], s33 offen sc1 lds
  s_add_u32 s33, s33, 128
  s_waitcnt vmcnt(12)
  s_barrier
  s_add_u32 m0, s34, 32768
  s_nop 0
  buffer_load_dwordx4 v9, s[24:27], s32 offen  lds
  s_add_u32 m0, s34, 33792
  s_nop 0
  buffer_load_dwordx4 v10, s[24:27], s32 offen  lds
  s_add_u32 m0, s34, 34816
  s_nop 0
  buffer_load_dwordx4 v11, s[24:27], s32 offen  lds
  s_add_u32 m0, s34, 35840
  s_nop 0
  buffer_load_dwordx4 v12, s[24:27], s32 offen  lds
  s_add_u32 s32, s32, 221184
  s_add_u32 m0, s35, 49152
  s_nop 0
  buffer_load_dwordx4 v13, s[28:31], s33 offen sc1 lds
  s_add_u32 m0, s35, 50176
  s_nop 0
  buffer_load_dwordx4 v14, s[28:31], s33 offen sc1 lds
  s_add_u32 m0, s35, 51200
  s_nop 0
  buffer_load_dwordx4 v15, s[28:31], s33 offen sc1 lds
  s_add_u32 m0, s35, 52224
  s_nop 0
  buffer_load_dwordx4 v16, s[28:31], s33 offen sc1 lds
  s_add_u32 s33, s33, 128
  s_waitcnt vmcnt(16)
  s_barrier
  s_add_u32 m0, s34, 65536
  s_nop 0
  buffer_load_dwordx4 v9, s[24:27], s32 offen  lds
  s_add_u32 m0, s34, 66560
  s_nop 0
  buffer_load_dwordx4 v10, s[24:27], s32 offen  lds
  s_add_u32 m0, s34, 67584
  s_nop 0
  buffer_load_dwordx4 v11, s[24:27], s32 offen  lds
  s_add_u32 m0, s34, 68608
  s_nop 0
  buffer_load_dwordx4 v12, s[24:27], s32 offen  lds
  s_add_u32 s32, s32, 221184
  s_add_u32 m0, s35, 81920
  s_nop 0
  buffer_load_dwordx4 v13, s[28:31], s33 offen sc1 lds
  s_add_u32 m0, s35, 82944
  s_nop 0
  buffer_load_dwordx4 v14, s[28:31], s33 offen sc1 lds
  s_add_u32 m0, s35, 83968
  s_nop 0
  buffer_load_dwordx4 v15, s[28:31], s33 offen sc1 lds
  s_add_u32 m0, s35, 84992
  s_nop 0
  buffer_load_dwordx4 v16, s[28:31], s33 offen sc1 lds
  s_add_u32 s33, s33, 128
  s_waitcnt vmcnt(16)
  s_barrier
  s_add_u32 m0, s34, 98304
  s_nop 0
  buffer_load_dwordx4 v9, s[24:27], s32 offen  lds
  s_add_u32 m0, s34, 99328
  s_nop 0
  buffer_load_dwordx4 v10, s[24:27], s32 offen  lds
  s_add_u32 m0, s34, 100352
  s_nop 0
  buffer_load_dwordx4 v11, s[24:27], s32 offen  lds
  s_add_u32 m0, s34, 101376
  s_nop 0
  buffer_load_dwordx4 v12, s[24:27], s32 offen  lds
  s_add_u32 s32, s32, 221184
  s_add_u32 m0, s35, 114688
  s_nop 0
  buffer_load_dwordx4 v13, s[28:31], s33 offen sc1 lds
  s_add_u32 m0, s35, 115712
  s_nop 0
  buffer_load_dwordx4 v14, s[28:31], s33 offen sc1 lds
  s_add_u32 m0, s35, 116736
  s_nop 0
  buffer_load_dwordx4 v15, s[28:31], s33 offen sc1 lds
  s_add_u32 m0, s35, 117760
  s_nop 0
  buffer_load_dwordx4 v16, s[28:31], s33 offen sc1 lds
  s_add_u32 s33, s33, 128
  s_waitcnt vmcnt(16)
  s_barrier
  s_add_u32 m0, s34, 0
  s_nop 0
  buffer_load_dwordx4 v9, s[24:27], s32 offen  lds
  s_add_u32 m0, s34, 1024
  s_nop 0
  buffer_load_dwordx4 v10, s[24:27], s32 offen  lds
  s_add_u32 m0, s34, 2048
  s_nop 0
  buffer_load_dwordx4 v11, s[24:27], s32 offen  lds
  s_add_u32 m0, s34, 3072
  s_nop 0
  buffer_load_dwordx4 v12, s[24:27], s32 offen  lds
  s_add_u32 s32, s32, 221184
  s_add_u32 m0, s35, 16384
  s_nop 0
  buffer_load_dwordx4 v13, s[28:31], s33 offen sc1 lds
  s_add_u32 m0, s35, 17408
  s_nop 0
  buffer_load_dwordx4 v14, s[28:31], s33 offen sc1 lds
  s_add_u32 m0, s35, 18432
  s_nop 0
  buffer_load_dwordx4 v15, s[28:31], s33 offen sc1 lds
  s_add_u32 m0, s35, 19456
  s_nop 0
  buffer_load_dwordx4 v16, s[28:31], s33 offen sc1 lds
  s_add_u32 s33, s33, 128
  s_waitcnt vmcnt(16)
  s_barrier
  s_add_u32 m0, s34, 32768
  s_nop 0
  buffer_load_dwordx4 v9, s[24:27], s32 offen  lds
  s_add_u32 m0, s34, 33792
  s_nop 0
  buffer_load_dwordx4 v10, s[24:27], s32 offen  lds
  s_add_u32 m0, s34, 34816
  s_nop 0
  buffer_load_dwordx4 v11, s[24:27], s32 offen  lds
  s_add_u32 m0, s34, 35840
  s_nop 0
  buffer_load_dwordx4 v12, s[24:27], s32 offen  lds
  s_add_u32 s32, s32, 221184
  s_add_u32 m0, s35, 49152
  s_nop 0
  buffer_load_dwordx4 v13, s[28:31], s33 offen sc1 lds
  s_add_u32 m0, s35, 50176
  s_nop 0
  buffer_load_dwordx4 v14, s[28:31], s33 offen sc1 lds
  s_add_u32 m0, s35, 51200
  s_nop 0
  buffer_load_dwordx4 v15, s[28:31], s33 offen sc1 lds
  s_add_u32 m0, s35, 52224
  s_nop 0
  buffer_load_dwordx4 v16, s[28:31], s33 offen sc1 lds
  s_add_u32 s33, s33, 128
  s_waitcnt vmcnt(16)
  s_barrier
  s_waitcnt vmcnt(8)
  s_barrier
  s_waitcnt vmcnt(0)
  s_barrier
  s_barrier
  s_barrier
  s_branch PH2
P1_dbl:
  s_sub_u32 s17, s15, 26
  s_lshl_b32 s18, s60, 1
  s_add_u32 s17, s17, s18
  s_lshl_b32 s18, s59, 2
  s_add_u32 s17, s17, s18
  s_mov_b32 s18, 13
  s_lshl_b32 s19, s17, 7
  s_mov_b32 s20, 26
  s_mov_b32 s50, 0
  v_readfirstlane_b32 s98, v0
  s_nop 3
  s_cmp_ge_u32 s98, 256
  s_cbranch_scc1 P1_dbl_ld
  v_and_b32 v1, 63, v0
  v_bfe_u32 v2, v0, 6, 2
  s_nop 0
  v_readfirstlane_b32 s16, v2
  v_mov_b32 v9, 0
  v_lshlrev_b32 v10, 5, v2
  v_lshrrev_b32 v3, 4, v1
  v_bfe_u32 v5, v1, 2, 2
  v_lshl_add_u32 v4, v3, 3, v5
  v_mul_u32_u24 v4, 128, v4
  v_and_b32 v6, 1, v1
  v_lshl_add_u32 v4, v6, 3, v4
  v_bfe_u32 v6, v1, 1, 1
  v_and_b32 v3, 1, v3
  v_lshlrev_b32 v3, 1, v3
  v_lshrrev_b32 v5, 1, v5
  v_lshlrev_b32 v5, 2, v5
  v_xor_b32 v3, v3, v5
  v_add_u32 v7, 0, v9
  v_lshl_add_u32 v7, v7, 1, v6
  v_xor_b32 v7, v7, v3
  v_lshl_add_u32 v11, v7, 4, v4
  v_add_u32 v7, 1, v9
  v_lshl_add_u32 v7, v7, 1, v6
  v_xor_b32 v7, v7, v3
  v_lshl_add_u32 v12, v7, 4, v4
  v_add_u32 v7, 2, v9
  v_lshl_add_u32 v7, v7, 1, v6
  v_xor_b32 v7, v7, v3
  v_lshl_add_u32 v13, v7, 4, v4
  v_add_u32 v7, 3, v9
  v_lshl_add_u32 v7, v7, 1, v6
  v_xor_b32 v7, v7, v3
  v_lshl_add_u32 v14, v7, 4, v4
  v_add_u32 v15, 49152, v11
  v_add_u32 v16, 49152, v12
  v_add_u32 v17, 49152, v13
  v_add_u32 v18, 49152, v14
  v_and_b32 v3, 15, v1
  v_add_u32 v3, v3, v10
  v_bfe_u32 v4, v3, 1, 3
  v_lshrrev_b32 v5, 4, v1
  v_xor_b32 v4, v4, v5
  v_lshlrev_b32 v4, 4, v4
  v_lshl_add_u32 v4, v3, 7, v4
  v_xor_b32 v19, 0, v4
  v_add_u32 v19, 8192, v19
  v_xor_b32 v20, 64, v4
  v_add_u32 v20, 8192, v20
  v_add_u32 v21, 49152, v19
  v_add_u32 v22, 49152, v20
  v_lshrrev_b32 v3, 5, v1
  v_add_u32 v3, v3, v9
  v_mul_u32_u24 v23, 34816, v3
  v_and_b32 v3, 31, v1
  v_add_u32 v3, v3, v10
  v_lshl_add_u32 v23, v3, 4, v23
  v_mov_b32 v24, 0xc0135761
  v_mov_b32 v25, 0xc0135761
  s_mov_b32 s36, 0xbdd2d3e8
  s_mov_b32 s37, 0xbdd2d3e8
  s_mov_b32 s38, 1.0
  s_mov_b32 s39, 1.0
  s_mul_i32 s45, s20, 139264
  s_lshl_b32 s48, s19, 4
  s_add_u32 s45, s45, s48
  s_mul_i32 s51, s50, 139264
  s_add_u32 s51, s51, s48
  s_waitcnt lgkmcnt(0)
  s_add_u32 s24, s6, 32505856
  s_addc_u32 s25, s7, 0
  s_mov_b32 s26, 229376
  s_mov_b32 s27, 0x20000
  s_add_u32 s28, s6, 8388608
  s_addc_u32 s29, s7, 0
  s_mov_b32 s30, 3760128
  s_mov_b32 s31, 0x20000
  s_add_u32 s40, s6, 12582912
  s_addc_u32 s41, s7, 0
  s_mov_b32 s42, 3760128
  s_mov_b32 s43, 0x20000
  s_barrier
  s_barrier
  ds_read_b64_tr_b16 v[60:61], v11 offset:0
  ds_read_b64_tr_b16 v[62:63], v11 offset:512
  ds_read_b128 v[64:67], v19 offset:0
  ds_read_b128 v[68:71], v19 offset:2048
  ds_read_b64_tr_b16 v[72:73], v12 offset:0
  ds_read_b64_tr_b16 v[74:75], v12 offset:512
  ds_read_b64_tr_b16 v[76:77], v13 offset:0
  ds_read_b64_tr_b16 v[78:79], v13 offset:512
  ds_read_b64_tr_b16 v[80:81], v14 offset:0
  ds_read_b64_tr_b16 v[82:83], v14 offset:512
  s_waitcnt lgkmcnt(7)
  v_mfma_f32_16x16x32_bf16 v[28:31], v[60:63], v[64:67], 0
  ds_read_b64_tr_b16 v[84:85], v11 offset:4096
  ds_read_b64_tr_b16 v[86:87], v11 offset:4608
  s_waitcnt lgkmcnt(8)
  v_mfma_f32_16x16x32_bf16 v[32:35], v[60:63], v[68:71], 0
  ds_read_b128 v[88:91], v20 offset:0
  ds_read_b128 v[92:95], v20 offset:2048
  s_waitcnt lgkmcnt(8)
  v_mfma_f32_16x16x32_bf16 v[36:39], v[72:75], v[64:67], 0
  ds_read_b64_tr_b16 v[96:97], v12 offset:4096
  ds_read_b64_tr_b16 v[98:99], v12 offset:4608
  v_mfma_f32_16x16x32_bf16 v[40:43], v[72:75], v[68:71], 0
  ds_read_b64_tr_b16 v[100:101], v13 offset:4096
  ds_read_b64_tr_b16 v[102:103], v13 offset:4608
  s_waitcnt lgkmcnt(10)
  v_mfma_f32_16x16x32_bf16 v[44:47], v[76:79], v[64:67], 0
  ds_read_b64_tr_b16 v[104:105], v14 offset:4096
  v_mfma_f32_16x16x32_bf16 v[48:51], v[76:79], v[68:71], 0
  ds_read_b64_tr_b16 v[106:107], v14 offset:4608
  s_waitcnt lgkmcnt(10)
  v_mfma_f32_16x16x32_bf16 v[52:55], v[80:83], v[64:67], 0
  v_mfma_f32_16x16x32_bf16 v[56:59], v[80:83], v[68:71], 0
  s_waitcnt lgkmcnt(7)
  v_mfma_f32_16x16x32_bf16 v[28:31], v[84:87], v[88:91], v[28:31]
  s_waitcnt lgkmcnt(6)
  v_mfma_f32_16x16x32_bf16 v[32:35], v[84:87], v[92:95], v[32:35]
  s_waitcnt lgkmcnt(0)
  s_barrier
  ds_read_b64_tr_b16 v[60:61], v11 offset:24576
  ds_read_b64_tr_b16 v[62:63], v11 offset:25088
  v_mfma_f32_16x16x32_bf16 v[36:39], v[96:99], v[88:91], v[36:39]
  ds_read_b128 v[64:67], v19 offset:24576
  ds_read_b128 v[68:71], v19 offset:26624
  v_mfma_f32_16x16x32_bf16 v[40:43], v[96:99], v[92:95], v[40:43]
  ds_read_b64_tr_b16 v[72:73], v12 offset:24576
  ds_read_b64_tr_b16 v[74:75], v12 offset:25088
  v_mfma_f32_16x16x32_bf16 v[44:47], v[100:103], v[88:91], v[44:47]
  ds_read_b64_tr_b16 v[76:77], v13 offset:24576
  ds_read_b64_tr_b16 v[78:79], v13 offset:25088
  v_mfma_f32_16x16x32_bf16 v[48:51], v[100:103], v[92:95], v[48:51]
  ds_read_b64_tr_b16 v[80:81], v14 offset:24576
  v_mfma_f32_16x16x32_bf16 v[52:55], v[104:107], v[88:91], v[52:55]
  ds_read_b64_tr_b16 v[82:83], v14 offset:25088
  v_mfma_f32_16x16x32_bf16 v[56:59], v[104:107], v[92:95], v[56:59]
  s_waitcnt lgkmcnt(7)
  v_mfma_f32_16x16x32_bf16 v[28:31], v[60:63], v[64:67], v[28:31]
  ds_read_b64_tr_b16 v[84:85], v11 offset:28672
  ds_read_b64_tr_b16 v[86:87], v11 offset:29184
  s_waitcnt lgkmcnt(8)
  v_mfma_f32_16x16x32_bf16 v[32:35], v[60:63], v[68:71], v[32:35]
  ds_read_b128 v[88:91], v20 offset:24576
  ds_read_b128 v[92:95], v20 offset:26624
  s_waitcnt lgkmcnt(8)
  v_mfma_f32_16x16x32_bf16 v[36:39], v[72:75], v[64:67], v[36:39]
  ds_read_b64_tr_b16 v[96:97], v12 offset:28672
  ds_read_b64_tr_b16 v[98:99], v12 offset:29184
  v_mfma_f32_16x16x32_bf16 v[40:43], v[72:75], v[68:71], v[40:43]
  ds_read_b64_tr_b16 v[100:101], v13 offset:28672
  ds_read_b64_tr_b16 v[102:103], v13 offset:29184
  s_waitcnt lgkmcnt(10)
  v_mfma_f32_16x16x32_bf16 v[44:47], v[76:79], v[64:67], v[44:47]
  ds_read_b64_tr_b16 v[104:105], v14 offset:28672
  v_mfma_f32_16x16x32_bf16 v[48:51], v[76:79], v[68:71], v[48:51]
  ds_read_b64_tr_b16 v[106:107], v14 offset:29184
  s_waitcnt lgkmcnt(10)
  v_mfma_f32_16x16x32_bf16 v[52:55], v[80:83], v[64:67], v[52:55]
  v_mfma_f32_16x16x32_bf16 v[56:59], v[80:83], v[68:71], v[56:59]
  s_waitcnt lgkmcnt(7)
  v_mfma_f32_16x16x32_bf16 v[28:31], v[84:87], v[88:91], v[28:31]
  s_waitcnt lgkmcnt(6)
  v_mfma_f32_16x16x32_bf16 v[32:35], v[84:87], v[92:95], v[32:35]
  s_waitcnt lgkmcnt(0)
  s_barrier
  ds_read_b64_tr_b16 v[60:61], v15 offset:0
  ds_read_b64_tr_b16 v[62:63], v15 offset:512
  v_mfma_f32_16x16x32_bf16 v[36:39], v[96:99], v[88:91], v[36:39]
  ds_read_b128 v[64:67], v21 offset:0
  ds_read_b128 v[68:71], v21 offset:2048
  v_mfma_f32_16x16x32_bf16 v[40:43], v[96:99], v[92:95], v[40:43]
  ds_read_b64_tr_b16 v[72:73], v16 offset:0
  ds_read_b64_tr_b16 v[74:75], v16 offset:512
  v_mfma_f32_16x16x32_bf16 v[44:47], v[100:103], v[88:91], v[44:47]
  ds_read_b64_tr_b16 v[76:77], v17 offset:0
  ds_read_b64_tr_b16 v[78:79], v17 offset:512
  v_mfma_f32_16x16x32_bf16 v[48:51], v[100:103], v[92:95], v[48:51]
  ds_read_b64_tr_b16 v[80:81], v18 offset:0
  v_mfma_f32_16x16x32_bf16 v[52:55], v[104:107], v[88:91], v[52:55]
  ds_read_b64_tr_b16 v[82:83], v18 offset:512
  v_mfma_f32_16x16x32_bf16 v[56:59], v[104:107], v[92:95], v[56:59]
  s_waitcnt lgkmcnt(7)
  v_mfma_f32_16x16x32_bf16 v[28:31], v[60:63], v[64:67], v[28:31]
  ds_read_b64_tr_b16 v[84:85], v15 offset:4096
  ds_read_b64_tr_b16 v[86:87], v15 offset:4608
  s_waitcnt lgkmcnt(8)
  v_mfma_f32_16x16x32_bf16 v[32:35], v[60:63], v[68:71], v[32:35]
  ds_read_b128 v[88:91], v22 offset:0
  ds_read_b128 v[92:95], v22 offset:2048
  s_waitcnt lgkmcnt(8)
  v_mfma_f32_16x16x32_bf16 v[36:39], v[72:75], v[64:67], v[36:39]
  ds_read_b64_tr_b16 v[96:97], v16 offset:4096
  ds_read_b64_tr_b16 v[98:99], v16 offset:4608
  v_mfma_f32_16x16x32_bf16 v[40:43], v[72:75], v[68:71], v[40:43]
  ds_read_b64_tr_b16 v[100:101], v17 offset:4096
  ds_read_b64_tr_b16 v[102:103], v17 offset:4608
  s_waitcnt lgkmcnt(10)
  v_mfma_f32_16x16x32_bf16 v[44:47], v[76:79], v[64:67], v[44:47]
  ds_read_b64_tr_b16 v[104:105], v18 offset:4096
  v_mfma_f32_16x16x32_bf16 v[48:51], v[76:79], v[68:71], v[48:51]
  ds_read_b64_tr_b16 v[106:107], v18 offset:4608
  s_waitcnt lgkmcnt(10)
  v_mfma_f32_16x16x32_bf16 v[52:55], v[80:83], v[64:67], v[52:55]
  v_mfma_f32_16x16x32_bf16 v[56:59], v[80:83], v[68:71], v[56:59]
  s_waitcnt lgkmcnt(7)
  v_mfma_f32_16x16x32_bf16 v[28:31], v[84:87], v[88:91], v[28:31]
  s_waitcnt lgkmcnt(6)
  v_mfma_f32_16x16x32_bf16 v[32:35], v[84:87], v[92:95], v[32:35]
  s_waitcnt lgkmcnt(0)
  s_barrier
  ds_read_b64_tr_b16 v[60:61], v15 offset:24576
  ds_read_b64_tr_b16 v[62:63], v15 offset:25088
  v_mfma_f32_16x16x32_bf16 v[36:39], v[96:99], v[88:91], v[36:39]
  ds_read_b128 v[64:67], v21 offset:24576
  ds_read_b128 v[68:71], v21 offset:26624
  v_mfma_f32_16x16x32_bf16 v[40:43], v[96:99], v[92:95], v[40:43]
  ds_read_b64_tr_b16 v[72:73], v16 offset:24576
  ds_read_b64_tr_b16 v[74:75], v16 offset:25088
  v_mfma_f32_16x16x32_bf16 v[44:47], v[100:103], v[88:91], v[44:47]
  ds_read_b64_tr_b16 v[76:77], v17 offset:24576
  ds_read_b64_tr_b16 v[78:79], v17 offset:25088
  v_mfma_f32_16x16x32_bf16 v[48:51], v[100:103], v[92:95], v[48:51]
  ds_read_b64_tr_b16 v[80:81], v18 offset:24576
  v_mfma_f32_16x16x32_bf16 v[52:55], v[104:107], v[88:91], v[52:55]
  ds_read_b64_tr_b16 v[82:83], v18 offset:25088
  v_mfma_f32_16x16x32_bf16 v[56:59], v[104:107], v[92:95], v[56:59]
  s_waitcnt lgkmcnt(7)
  v_mfma_f32_16x16x32_bf16 v[28:31], v[60:63], v[64:67], v[28:31]
  ds_read_b64_tr_b16 v[84:85], v15 offset:28672
  ds_read_b64_tr_b16 v[86:87], v15 offset:29184
  s_waitcnt lgkmcnt(8)
  v_mfma_f32_16x16x32_bf16 v[32:35], v[60:63], v[68:71], v[32:35]
  ds_read_b128 v[88:91], v22 offset:24576
  ds_read_b128 v[92:95], v22 offset:26624
  s_waitcnt lgkmcnt(8)
  v_mfma_f32_16x16x32_bf16 v[36:39], v[72:75], v[64:67], v[36:39]
  ds_read_b64_tr_b16 v[96:97], v16 offset:28672
  ds_read_b64_tr_b16 v[98:99], v16 offset:29184
  v_mfma_f32_16x16x32_bf16 v[40:43], v[72:75], v[68:71], v[40:43]
  ds_read_b64_tr_b16 v[100:101], v17 offset:28672
  ds_read_b64_tr_b16 v[102:103], v17 offset:29184
  s_waitcnt lgkmcnt(10)
  v_mfma_f32_16x16x32_bf16 v[44:47], v[76:79], v[64:67], v[44:47]
  ds_read_b64_tr_b16 v[104:105], v18 offset:28672
  v_mfma_f32_16x16x32_bf16 v[48:51], v[76:79], v[68:71], v[48:51]
  ds_read_b64_tr_b16 v[106:107], v18 offset:29184
  s_waitcnt lgkmcnt(10)
  v_mfma_f32_16x16x32_bf16 v[52:55], v[80:83], v[64:67], v[52:55]
  v_mfma_f32_16x16x32_bf16 v[56:59], v[80:83], v[68:71], v[56:59]
  s_waitcnt lgkmcnt(7)
  v_mfma_f32_16x16x32_bf16 v[28:31], v[84:87], v[88:91], v[28:31]
  s_waitcnt lgkmcnt(6)
  v_mfma_f32_16x16x32_bf16 v[32:35], v[84:87], v[92:95], v[32:35]
  s_waitcnt lgkmcnt(0)
  s_barrier
  ds_read_b64_tr_b16 v[60:61], v11 offset:0
  ds_read_b64_tr_b16 v[62:63], v11 offset:512
  v_mfma_f32_16x16x32_bf16 v[36:39], v[96:99], v[88:91], v[36:39]
  ds_read_b128 v[64:67], v19 offset:0
  ds_read_b128 v[68:71], v19 offset:2048
  v_mfma_f32_16x16x32_bf16 v[40:43], v[96:99], v[92:95], v[40:43]
  ds_read_b64_tr_b16 v[72:73], v12 offset:0
  ds_read_b64_tr_b16 v[74:75], v12 offset:512
  v_mfma_f32_16x16x32_bf16 v[44:47], v[100:103], v[88:91], v[44:47]
  ds_read_b64_tr_b16 v[76:77], v13 offset:0
  ds_read_b64_tr_b16 v[78:79], v13 offset:512
  v_mfma_f32_16x16x32_bf16 v[48:51], v[100:103], v[92:95], v[48:51]
  ds_read_b64_tr_b16 v[80:81], v14 offset:0
  v_mfma_f32_16x16x32_bf16 v[52:55], v[104:107], v[88:91], v[52:55]
  ds_read_b64_tr_b16 v[82:83], v14 offset:512
  v_mfma_f32_16x16x32_bf16 v[56:59], v[104:107], v[92:95], v[56:59]
  s_waitcnt lgkmcnt(7)
  v_mfma_f32_16x16x32_bf16 v[28:31], v[60:63], v[64:67], v[28:31]
  ds_read_b64_tr_b16 v[84:85], v11 offset:4096
  ds_read_b64_tr_b16 v[86:87], v11 offset:4608
  s_waitcnt lgkmcnt(8)
  v_mfma_f32_16x16x32_bf16 v[32:35], v[60:63], v[68:71], v[32:35]
  ds_read_b128 v[88:91], v20 offset:0
  ds_read_b128 v[92:95], v20 offset:2048
  s_waitcnt lgkmcnt(8)
  v_mfma_f32_16x16x32_bf16 v[36:39], v[72:75], v[64:67], v[36:39]
  ds_read_b64_tr_b16 v[96:97], v12 offset:4096
  ds_read_b64_tr_b16 v[98:99], v12 offset:4608
  v_mfma_f32_16x16x32_bf16 v[40:43], v[72:75], v[68:71], v[40:43]
  ds_read_b64_tr_b16 v[100:101], v13 offset:4096
  ds_read_b64_tr_b16 v[102:103], v13 offset:4608
  s_waitcnt lgkmcnt(10)
  v_mfma_f32_16x16x32_bf16 v[44:47], v[76:79], v[64:67], v[44:47]
  ds_read_b64_tr_b16 v[104:105], v14 offset:4096
  v_mfma_f32_16x16x32_bf16 v[48:51], v[76:79], v[68:71], v[48:51]
  ds_read_b64_tr_b16 v[106:107], v14 offset:4608
  s_waitcnt lgkmcnt(10)
  v_mfma_f32_16x16x32_bf16 v[52:55], v[80:83], v[64:67], v[52:55]
  v_mfma_f32_16x16x32_bf16 v[56:59], v[80:83], v[68:71], v[56:59]
  s_waitcnt lgkmcnt(7)
  v_mfma_f32_16x16x32_bf16 v[28:31], v[84:87], v[88:91], v[28:31]
  s_waitcnt lgkmcnt(6)
  v_mfma_f32_16x16x32_bf16 v[32:35], v[84:87], v[92:95], v[32:35]
  s_waitcnt lgkmcnt(0)
  s_barrier
  ds_read_b64_tr_b16 v[60:61], v11 offset:24576
  ds_read_b64_tr_b16 v[62:63], v11 offset:25088
  v_mfma_f32_16x16x32_bf16 v[36:39], v[96:99], v[88:91], v[36:39]
  ds_read_b128 v[64:67], v19 offset:24576
  ds_read_b128 v[68:71], v19 offset:26624
  v_mfma_f32_16x16x32_bf16 v[40:43], v[96:99], v[92:95], v[40:43]
  ds_read_b64_tr_b16 v[72:73], v12 offset:24576
  ds_read_b64_tr_b16 v[74:75], v12 offset:25088
  v_mfma_f32_16x16x32_bf16 v[44:47], v[100:103], v[88:91], v[44:47]
  ds_read_b64_tr_b16 v[76:77], v13 offset:24576
  ds_read_b64_tr_b16 v[78:79], v13 offset:25088
  v_mfma_f32_16x16x32_bf16 v[48:51], v[100:103], v[92:95], v[48:51]
  ds_read_b64_tr_b16 v[80:81], v14 offset:24576
  v_mfma_f32_16x16x32_bf16 v[52:55], v[104:107], v[88:91], v[52:55]
  ds_read_b64_tr_b16 v[82:83], v14 offset:25088
  v_mfma_f32_16x16x32_bf16 v[56:59], v[104:107], v[92:95], v[56:59]
  s_waitcnt lgkmcnt(7)
  v_mfma_f32_16x16x32_bf16 v[28:31], v[60:63], v[64:67], v[28:31]
  ds_read_b64_tr_b16 v[84:85], v11 offset:28672
  ds_read_b64_tr_b16 v[86:87], v11 offset:29184
  s_waitcnt lgkmcnt(8)
  v_mfma_f32_16x16x32_bf16 v[32:35], v[60:63], v[68:71], v[32:35]
  ds_read_b128 v[88:91], v20 offset:24576
  ds_read_b128 v[92:95], v20 offset:26624
  s_waitcnt lgkmcnt(8)
  v_mfma_f32_16x16x32_bf16 v[36:39], v[72:75], v[64:67], v[36:39]
  ds_read_b64_tr_b16 v[96:97], v12 offset:28672
  ds_read_b64_tr_b16 v[98:99], v12 offset:29184
  v_mfma_f32_16x16x32_bf16 v[40:43], v[72:75], v[68:71], v[40:43]
  ds_read_b64_tr_b16 v[100:101], v13 offset:28672
  ds_read_b64_tr_b16 v[102:103], v13 offset:29184
  s_waitcnt lgkmcnt(10)
  v_mfma_f32_16x16x32_bf16 v[44:47], v[76:79], v[64:67], v[44:47]
  ds_read_b64_tr_b16 v[104:105], v14 offset:28672
  v_mfma_f32_16x16x32_bf16 v[48:51], v[76:79], v[68:71], v[48:51]
  ds_read_b64_tr_b16 v[106:107], v14 offset:29184
  s_waitcnt lgkmcnt(10)
  v_mfma_f32_16x16x32_bf16 v[52:55], v[80:83], v[64:67], v[52:55]
  v_mfma_f32_16x16x32_bf16 v[56:59], v[80:83], v[68:71], v[56:59]
  s_waitcnt lgkmcnt(7)
  v_mfma_f32_16x16x32_bf16 v[28:31], v[84:87], v[88:91], v[28:31]
  s_waitcnt lgkmcnt(6)
  v_mfma_f32_16x16x32_bf16 v[32:35], v[84:87], v[92:95], v[32:35]
  s_waitcnt lgkmcnt(0)
  s_barrier
  ds_read_b64_tr_b16 v[60:61], v15 offset:0
  ds_read_b64_tr_b16 v[62:63], v15 offset:512
  v_mfma_f32_16x16x32_bf16 v[36:39], v[96:99], v[88:91], v[36:39]
  ds_read_b128 v[64:67], v21 offset:0
  ds_read_b128 v[68:71], v21 offset:2048
  v_mfma_f32_16x16x32_bf16 v[40:43], v[96:99], v[92:95], v[40:43]
  ds_read_b64_tr_b16 v[72:73], v16 offset:0
  ds_read_b64_tr_b16 v[74:75], v16 offset:512
  v_mfma_f32_16x16x32_bf16 v[44:47], v[100:103], v[88:91], v[44:47]
  ds_read_b64_tr_b16 v[76:77], v17 offset:0
  ds_read_b64_tr_b16 v[78:79], v17 offset:512
  v_mfma_f32_16x16x32_bf16 v[48:51], v[100:103], v[92:95], v[48:51]
  ds_read_b64_tr_b16 v[80:81], v18 offset:0
  v_mfma_f32_16x16x32_bf16 v[52:55], v[104:107], v[88:91], v[52:55]
  ds_read_b64_tr_b16 v[82:83], v18 offset:512
  v_mfma_f32_16x16x32_bf16 v[56:59], v[104:107], v[92:95], v[56:59]
  s_waitcnt lgkmcnt(7)
  v_mfma_f32_16x16x32_bf16 v[28:31], v[60:63], v[64:67], v[28:31]
  ds_read_b64_tr_b16 v[84:85], v15 offset:4096
  ds_read_b64_tr_b16 v[86:87], v15 offset:4608
  s_waitcnt lgkmcnt(8)
  v_mfma_f32_16x16x32_bf16 v[32:35], v[60:63], v[68:71], v[32:35]
  ds_read_b128 v[88:91], v22 offset:0
  ds_read_b128 v[92:95], v22 offset:2048
  s_waitcnt lgkmcnt(8)
  v_mfma_f32_16x16x32_bf16 v[36:39], v[72:75], v[64:67], v[36:39]
  ds_read_b64_tr_b16 v[96:97], v16 offset:4096
  ds_read_b64_tr_b16 v[98:99], v16 offset:4608
  v_mfma_f32_16x16x32_bf16 v[40:43], v[72:75], v[68:71], v[40:43]
  ds_read_b64_tr_b16 v[100:101], v17 offset:4096
  ds_read_b64_tr_b16 v[102:103], v17 offset:4608
  s_waitcnt lgkmcnt(10)
  v_mfma_f32_16x16x32_bf16 v[44:47], v[76:79], v[64:67], v[44:47]
  ds_read_b64_tr_b16 v[104:105], v18 offset:4096
  v_mfma_f32_16x16x32_bf16 v[48:51], v[76:79], v[68:71], v[48:51]
  ds_read_b64_tr_b16 v[106:107], v18 offset:4608
  s_waitcnt lgkmcnt(10)
  v_mfma_f32_16x16x32_bf16 v[52:55], v[80:83], v[64:67], v[52:55]
  v_mfma_f32_16x16x32_bf16 v[56:59], v[80:83], v[68:71], v[56:59]
  s_waitcnt lgkmcnt(7)
  v_mfma_f32_16x16x32_bf16 v[28:31], v[84:87], v[88:91], v[28:31]
  s_waitcnt lgkmcnt(6)
  v_mfma_f32_16x16x32_bf16 v[32:35], v[84:87], v[92:95], v[32:35]
  s_waitcnt lgkmcnt(0)
  s_barrier
  ds_read_b64_tr_b16 v[60:61], v15 offset:24576
  ds_read_b64_tr_b16 v[62:63], v15 offset:25088
  v_mfma_f32_16x16x32_bf16 v[36:39], v[96:99], v[88:91], v[36:39]
  ds_read_b128 v[64:67], v21 offset:24576
  ds_read_b128 v[68:71], v21 offset:26624
  v_mfma_f32_16x16x32_bf16 v[40:43], v[96:99], v[92:95], v[40:43]
  ds_read_b64_tr_b16 v[72:73], v16 offset:24576
  ds_read_b64_tr_b16 v[74:75], v16 offset:25088
  v_mfma_f32_16x16x32_bf16 v[44:47], v[100:103], v[88:91], v[44:47]
  ds_read_b64_tr_b16 v[76:77], v17 offset:24576
  ds_read_b64_tr_b16 v[78:79], v17 offset:25088
  v_mfma_f32_16x16x32_bf16 v[48:51], v[100:103], v[92:95], v[48:51]
  ds_read_b64_tr_b16 v[80:81], v18 offset:24576
  v_mfma_f32_16x16x32_bf16 v[52:55], v[104:107], v[88:91], v[52:55]
  ds_read_b64_tr_b16 v[82:83], v18 offset:25088
  v_mfma_f32_16x16x32_bf16 v[56:59], v[104:107], v[92:95], v[56:59]
  s_and_b32 s58, s2, 7
  s_lshr_b32 s61, s2, 3
  s_mov_b32 s64, s82
  s_mov_b32 s65, s83
  s_mov_b32 s66, 8388608
  s_mov_b32 s67, 0x20000
  s_lshl_b32 s48, s61, 8
  v_add_u32 v3, s48, v0
  v_lshrrev_b32 v4, 4, v3
  v_and_b32 v3, 15, v3
  v_lshlrev_b32 v4, 12, v4
  v_lshl_add_u32 v4, v3, 7, v4
  s_lshr_b32 s48, s58, 1
  s_lshl_b32 s48, s48, 21
  s_and_b32 s49, s58, 1
  s_lshl_b32 s49, s49, 11
  s_add_u32 s48, s48, s49
  buffer_load_dword v246, v4, s[64:67], s48 offen
  s_mul_i32 s48, s61, 72
  v_add_u32 v3, s48, v0
  v_mul_u32_u24 v4, 7282, v3
  v_lshrrev_b32 v4, 16, v4
  v_mul_u32_u24 v5, 9, v4
  v_sub_u32 v5, v3, v5
  v_and_b32 v6, 127, v4
  v_lshlrev_b32 v6, 13, v6
  v_lshl_add_u32 v6, v5, 7, v6
  v_lshrrev_b32 v4, 7, v4
  s_and_b32 s48, s58, 3
  s_lshl_b32 s48, s48, 8
  s_lshr_b32 s49, s58, 2
  s_add_u32 s48, s48, s49
  s_lshl_b32 s48, s48, 12
  v_mov_b32 v5, 0x40000000
  v_cmp_gt_u32 vcc, 72, v0
  s_nop 1
  v_cndmask_b32 v6, v5, v6, vcc
  v_cmp_eq_u32 vcc, 0, v4
  s_nop 1
  v_cndmask_b32 v7, v5, v6, vcc
  v_cndmask_b32 v8, v6, v5, vcc
  s_mov_b32 s64, s70
  s_mov_b32 s65, s71
  s_mov_b32 s66, 8388608
  s_mov_b32 s67, 0x20000
  buffer_load_dword v244, v7, s[64:67], s48 offen
  s_mov_b32 s64, s72
  s_mov_b32 s65, s73
  s_mov_b32 s66, 8388608
  s_mov_b32 s67, 0x20000
  buffer_load_dword v245, v8, s[64:67], s48 offen
  s_waitcnt lgkmcnt(7)
  v_mfma_f32_16x16x32_bf16 v[28:31], v[60:63], v[64:67], v[28:31]
  ds_read_b64_tr_b16 v[84:85], v15 offset:28672
  ds_read_b64_tr_b16 v[86:87], v15 offset:29184
  s_waitcnt lgkmcnt(8)
  v_mfma_f32_16x16x32_bf16 v[32:35], v[60:63], v[68:71], v[32:35]
  ds_read_b128 v[88:91], v22 offset:24576
  ds_read_b128 v[92:95], v22 offset:26624
  s_waitcnt lgkmcnt(8)
  v_mfma_f32_16x16x32_bf16 v[36:39], v[72:75], v[64:67], v[36:39]
  ds_read_b64_tr_b16 v[96:97], v16 offset:28672
  ds_read_b64_tr_b16 v[98:99], v16 offset:29184
  v_mfma_f32_16x16x32_bf16 v[40:43], v[72:75], v[68:71], v[40:43]
  ds_read_b64_tr_b16 v[100:101], v17 offset:28672
  ds_read_b64_tr_b16 v[102:103], v17 offset:29184
  s_waitcnt lgkmcnt(10)
  v_mfma_f32_16x16x32_bf16 v[44:47], v[76:79], v[64:67], v[44:47]
  ds_read_b64_tr_b16 v[104:105], v18 offset:28672
  v_mfma_f32_16x16x32_bf16 v[48:51], v[76:79], v[68:71], v[48:51]
  ds_read_b64_tr_b16 v[106:107], v18 offset:29184
  s_waitcnt lgkmcnt(10)
  v_mfma_f32_16x16x32_bf16 v[52:55], v[80:83], v[64:67], v[52:55]
  v_mfma_f32_16x16x32_bf16 v[56:59], v[80:83], v[68:71], v[56:59]
  s_waitcnt lgkmcnt(7)
  v_mfma_f32_16x16x32_bf16 v[28:31], v[84:87], v[88:91], v[28:31]
  s_waitcnt lgkmcnt(6)
  v_mfma_f32_16x16x32_bf16 v[32:35], v[84:87], v[92:95], v[32:35]
  s_waitcnt lgkmcnt(0)
  s_barrier
  ds_read_b64_tr_b16 v[60:61], v11 offset:0
  ds_read_b64_tr_b16 v[62:63], v11 offset:512
  v_mfma_f32_16x16x32_bf16 v[36:39], v[96:99], v[88:91], v[36:39]
  ds_read_b128 v[64:67], v19 offset:0
  ds_read_b128 v[68:71], v19 offset:2048
  v_mfma_f32_16x16x32_bf16 v[40:43], v[96:99], v[92:95], v[40:43]
  ds_read_b64_tr_b16 v[72:73], v12 offset:0
  ds_read_b64_tr_b16 v[74:75], v12 offset:512
  v_mfma_f32_16x16x32_bf16 v[44:47], v[100:103], v[88:91], v[44:47]
  ds_read_b64_tr_b16 v[76:77], v13 offset:0
  ds_read_b64_tr_b16 v[78:79], v13 offset:512
  v_mfma_f32_16x16x32_bf16 v[48:51], v[100:103], v[92:95], v[48:51]
  ds_read_b64_tr_b16 v[80:81], v14 offset:0
  v_mfma_f32_16x16x32_bf16 v[52:55], v[104:107], v[88:91], v[52:55]
  ds_read_b64_tr_b16 v[82:83], v14 offset:512
  v_mfma_f32_16x16x32_bf16 v[56:59], v[104:107], v[92:95], v[56:59]
  s_waitcnt lgkmcnt(7)
  v_mfma_f32_16x16x32_bf16 v[28:31], v[60:63], v[64:67], v[28:31]
  ds_read_b64_tr_b16 v[84:85], v11 offset:4096
  ds_read_b64_tr_b16 v[86:87], v11 offset:4608
  s_waitcnt lgkmcnt(8)
  v_mfma_f32_16x16x32_bf16 v[32:35], v[60:63], v[68:71], v[32:35]
  ds_read_b128 v[88:91], v20 offset:0
  ds_read_b128 v[92:95], v20 offset:2048
  s_waitcnt lgkmcnt(8)
  v_mfma_f32_16x16x32_bf16 v[36:39], v[72:75], v[64:67], v[36:39]
  ds_read_b64_tr_b16 v[96:97], v12 offset:4096
  ds_read_b64_tr_b16 v[98:99], v12 offset:4608
  v_mfma_f32_16x16x32_bf16 v[40:43], v[72:75], v[68:71], v[40:43]
  ds_read_b64_tr_b16 v[100:101], v13 offset:4096
  ds_read_b64_tr_b16 v[102:103], v13 offset:4608
  s_waitcnt lgkmcnt(10)
  v_mfma_f32_16x16x32_bf16 v[44:47], v[76:79], v[64:67], v[44:47]
  ds_read_b64_tr_b16 v[104:105], v14 offset:4096
  v_mfma_f32_16x16x32_bf16 v[48:51], v[76:79], v[68:71], v[48:51]
  ds_read_b64_tr_b16 v[106:107], v14 offset:4608
  s_waitcnt lgkmcnt(10)
  v_mfma_f32_16x16x32_bf16 v[52:55], v[80:83], v[64:67], v[52:55]
  v_mfma_f32_16x16x32_bf16 v[56:59], v[80:83], v[68:71], v[56:59]
  s_waitcnt lgkmcnt(7)
  v_mfma_f32_16x16x32_bf16 v[28:31], v[84:87], v[88:91], v[28:31]
  s_waitcnt lgkmcnt(6)
  v_mfma_f32_16x16x32_bf16 v[32:35], v[84:87], v[92:95], v[32:35]
  s_waitcnt lgkmcnt(0)
  s_barrier
  ds_read_b64_tr_b16 v[60:61], v11 offset:24576
  ds_read_b64_tr_b16 v[62:63], v11 offset:25088
  v_mfma_f32_16x16x32_bf16 v[36:39], v[96:99], v[88:91], v[36:39]
  ds_read_b128 v[64:67], v19 offset:24576
  ds_read_b128 v[68:71], v19 offset:26624
  v_mfma_f32_16x16x32_bf16 v[40:43], v[96:99], v[92:95], v[40:43]
  ds_read_b64_tr_b16 v[72:73], v12 offset:24576
  ds_read_b64_tr_b16 v[74:75], v12 offset:25088
  v_mfma_f32_16x16x32_bf16 v[44:47], v[100:103], v[88:91], v[44:47]
  ds_read_b64_tr_b16 v[76:77], v13 offset:24576
  ds_read_b64_tr_b16 v[78:79], v13 offset:25088
  v_mfma_f32_16x16x32_bf16 v[48:51], v[100:103], v[92:95], v[48:51]
  ds_read_b64_tr_b16 v[80:81], v14 offset:24576
  v_mfma_f32_16x16x32_bf16 v[52:55], v[104:107], v[88:91], v[52:55]
  ds_read_b64_tr_b16 v[82:83], v14 offset:25088
  v_mfma_f32_16x16x32_bf16 v[56:59], v[104:107], v[92:95], v[56:59]
  s_waitcnt lgkmcnt(7)
  v_mfma_f32_16x16x32_bf16 v[28:31], v[60:63], v[64:67], v[28:31]
  ds_read_b64_tr_b16 v[84:85], v11 offset:28672
  ds_read_b64_tr_b16 v[86:87], v11 offset:29184
  s_waitcnt lgkmcnt(8)
  v_mfma_f32_16x16x32_bf16 v[32:35], v[60:63], v[68:71], v[32:35]
  ds_read_b128 v[88:91], v20 offset:24576
  ds_read_b128 v[92:95], v20 offset:26624
  s_waitcnt lgkmcnt(8)
  v_mfma_f32_16x16x32_bf16 v[36:39], v[72:75], v[64:67], v[36:39]
  ds_read_b64_tr_b16 v[96:97], v12 offset:28672
  ds_read_b64_tr_b16 v[98:99], v12 offset:29184
  v_mfma_f32_16x16x32_bf16 v[40:43], v[72:75], v[68:71], v[40:43]
  ds_read_b64_tr_b16 v[100:101], v13 offset:28672
  ds_read_b64_tr_b16 v[102:103], v13 offset:29184
  s_waitcnt lgkmcnt(10)
  v_mfma_f32_16x16x32_bf16 v[44:47], v[76:79], v[64:67], v[44:47]
  ds_read_b64_tr_b16 v[104:105], v14 offset:28672
  v_mfma_f32_16x16x32_bf16 v[48:51], v[76:79], v[68:71], v[48:51]
  ds_read_b64_tr_b16 v[106:107], v14 offset:29184
  s_waitcnt lgkmcnt(10)
  v_mfma_f32_16x16x32_bf16 v[52:55], v[80:83], v[64:67], v[52:55]
  v_mfma_f32_16x16x32_bf16 v[56:59], v[80:83], v[68:71], v[56:59]
  s_waitcnt lgkmcnt(7)
  v_mfma_f32_16x16x32_bf16 v[28:31], v[84:87], v[88:91], v[28:31]
  s_waitcnt lgkmcnt(6)
  v_mfma_f32_16x16x32_bf16 v[32:35], v[84:87], v[92:95], v[32:35]
  s_waitcnt lgkmcnt(4)
  v_mfma_f32_16x16x32_bf16 v[36:39], v[96:99], v[88:91], v[36:39]
  v_mfma_f32_16x16x32_bf16 v[40:43], v[96:99], v[92:95], v[40:43]
  s_waitcnt lgkmcnt(2)
  v_mfma_f32_16x16x32_bf16 v[44:47], v[100:103], v[88:91], v[44:47]
  v_mfma_f32_16x16x32_bf16 v[48:51], v[100:103], v[92:95], v[48:51]
  s_waitcnt lgkmcnt(0)
  v_mfma_f32_16x16x32_bf16 v[52:55], v[104:107], v[88:91], v[52:55]
  v_mfma_f32_16x16x32_bf16 v[56:59], v[104:107], v[92:95], v[56:59]
  s_nop 4
  v_pk_mul_f32 v[108:109], v[28:29], v[28:29]
  v_pk_mul_f32 v[110:111], v[30:31], v[30:31]
  v_pk_mul_f32 v[112:113], v[32:33], v[32:33]
  v_pk_mul_f32 v[114:115], v[34:35], v[34:35]
  v_pk_mul_f32 v[116:117], v[36:37], v[36:37]
  v_pk_mul_f32 v[118:119], v[38:39], v[38:39]
  v_pk_mul_f32 v[120:121], v[40:41], v[40:41]
  v_pk_mul_f32 v[122:123], v[42:43], v[42:43]
  v_pk_fma_f32 v[108:109], v[108:109], s[36:37], v[24:25]
  v_pk_fma_f32 v[110:111], v[110:111], s[36:37], v[24:25]
  v_pk_fma_f32 v[112:113], v[112:113], s[36:37], v[24:25]
  v_pk_fma_f32 v[114:115], v[114:115], s[36:37], v[24:25]
  v_pk_fma_f32 v[116:117], v[116:117], s[36:37], v[24:25]
  v_pk_fma_f32 v[118:119], v[118:119], s[36:37], v[24:25]
  v_pk_fma_f32 v[120:121], v[120:121], s[36:37], v[24:25]
  v_pk_fma_f32 v[122:123], v[122:123], s[36:37], v[24:25]
  v_pk_mul_f32 v[108:109], v[28:29], v[108:109]
  v_pk_mul_f32 v[110:111], v[30:31], v[110:111]
  v_pk_mul_f32 v[112:113], v[32:33], v[112:113]
  v_pk_mul_f32 v[114:115], v[34:35], v[114:115]
  v_pk_mul_f32 v[116:117], v[36:37], v[116:117]
  v_pk_mul_f32 v[118:119], v[38:39], v[118:119]
  v_pk_mul_f32 v[120:121], v[40:41], v[120:121]
  v_pk_mul_f32 v[122:123], v[42:43], v[122:123]
  v_exp_f32 v108, v108
  v_exp_f32 v109, v109
  v_exp_f32 v110, v110
  v_exp_f32 v111, v111
  v_exp_f32 v112, v112
  v_exp_f32 v113, v113
  v_exp_f32 v114, v114
  v_exp_f32 v115, v115
  v_exp_f32 v116, v116
  v_exp_f32 v117, v117
  v_exp_f32 v118, v118
  v_exp_f32 v119, v119
  v_exp_f32 v120, v120
  v_exp_f32 v121, v121
  v_exp_f32 v122, v122
  v_exp_f32 v123, v123
  v_pk_add_f32 v[108:109], v[108:109], s[38:39]
  v_pk_add_f32 v[110:111], v[110:111], s[38:39]
  v_pk_add_f32 v[112:113], v[112:113], s[38:39]
  v_pk_add_f32 v[114:115], v[114:115], s[38:39]
  v_pk_add_f32 v[116:117], v[116:117], s[38:39]
  v_pk_add_f32 v[118:119], v[118:119], s[38:39]
  v_pk_add_f32 v[120:121], v[120:121], s[38:39]
  v_pk_add_f32 v[122:123], v[122:123], s[38:39]
  v_rcp_f32 v108, v108
  v_rcp_f32 v109, v109
  v_rcp_f32 v110, v110
  v_rcp_f32 v111, v111
  v_rcp_f32 v112, v112
  v_rcp_f32 v113, v113
  v_rcp_f32 v114, v114
  v_rcp_f32 v115, v115
  v_rcp_f32 v116, v116
  v_rcp_f32 v117, v117
  v_rcp_f32 v118, v118
  v_rcp_f32 v119, v119
  v_rcp_f32 v120, v120
  v_rcp_f32 v121, v121
  v_rcp_f32 v122, v122
  v_rcp_f32 v123, v123
  v_pk_mul_f32 v[28:29], v[28:29], v[108:109]
  v_pk_mul_f32 v[30:31], v[30:31], v[110:111]
  v_pk_mul_f32 v[32:33], v[32:33], v[112:113]
  v_pk_mul_f32 v[34:35], v[34:35], v[114:115]
  v_pk_mul_f32 v[36:37], v[36:37], v[116:117]
  v_pk_mul_f32 v[38:39], v[38:39], v[118:119]
  v_pk_mul_f32 v[40:41], v[40:41], v[120:121]
  v_pk_mul_f32 v[42:43], v[42:43], v[122:123]
  v_pk_add_f32 v[124:125], v[28:29], v[30:31]
  v_pk_mul_f32 v[132:133], v[28:29], v[28:29]
  v_pk_add_f32 v[126:127], v[32:33], v[34:35]
  v_pk_mul_f32 v[134:135], v[32:33], v[32:33]
  v_pk_add_f32 v[124:125], v[124:125], v[36:37]
  v_pk_fma_f32 v[132:133], v[30:31], v[30:31], v[132:133]
  v_pk_add_f32 v[126:127], v[126:127], v[40:41]
  v_pk_fma_f32 v[134:135], v[34:35], v[34:35], v[134:135]
  v_pk_add_f32 v[124:125], v[124:125], v[38:39]
  v_pk_fma_f32 v[132:133], v[36:37], v[36:37], v[132:133]
  v_pk_add_f32 v[126:127], v[126:127], v[42:43]
  v_pk_fma_f32 v[134:135], v[40:41], v[40:41], v[134:135]
  v_pk_fma_f32 v[132:133], v[38:39], v[38:39], v[132:133]
  v_add_f32 v124, v124, v125
  v_pk_fma_f32 v[134:135], v[42:43], v[42:43], v[134:135]
  v_add_f32 v126, v126, v127
  v_add_f32 v132, v132, v133
  v_add_f32 v134, v134, v135
  s_nop 1
  v_permlane16_swap_b32 v124, v126
  v_permlane16_swap_b32 v132, v134
  s_nop 0
  v_add_f32 v124, v124, v126
  v_add_f32 v132, v132, v134
  v_mov_b32 v126, v124
  v_mov_b32 v134, v132
  s_nop 1
  v_permlane32_swap_b32 v124, v126
  v_permlane32_swap_b32 v132, v134
  s_nop 0
  v_add_f32 v108, v124, v126
  v_add_f32 v109, v132, v134
  v_add_u32 v3, v1, v10
  v_lshlrev_b32 v3, 3, v3
  s_mul_i32 s44, s17, 14
  s_add_u32 s44, s44, 13
  s_lshl_b32 s44, s44, 10
  v_mov_b32 v4, 0x40000000
  v_cmp_gt_u32 vcc, 32, v1
  s_nop 1
  v_cndmask_b32 v4, v4, v3, vcc
  buffer_store_dwordx2 v[108:109], v4, s[24:27], s44 offen sc1
  s_nop 1
  v_pk_mul_f32 v[108:109], v[44:45], v[44:45]
  v_pk_mul_f32 v[110:111], v[46:47], v[46:47]
  v_pk_mul_f32 v[112:113], v[48:49], v[48:49]
  v_pk_mul_f32 v[114:115], v[50:51], v[50:51]
  v_pk_mul_f32 v[116:117], v[52:53], v[52:53]
  v_pk_mul_f32 v[118:119], v[54:55], v[54:55]
  v_pk_mul_f32 v[120:121], v[56:57], v[56:57]
  v_pk_mul_f32 v[122:123], v[58:59], v[58:59]
  v_pk_fma_f32 v[108:109], v[108:109], s[36:37], v[24:25]
  v_pk_fma_f32 v[110:111], v[110:111], s[36:37], v[24:25]
  v_pk_fma_f32 v[112:113], v[112:113], s[36:37], v[24:25]
  v_pk_fma_f32 v[114:115], v[114:115], s[36:37], v[24:25]
  v_pk_fma_f32 v[116:117], v[116:117], s[36:37], v[24:25]
  v_pk_fma_f32 v[118:119], v[118:119], s[36:37], v[24:25]
  v_pk_fma_f32 v[120:121], v[120:121], s[36:37], v[24:25]
  v_pk_fma_f32 v[122:123], v[122:123], s[36:37], v[24:25]
  v_pk_mul_f32 v[108:109], v[44:45], v[108:109]
  v_pk_mul_f32 v[110:111], v[46:47], v[110:111]
  v_pk_mul_f32 v[112:113], v[48:49], v[112:113]
  v_pk_mul_f32 v[114:115], v[50:51], v[114:115]
  v_pk_mul_f32 v[116:117], v[52:53], v[116:117]
  v_pk_mul_f32 v[118:119], v[54:55], v[118:119]
  v_pk_mul_f32 v[120:121], v[56:57], v[120:121]
  v_pk_mul_f32 v[122:123], v[58:59], v[122:123]
  v_exp_f32 v108, v108
  v_exp_f32 v109, v109
  v_exp_f32 v110, v110
  v_exp_f32 v111, v111
  v_exp_f32 v112, v112
  v_exp_f32 v113, v113
  v_exp_f32 v114, v114
  v_exp_f32 v115, v115
  v_exp_f32 v116, v116
  v_exp_f32 v117, v117
  v_exp_f32 v118, v118
  v_exp_f32 v119, v119
  v_exp_f32 v120, v120
  v_exp_f32 v121, v121
  v_exp_f32 v122, v122
  v_exp_f32 v123, v123
  v_pk_add_f32 v[108:109], v[108:109], s[38:39]
  v_pk_add_f32 v[110:111], v[110:111], s[38:39]
  v_pk_add_f32 v[112:113], v[112:113], s[38:39]
  v_pk_add_f32 v[114:115], v[114:115], s[38:39]
  v_pk_add_f32 v[116:117], v[116:117], s[38:39]
  v_pk_add_f32 v[118:119], v[118:119], s[38:39]
  v_pk_add_f32 v[120:121], v[120:121], s[38:39]
  v_pk_add_f32 v[122:123], v[122:123], s[38:39]
  v_rcp_f32 v108, v108
  v_rcp_f32 v109, v109
  v_rcp_f32 v110, v110
  v_rcp_f32 v111, v111
  v_rcp_f32 v112, v112
  v_rcp_f32 v113, v113
  v_rcp_f32 v114, v114
  v_rcp_f32 v115, v115
  v_rcp_f32 v116, v116
  v_rcp_f32 v117, v117
  v_rcp_f32 v118, v118
  v_rcp_f32 v119, v119
  v_rcp_f32 v120, v120
  v_rcp_f32 v121, v121
  v_rcp_f32 v122, v122
  v_rcp_f32 v123, v123
  v_pk_mul_f32 v[44:45], v[44:45], v[108:109]
  v_pk_mul_f32 v[46:47], v[46:47], v[110:111]
  v_pk_mul_f32 v[48:49], v[48:49], v[112:113]
  v_pk_mul_f32 v[50:51], v[50:51], v[114:115]
  v_pk_mul_f32 v[52:53], v[52:53], v[116:117]
  v_pk_mul_f32 v[54:55], v[54:55], v[118:119]
  v_pk_mul_f32 v[56:57], v[56:57], v[120:121]
  v_pk_mul_f32 v[58:59], v[58:59], v[122:123]
  v_cvt_pk_bf16_f32 v140, v44, v45
  v_cvt_pk_bf16_f32 v141, v46, v47
  v_cvt_pk_bf16_f32 v142, v48, v49
  v_cvt_pk_bf16_f32 v143, v50, v51
  s_nop 1
  v_permlane16_swap_b32 v140, v142
  v_permlane16_swap_b32 v141, v143
  s_add_u32 s48, s45, 0
  buffer_store_dwordx4 v[140:143], v23, s[28:31], s48 offen offset:0 sc1
  s_nop 1
  v_cvt_pk_bf16_f32 v140, v52, v53
  v_cvt_pk_bf16_f32 v141, v54, v55
  v_cvt_pk_bf16_f32 v142, v56, v57
  v_cvt_pk_bf16_f32 v143, v58, v59
  s_nop 1
  v_permlane16_swap_b32 v140, v142
  v_permlane16_swap_b32 v141, v143
  s_add_u32 s48, s45, 69632
  buffer_store_dwordx4 v[140:143], v23, s[28:31], s48 offen offset:0 sc1
  s_nop 1
  v_and_b32 v3, 127, v0
  v_lshlrev_b32 v3, 3, v3
  v_lshrrev_b32 v4, 7, v0
  v_mul_u32_u24 v4, 7168, v4
  v_add_u32 v3, v3, v4
  s_mul_i32 s44, s17, 14336
  s_mov_b32 s49, 0
poll_9:
  buffer_load_dwordx2 v[108:109], v3, s[24:27], s44 offen offset:0 sc1
  buffer_load_dwordx2 v[110:111], v3, s[24:27], s44 offen offset:1024 sc1
  buffer_load_dwordx2 v[112:113], v3, s[24:27], s44 offen offset:2048 sc1
  buffer_load_dwordx2 v[114:115], v3, s[24:27], s44 offen offset:3072 sc1
  s_add_u32 s48, s44, 4096
  buffer_load_dwordx2 v[116:117], v3, s[24:27], s48 offen offset:0 sc1
  s_add_u32 s48, s44, 4096
  buffer_load_dwordx2 v[118:119], v3, s[24:27], s48 offen offset:1024 sc1
  s_add_u32 s48, s44, 4096
  buffer_load_dwordx2 v[120:121], v3, s[24:27], s48 offen offset:2048 sc1
  s_waitcnt vmcnt(0)
  v_cmp_ne_u32 vcc, -1, v108
  v_cmp_ne_u32 s[46:47], -1, v110
  s_and_b64 vcc, vcc, s[46:47]
  v_cmp_ne_u32 s[46:47], -1, v112
  s_and_b64 vcc, vcc, s[46:47]
  v_cmp_ne_u32 s[46:47], -1, v114
  s_and_b64 vcc, vcc, s[46:47]
  v_cmp_ne_u32 s[46:47], -1, v116
  s_and_b64 vcc, vcc, s[46:47]
  v_cmp_ne_u32 s[46:47], -1, v118
  s_and_b64 vcc, vcc, s[46:47]
  v_cmp_ne_u32 s[46:47], -1, v120
  s_and_b64 vcc, vcc, s[46:47]
  s_add_u32 s49, s49, 1
  s_cmp_eq_u64 vcc, exec
  s_cbranch_scc1 polldone_10
  s_cmp_lt_u32 s49, 20000
  s_cbranch_scc1 poll_9
polldone_10:
  v_pk_add_f32 v[108:109], v[108:109], v[110:111]
  v_pk_add_f32 v[108:109], v[108:109], v[112:113]
  v_pk_add_f32 v[108:109], v[108:109], v[114:115]
  v_pk_add_f32 v[108:109], v[108:109], v[116:117]
  v_pk_add_f32 v[108:109], v[108:109], v[118:119]
  v_pk_add_f32 v[108:109], v[108:109], v[120:121]
  v_lshlrev_b32 v4, 3, v0
  v_add_u32 v4, 131072, v4
  ds_write_b64 v4, v[108:109] offset:4096
  s_waitcnt lgkmcnt(0)
  s_barrier
  v_and_b32 v3, 15, v1
  v_add_u32 v3, v3, v10
  v_lshlrev_b32 v3, 3, v3
  v_add_u32 v3, 131072, v3
  ds_read_b64 v[108:109], v3 offset:4096
  ds_read_b64 v[110:111], v3 offset:5120
  ds_read_b64 v[112:113], v3 offset:4224
  ds_read_b64 v[114:115], v3 offset:5248
  s_waitcnt lgkmcnt(0)
  v_pk_add_f32 v[108:109], v[108:109], v[110:111]
  v_pk_add_f32 v[112:113], v[112:113], v[114:115]
  v_mul_f32 v108, 0x3a97b426, v108
  v_mul_f32 v109, 0x3a97b426, v109
  v_mul_f32 v112, 0x3a97b426, v112
  v_mul_f32 v113, 0x3a97b426, v113
  v_fma_f32 v109, -v108, v108, v109
  v_fma_f32 v113, -v112, v112, v113
  v_max_f32 v109, 0, v109
  v_max_f32 v113, 0, v113
  v_add_f32 v109, 0x3727c5ac, v109
  v_add_f32 v113, 0x3727c5ac, v113
  v_rsq_f32 v124, v109
  v_rsq_f32 v126, v113
  s_nop 0
  v_mov_b32 v125, v124
  v_mul_f32 v132, v108, v124
  v_sub_f32 v132, 0, v132
  v_mov_b32 v133, v132
  v_mov_b32 v127, v126
  v_mul_f32 v134, v112, v126
  v_sub_f32 v134, 0, v134
  v_mov_b32 v135, v134
  v_pk_fma_f32 v[28:29], v[28:29], v[124:125], v[132:133]
  v_pk_fma_f32 v[30:31], v[30:31], v[124:125], v[132:133]
  v_pk_fma_f32 v[32:33], v[32:33], v[126:127], v[134:135]
  v_pk_fma_f32 v[34:35], v[34:35], v[126:127], v[134:135]
  v_cvt_pk_bf16_f32 v140, v28, v29
  v_cvt_pk_bf16_f32 v141, v30, v31
  v_cvt_pk_bf16_f32 v142, v32, v33
  v_cvt_pk_bf16_f32 v143, v34, v35
  s_nop 1
  v_permlane16_swap_b32 v140, v142
  v_permlane16_swap_b32 v141, v143
  s_add_u32 s48, s51, 0
  buffer_store_dwordx4 v[140:143], v23, s[40:43], s48 offen offset:0 sc1
  s_nop 1
  v_pk_fma_f32 v[36:37], v[36:37], v[124:125], v[132:133]
  v_pk_fma_f32 v[38:39], v[38:39], v[124:125], v[132:133]
  v_pk_fma_f32 v[40:41], v[40:41], v[126:127], v[134:135]
  v_pk_fma_f32 v[42:43], v[42:43], v[126:127], v[134:135]
  v_cvt_pk_bf16_f32 v140, v36, v37
  v_cvt_pk_bf16_f32 v141, v38, v39
  v_cvt_pk_bf16_f32 v142, v40, v41
  v_cvt_pk_bf16_f32 v143, v42, v43
  s_nop 1
  v_permlane16_swap_b32 v140, v142
  v_permlane16_swap_b32 v141, v143
  s_add_u32 s48, s51, 69632
  buffer_store_dwordx4 v[140:143], v23, s[40:43], s48 offen offset:0 sc1
  s_nop 1
  s_add_u32 s64, s92, 33030144
  s_addc_u32 s65, s93, 0
  s_mov_b32 s66, 20480
  s_mov_b32 s67, 0x20000
  s_add_u32 s98, s94, 2
  v_mov_b32 v108, s98
  v_mov_b32 v109, 0x40000000
  v_cmp_gt_u32 vcc, 16, v0
  s_lshl_b32 s98, s2, 2
  v_mul_u32_u24 v110, 1280, v0
  v_cndmask_b32 v109, v109, v110, vcc
  v_readfirstlane_b32 s99, v0
  s_waitcnt vmcnt(0)
  s_barrier
  s_cmp_lg_u32 s99, 0
  s_cbranch_scc1 noflag_11
  buffer_store_dword v108, v109, s[64:67], s98 offen sc1
noflag_11:
  s_branch PH2
P1_dbl_ld:
  v_and_b32 v1, 63, v0
  v_bfe_u32 v2, v0, 6, 2
  s_nop 0
  v_readfirstlane_b32 s16, v2
  s_lshl_b32 s21, s20, 6
  s_lshl_b32 s23, s50, 6
  s_add_u32 s23, s23, 1728
  v_mul_u32_u24 v3, 128, v2
  v_add_u32 v3, v3, v1
  v_and_b32 v4, 7, v3
  v_lshrrev_b32 v3, 3, v3
  v_bfe_u32 v8, v3, 1, 1
  v_lshlrev_b32 v8, 2, v8
  v_xor_b32 v4, v4, v8
  v_bfe_u32 v8, v3, 3, 1
  v_lshlrev_b32 v8, 1, v8
  v_xor_b32 v4, v4, v8
  v_mul_u32_u24 v9, 3456, v3
  v_lshrrev_b32 v6, 3, v4
  v_lshl_add_u32 v9, v6, 6, v9
  v_and_b32 v6, 3, v4
  v_lshl_add_u32 v9, v6, 4, v9
  v_bfe_u32 v6, v4, 2, 1
  v_cmp_eq_u32 vcc, 1, v6
  v_mov_b32 v6, s23
  v_mov_b32 v7, s21
  v_cndmask_b32 v6, v6, v7, vcc
  v_add_u32 v9, v9, v6
  v_mul_u32_u24 v3, 128, v2
  v_add_u32 v3, v3, v1
  v_add_u32 v3, 64, v3
  v_and_b32 v4, 7, v3
  v_lshrrev_b32 v3, 3, v3
  v_bfe_u32 v8, v3, 1, 1
  v_lshlrev_b32 v8, 2, v8
  v_xor_b32 v4, v4, v8
  v_bfe_u32 v8, v3, 3, 1
  v_lshlrev_b32 v8, 1, v8
  v_xor_b32 v4, v4, v8
  v_mul_u32_u24 v10, 3456, v3
  v_lshrrev_b32 v6, 3, v4
  v_lshl_add_u32 v10, v6, 6, v10
  v_and_b32 v6, 3, v4
  v_lshl_add_u32 v10, v6, 4, v10
  v_bfe_u32 v6, v4, 2, 1
  v_cmp_eq_u32 vcc, 1, v6
  v_mov_b32 v6, s23
  v_mov_b32 v7, s21
  v_cndmask_b32 v6, v6, v7, vcc
  v_add_u32 v10, v10, v6
  s_mul_i32 s22, s19, 1280
  v_mul_u32_u24 v3, 32, v2
  v_lshrrev_b32 v4, 3, v1
  v_add3_u32 v3, v3, v4, 0
  v_bfe_u32 v4, v3, 1, 3
  v_and_b32 v8, 7, v1
  v_xor_b32 v4, v4, v8
  v_mul_u32_u24 v11, 1280, v3
  v_lshl_add_u32 v11, v4, 4, v11
  v_add_u32 v11, s22, v11
  v_mul_u32_u24 v3, 32, v2
  v_lshrrev_b32 v4, 3, v1
  v_add3_u32 v3, v3, v4, 8
  v_bfe_u32 v4, v3, 1, 3
  v_and_b32 v8, 7, v1
  v_xor_b32 v4, v4, v8
  v_mul_u32_u24 v12, 1280, v3
  v_lshl_add_u32 v12, v4, 4, v12
  v_add_u32 v12, s22, v12
  v_mul_u32_u24 v3, 32, v2
  v_lshrrev_b32 v4, 3, v1
  v_add3_u32 v3, v3, v4, 16
  v_bfe_u32 v4, v3, 1, 3
  v_and_b32 v8, 7, v1
  v_xor_b32 v4, v4, v8
  v_mul_u32_u24 v13, 1280, v3
  v_lshl_add_u32 v13, v4, 4, v13
  v_add_u32 v13, s22, v13
  v_mul_u32_u24 v3, 32, v2
  v_lshrrev_b32 v4, 3, v1
  v_add3_u32 v3, v3, v4, 24
  v_bfe_u32 v4, v3, 1, 3
  v_and_b32 v8, 7, v1
  v_xor_b32 v4, v4, v8
  v_mul_u32_u24 v14, 1280, v3
  v_lshl_add_u32 v14, v4, 4, v14
  v_add_u32 v14, s22, v14
  s_mul_i32 s34, s16, 2048
  s_mul_i32 s35, s16, 4096
  s_mov_b32 s32, 0
  s_mov_b32 s33, 0
  s_waitcnt lgkmcnt(0)
  s_mov_b32 s24, s4
  s_mov_b32 s25, s5
  s_mov_b32 s26, 2211840
  s_mov_b32 s27, 0x20000
  s_mov_b32 s28, s6
  s_mov_b32 s29, s7
  s_mov_b32 s30, 2621440
  s_mov_b32 s31, 0x20000
  s_mov_b32 s97, 1
  s_cmp_lg_u32 s16, 0
  s_cbranch_scc1 pre_12
  s_add_u32 s64, s92, 33030144
  s_addc_u32 s65, s93, 0
  s_mov_b32 s66, 20480
  s_mov_b32 s67, 0x20000
  v_lshlrev_b32 v20, 4, v1
  s_and_b32 s98, s2, 15
  s_mul_i32 s98, s98, 1280
  v_add_u32 v20, s98, v20
  s_add_u32 s98, s94, 1
  s_mov_b32 s97, 0
pre_12:
  s_waitcnt vmcnt(0)
  s_barrier
  s_add_u32 m0, s34, 0
  s_nop 0
  buffer_load_dwordx4 v9, s[24:27], s32 offen  lds
  s_add_u32 m0, s34, 1024
  s_nop 0
  buffer_load_dwordx4 v10, s[24:27], s32 offen  lds
  s_add_u32 s32, s32, 221184
  s_add_u32 m0, s34, 24576
  s_nop 0
  buffer_load_dwordx4 v9, s[24:27], s32 offen  lds
  s_add_u32 m0, s34, 25600
  s_nop 0
  buffer_load_dwordx4 v10, s[24:27], s32 offen  lds
  s_add_u32 s32, s32, 221184
  s_add_u32 m0, s34, 49152
  s_nop 0
  buffer_load_dwordx4 v9, s[24:27], s32 offen  lds
  s_add_u32 m0, s34, 50176
  s_nop 0
  buffer_load_dwordx4 v10, s[24:27], s32 offen  lds
  s_add_u32 s32, s32, 221184
  s_add_u32 m0, s34, 73728
  s_nop 0
  buffer_load_dwordx4 v9, s[24:27], s32 offen  lds
  s_add_u32 m0, s34, 74752
  s_nop 0
  buffer_load_dwordx4 v10, s[24:27], s32 offen  lds
  s_add_u32 s32, s32, 221184
  s_cmp_eq_u32 s97, 1
  s_cbranch_scc1 pollskip_14
  s_mov_b32 s99, 0
poll_13:
  buffer_load_dwordx4 v[16:19], v20, s[64:67], 0 offen sc1
  s_waitcnt vmcnt(0)
  v_subrev_u32 v16, s98, v16
  v_subrev_u32 v17, s98, v17
  v_subrev_u32 v18, s98, v18
  v_subrev_u32 v19, s98, v19
  v_max_u32 v16, v16, v17
  v_max_u32 v18, v18, v19
  v_max_u32 v16, v16, v18
  v_cmp_ge_u32 vcc, 2, v16
  s_add_u32 s99, s99, 1
  s_cmp_eq_u64 vcc, exec
  s_cbranch_scc1 pollskip_14
  s_cmp_lt_u32 s99, 40000
  s_cbranch_scc1 poll_13
pollskip_14:
  s_barrier
  s_add_u32 m0, s35, 8192
  s_nop 0
  buffer_load_dwordx4 v11, s[28:31], s33 offen sc1 lds
  s_add_u32 m0, s35, 9216
  s_nop 0
  buffer_load_dwordx4 v12, s[28:31], s33 offen sc1 lds
  s_add_u32 m0, s35, 10240
  s_nop 0
  buffer_load_dwordx4 v13, s[28:31], s33 offen sc1 lds
  s_add_u32 m0, s35, 11264
  s_nop 0
  buffer_load_dwordx4 v14, s[28:31], s33 offen sc1 lds
  s_add_u32 s33, s33, 128
  s_add_u32 m0, s35, 32768
  s_nop 0
  buffer_load_dwordx4 v11, s[28:31], s33 offen sc1 lds
  s_add_u32 m0, s35, 33792
  s_nop 0
  buffer_load_dwordx4 v12, s[28:31], s33 offen sc1 lds
  s_add_u32 m0, s35, 34816
  s_nop 0
  buffer_load_dwordx4 v13, s[28:31], s33 offen sc1 lds
  s_add_u32 m0, s35, 35840
  s_nop 0
  buffer_load_dwordx4 v14, s[28:31], s33 offen sc1 lds
  s_add_u32 s33, s33, 128
  s_waitcnt vmcnt(4)
  s_barrier
  s_add_u32 m0, s35, 57344
  s_nop 0
  buffer_load_dwordx4 v11, s[28:31], s33 offen sc1 lds
  s_add_u32 m0, s35, 58368
  s_nop 0
  buffer_load_dwordx4 v12, s[28:31], s33 offen sc1 lds
  s_add_u32 m0, s35, 59392
  s_nop 0
  buffer_load_dwordx4 v13, s[28:31], s33 offen sc1 lds
  s_add_u32 m0, s35, 60416
  s_nop 0
  buffer_load_dwordx4 v14, s[28:31], s33 offen sc1 lds
  s_add_u32 s33, s33, 128
  s_add_u32 m0, s35, 81920
  s_nop 0
  buffer_load_dwordx4 v11, s[28:31], s33 offen sc1 lds
  s_add_u32 m0, s35, 82944
  s_nop 0
  buffer_load_dwordx4 v12, s[28:31], s33 offen sc1 lds
  s_add_u32 m0, s35, 83968
  s_nop 0
  buffer_load_dwordx4 v13, s[28:31], s33 offen sc1 lds
  s_add_u32 m0, s35, 84992
  s_nop 0
  buffer_load_dwordx4 v14, s[28:31], s33 offen sc1 lds
  s_add_u32 s33, s33, 128
  s_waitcnt vmcnt(8)
  s_barrier
  s_add_u32 m0, s34, 0
  s_nop 0
  buffer_load_dwordx4 v9, s[24:27], s32 offen  lds
  s_add_u32 m0, s34, 1024
  s_nop 0
  buffer_load_dwordx4 v10, s[24:27], s32 offen  lds
  s_add_u32 s32, s32, 221184
  s_add_u32 m0, s35, 8192
  s_nop 0
  buffer_load_dwordx4 v11, s[28:31], s33 offen sc1 lds
  s_add_u32 m0, s35, 9216
  s_nop 0
  buffer_load_dwordx4 v12, s[28:31], s33 offen sc1 lds
  s_add_u32 m0, s35, 10240
  s_nop 0
  buffer_load_dwordx4 v13, s[28:31], s33 offen sc1 lds
  s_add_u32 m0, s35, 11264
  s_nop 0
  buffer_load_dwordx4 v14, s[28:31], s33 offen sc1 lds
  s_add_u32 s33, s33, 128
  s_waitcnt vmcnt(10)
  s_barrier
  s_add_u32 m0, s34, 24576
  s_nop 0
  buffer_load_dwordx4 v9, s[24:27], s32 offen  lds
  s_add_u32 m0, s34, 25600
  s_nop 0
  buffer_load_dwordx4 v10, s[24:27], s32 offen  lds
  s_add_u32 s32, s32, 221184
  s_add_u32 m0, s35, 32768
  s_nop 0
  buffer_load_dwordx4 v11, s[28:31], s33 offen sc1 lds
  s_add_u32 m0, s35, 33792
  s_nop 0
  buffer_load_dwordx4 v12, s[28:31], s33 offen sc1 lds
  s_add_u32 m0, s35, 34816
  s_nop 0
  buffer_load_dwordx4 v13, s[28:31], s33 offen sc1 lds
  s_add_u32 m0, s35, 35840
  s_nop 0
  buffer_load_dwordx4 v14, s[28:31], s33 offen sc1 lds
  s_add_u32 s33, s33, 128
  s_waitcnt vmcnt(12)
  s_barrier
  s_add_u32 m0, s34, 49152
  s_nop 0
  buffer_load_dwordx4 v9, s[24:27], s32 offen  lds
  s_add_u32 m0, s34, 50176
  s_nop 0
  buffer_load_dwordx4 v10, s[24:27], s32 offen  lds
  s_add_u32 s32, s32, 221184
  s_add_u32 m0, s35, 57344
  s_nop 0
  buffer_load_dwordx4 v11, s[28:31], s33 offen sc1 lds
  s_add_u32 m0, s35, 58368
  s_nop 0
  buffer_load_dwordx4 v12, s[28:31], s33 offen sc1 lds
  s_add_u32 m0, s35, 59392
  s_nop 0
  buffer_load_dwordx4 v13, s[28:31], s33 offen sc1 lds
  s_add_u32 m0, s35, 60416
  s_nop 0
  buffer_load_dwordx4 v14, s[28:31], s33 offen sc1 lds
  s_add_u32 s33, s33, 128
  s_waitcnt vmcnt(12)
  s_barrier
  s_add_u32 m0, s34, 73728
  s_nop 0
  buffer_load_dwordx4 v9, s[24:27], s32 offen  lds
  s_add_u32 m0, s34, 74752
  s_nop 0
  buffer_load_dwordx4 v10, s[24:27], s32 offen  lds
  s_add_u32 s32, s32, 221184
  s_add_u32 m0, s35, 81920
  s_nop 0
  buffer_load_dwordx4 v11, s[28:31], s33 offen sc1 lds
  s_add_u32 m0, s35, 82944
  s_nop 0
  buffer_load_dwordx4 v12, s[28:31], s33 offen sc1 lds
  s_add_u32 m0, s35, 83968
  s_nop 0
  buffer_load_dwordx4 v13, s[28:31], s33 offen sc1 lds
  s_add_u32 m0, s35, 84992
  s_nop 0
  buffer_load_dwordx4 v14, s[28:31], s33 offen sc1 lds
  s_add_u32 s33, s33, 128
  s_waitcnt vmcnt(12)
  s_barrier
  s_add_u32 m0, s34, 0
  s_nop 0
  buffer_load_dwordx4 v9, s[24:27], s32 offen  lds
  s_add_u32 m0, s34, 1024
  s_nop 0
  buffer_load_dwordx4 v10, s[24:27], s32 offen  lds
  s_add_u32 s32, s32, 221184
  s_add_u32 m0, s35, 8192
  s_nop 0
  buffer_load_dwordx4 v11, s[28:31], s33 offen sc1 lds
  s_add_u32 m0, s35, 9216
  s_nop 0
  buffer_load_dwordx4 v12, s[28:31], s33 offen sc1 lds
  s_add_u32 m0, s35, 10240
  s_nop 0
  buffer_load_dwordx4 v13, s[28:31], s33 offen sc1 lds
  s_add_u32 m0, s35, 11264
  s_nop 0
  buffer_load_dwordx4 v14, s[28:31], s33 offen sc1 lds
  s_add_u32 s33, s33, 128
  s_waitcnt vmcnt(12)
  s_barrier
  s_add_u32 m0, s34, 24576
  s_nop 0
  buffer_load_dwordx4 v9, s[24:27], s32 offen  lds
  s_add_u32 m0, s34, 25600
  s_nop 0
  buffer_load_dwordx4 v10, s[24:27], s32 offen  lds
  s_add_u32 s32, s32, 221184
  s_add_u32 m0, s35, 32768
  s_nop 0
  buffer_load_dwordx4 v11, s[28:31], s33 offen sc1 lds
  s_add_u32 m0, s35, 33792
  s_nop 0
  buffer_load_dwordx4 v12, s[28:31], s33 offen sc1 lds
  s_add_u32 m0, s35, 34816
  s_nop 0
  buffer_load_dwordx4 v13, s[28:31], s33 offen sc1 lds
  s_add_u32 m0, s35, 35840
  s_nop 0
  buffer_load_dwordx4 v14, s[28:31], s33 offen sc1 lds
  s_add_u32 s33, s33, 128
  s_waitcnt vmcnt(12)
  s_barrier
  s_waitcnt vmcnt(6)
  s_barrier
  s_waitcnt vmcnt(0)
  s_barrier
  s_barrier
  s_branch PH2
P1_dft:
  s_sub_u32 s17, s15, 28
  s_lshl_b32 s18, s14, 2
  s_add_u32 s17, s17, s18
  s_lshr_b32 s18, s17, 3
  s_lshr_b32 s19, s17, 1
  s_and_b32 s19, s19, 3
  s_and_b32 s20, s17, 1
  v_readfirstlane_b32 s98, v0
  s_nop 3
  s_cmp_ge_u32 s98, 256
  s_cbranch_scc1 P1_dft_ld
  v_and_b32 v1, 63, v0
  v_bfe_u32 v2, v0, 6, 2
  s_nop 0
  v_readfirstlane_b32 s16, v2
  v_lshrrev_b32 v9, 1, v2
  v_mul_u32_u24 v9, 80, v9
  v_and_b32 v10, 1, v2
  v_mul_u32_u24 v10, 96, v10
  v_and_b32 v3, 15, v1
  v_add_u32 v3, v3, v9
  v_bfe_u32 v4, v3, 1, 3
  v_lshrrev_b32 v5, 4, v1
  v_xor_b32 v4, v4, v5
  v_lshlrev_b32 v4, 4, v4
  v_lshl_add_u32 v4, v3, 7, v4
  v_xor_b32 v11, 0, v4
  v_xor_b32 v12, 64, v4
  v_add_u32 v13, 45056, v11
  v_add_u32 v14, 45056, v12
  v_add_u32 v15, 90112, v11
  v_add_u32 v16, 90112, v12
  v_and_b32 v3, 15, v1
  v_add_u32 v3, v3, v10
  v_bfe_u32 v4, v3, 1, 3
  v_lshrrev_b32 v5, 4, v1
  v_xor_b32 v4, v4, v5
  v_lshlrev_b32 v4, 4, v4
  v_lshl_add_u32 v4, v3, 7, v4
  v_xor_b32 v17, 0, v4
  v_add_u32 v17, 20480, v17
  v_xor_b32 v18, 64, v4
  v_add_u32 v18, 20480, v18
  v_add_u32 v19, 45056, v17
  v_add_u32 v20, 45056, v18
  v_add_u32 v21, 90112, v17
  v_add_u32 v22, 90112, v18
  v_lshrrev_b32 v3, 5, v1
  v_lshrrev_b32 v4, 3, v9
  v_add_u32 v3, v3, v4
  v_mul_u32_u24 v23, 5632, v3
  v_and_b32 v3, 31, v1
  v_add_u32 v3, v3, v10
  v_lshl_add_u32 v23, v3, 4, v23
  s_mul_i32 s37, s19, 90112
  s_mul_i32 s38, s20, 2560
  s_add_u32 s37, s37, s38
  s_waitcnt lgkmcnt(0)
  s_mul_i32 s36, s18, 524288
  s_add_u32 s36, s36, 5242880
  s_add_u32 s24, s6, s36
  s_addc_u32 s25, s7, 0
  s_mov_b32 s26, 450560
  s_mov_b32 s27, 0x20000
  s_barrier
  s_barrier
  ds_read_b128 v[144:147], v11 offset:0
  ds_read_b128 v[148:151], v17 offset:0
  ds_read_b128 v[152:155], v17 offset:2048
  ds_read_b128 v[156:159], v17 offset:4096
  ds_read_b128 v[160:163], v17 offset:6144
  ds_read_b128 v[164:167], v17 offset:8192
  ds_read_b128 v[168:171], v17 offset:10240
  ds_read_b128 v[172:175], v11 offset:2048
  ds_read_b128 v[176:179], v11 offset:4096
  ds_read_b128 v[180:183], v11 offset:6144
  ds_read_b128 v[184:187], v11 offset:8192
  s_and_b32 s58, s2, 7
  s_lshr_b32 s61, s2, 3
  s_mov_b32 s64, s82
  s_mov_b32 s65, s83
  s_mov_b32 s66, 8388608
  s_mov_b32 s67, 0x20000
  s_lshl_b32 s48, s61, 8
  v_add_u32 v3, s48, v0
  v_lshrrev_b32 v4, 4, v3
  v_and_b32 v3, 15, v3
  v_lshlrev_b32 v4, 12, v4
  v_lshl_add_u32 v4, v3, 7, v4
  s_lshr_b32 s48, s58, 1
  s_lshl_b32 s48, s48, 21
  s_and_b32 s49, s58, 1
  s_lshl_b32 s49, s49, 11
  s_add_u32 s48, s48, s49
  buffer_load_dword v246, v4, s[64:67], s48 offen
  s_mul_i32 s48, s61, 72
  v_add_u32 v3, s48, v0
  v_mul_u32_u24 v4, 7282, v3
  v_lshrrev_b32 v4, 16, v4
  v_mul_u32_u24 v5, 9, v4
  v_sub_u32 v5, v3, v5
  v_and_b32 v6, 127, v4
  v_lshlrev_b32 v6, 13, v6
  v_lshl_add_u32 v6, v5, 7, v6
  v_lshrrev_b32 v4, 7, v4
  s_and_b32 s48, s58, 3
  s_lshl_b32 s48, s48, 8
  s_lshr_b32 s49, s58, 2
  s_add_u32 s48, s48, s49
  s_lshl_b32 s48, s48, 12
  v_mov_b32 v5, 0x40000000
  v_cmp_gt_u32 vcc, 72, v0
  s_nop 1
  v_cndmask_b32 v6, v5, v6, vcc
  v_cmp_eq_u32 vcc, 0, v4
  s_nop 1
  v_cndmask_b32 v7, v5, v6, vcc
  v_cndmask_b32 v8, v6, v5, vcc
  s_mov_b32 s64, s70
  s_mov_b32 s65, s71
  s_mov_b32 s66, 8388608
  s_mov_b32 s67, 0x20000
  buffer_load_dword v244, v7, s[64:67], s48 offen
  s_mov_b32 s64, s72
  s_mov_b32 s65, s73
  s_mov_b32 s66, 8388608
  s_mov_b32 s67, 0x20000
  buffer_load_dword v245, v8, s[64:67], s48 offen
  s_waitcnt lgkmcnt(9)
  v_mfma_f32_16x16x32_bf16 v[24:27], v[144:147], v[148:151], 0
  ds_read_b128 v[188:191], v12 offset:0
  s_waitcnt lgkmcnt(9)
  v_mfma_f32_16x16x32_bf16 v[28:31], v[144:147], v[152:155], 0
  ds_read_b128 v[192:195], v18 offset:0
  s_waitcnt lgkmcnt(9)
  v_mfma_f32_16x16x32_bf16 v[32:35], v[144:147], v[156:159], 0
  ds_read_b128 v[196:199], v18 offset:2048
  s_waitcnt lgkmcnt(9)
  v_mfma_f32_16x16x32_bf16 v[36:39], v[144:147], v[160:163], 0
  ds_read_b128 v[200:203], v18 offset:4096
  s_waitcnt lgkmcnt(9)
  v_mfma_f32_16x16x32_bf16 v[40:43], v[144:147], v[164:167], 0
  ds_read_b128 v[204:207], v18 offset:6144
  s_waitcnt lgkmcnt(9)
  v_mfma_f32_16x16x32_bf16 v[44:47], v[144:147], v[168:171], 0
  ds_read_b128 v[208:211], v18 offset:8192
  s_waitcnt lgkmcnt(9)
  v_mfma_f32_16x16x32_bf16 v[48:51], v[172:175], v[148:151], 0
  ds_read_b128 v[212:215], v18 offset:10240
  v_mfma_f32_16x16x32_bf16 v[52:55], v[172:175], v[152:155], 0
  ds_read_b128 v[216:219], v12 offset:2048
  v_mfma_f32_16x16x32_bf16 v[56:59], v[172:175], v[156:159], 0
  ds_read_b128 v[220:223], v12 offset:4096
  v_mfma_f32_16x16x32_bf16 v[60:63], v[172:175], v[160:163], 0
  ds_read_b128 v[224:227], v12 offset:6144
  v_mfma_f32_16x16x32_bf16 v[64:67], v[172:175], v[164:167], 0
  ds_read_b128 v[228:231], v12 offset:8192
  v_mfma_f32_16x16x32_bf16 v[68:71], v[172:175], v[168:171], 0
  s_waitcnt lgkmcnt(13)
  v_mfma_f32_16x16x32_bf16 v[72:75], v[176:179], v[148:151], 0
  v_mfma_f32_16x16x32_bf16 v[76:79], v[176:179], v[152:155], 0
  v_mfma_f32_16x16x32_bf16 v[80:83], v[176:179], v[156:159], 0
  v_mfma_f32_16x16x32_bf16 v[84:87], v[176:179], v[160:163], 0
  v_mfma_f32_16x16x32_bf16 v[88:91], v[176:179], v[164:167], 0
  v_mfma_f32_16x16x32_bf16 v[92:95], v[176:179], v[168:171], 0
  s_waitcnt lgkmcnt(12)
  v_mfma_f32_16x16x32_bf16 v[96:99], v[180:183], v[148:151], 0
  v_mfma_f32_16x16x32_bf16 v[100:103], v[180:183], v[152:155], 0
  v_mfma_f32_16x16x32_bf16 v[104:107], v[180:183], v[156:159], 0
  v_mfma_f32_16x16x32_bf16 v[108:111], v[180:183], v[160:163], 0
  v_mfma_f32_16x16x32_bf16 v[112:115], v[180:183], v[164:167], 0
  v_mfma_f32_16x16x32_bf16 v[116:119], v[180:183], v[168:171], 0
  s_waitcnt lgkmcnt(11)
  v_mfma_f32_16x16x32_bf16 v[120:123], v[184:187], v[148:151], 0
  v_mfma_f32_16x16x32_bf16 v[124:127], v[184:187], v[152:155], 0
  v_mfma_f32_16x16x32_bf16 v[128:131], v[184:187], v[156:159], 0
  v_mfma_f32_16x16x32_bf16 v[132:135], v[184:187], v[160:163], 0
  v_mfma_f32_16x16x32_bf16 v[136:139], v[184:187], v[164:167], 0
  v_mfma_f32_16x16x32_bf16 v[140:143], v[184:187], v[168:171], 0
  s_waitcnt lgkmcnt(9)
  v_mfma_f32_16x16x32_bf16 v[24:27], v[188:191], v[192:195], v[24:27]
  s_waitcnt lgkmcnt(8)
  v_mfma_f32_16x16x32_bf16 v[28:31], v[188:191], v[196:199], v[28:31]
  s_waitcnt lgkmcnt(0)
  s_barrier
  ds_read_b128 v[144:147], v13 offset:0
  v_mfma_f32_16x16x32_bf16 v[32:35], v[188:191], v[200:203], v[32:35]
  ds_read_b128 v[148:151], v19 offset:0
  v_mfma_f32_16x16x32_bf16 v[36:39], v[188:191], v[204:207], v[36:39]
  ds_read_b128 v[152:155], v19 offset:2048
  v_mfma_f32_16x16x32_bf16 v[40:43], v[188:191], v[208:211], v[40:43]
  ds_read_b128 v[156:159], v19 offset:4096
  v_mfma_f32_16x16x32_bf16 v[44:47], v[188:191], v[212:215], v[44:47]
  ds_read_b128 v[160:163], v19 offset:6144
  v_mfma_f32_16x16x32_bf16 v[48:51], v[216:219], v[192:195], v[48:51]
  ds_read_b128 v[164:167], v19 offset:8192
  v_mfma_f32_16x16x32_bf16 v[52:55], v[216:219], v[196:199], v[52:55]
  ds_read_b128 v[168:171], v19 offset:10240
  v_mfma_f32_16x16x32_bf16 v[56:59], v[216:219], v[200:203], v[56:59]
  ds_read_b128 v[172:175], v13 offset:2048
  v_mfma_f32_16x16x32_bf16 v[60:63], v[216:219], v[204:207], v[60:63]
  ds_read_b128 v[176:179], v13 offset:4096
  v_mfma_f32_16x16x32_bf16 v[64:67], v[216:219], v[208:211], v[64:67]
  ds_read_b128 v[180:183], v13 offset:6144
  v_mfma_f32_16x16x32_bf16 v[68:71], v[216:219], v[212:215], v[68:71]
  ds_read_b128 v[184:187], v13 offset:8192
  v_mfma_f32_16x16x32_bf16 v[72:75], v[220:223], v[192:195], v[72:75]
  v_mfma_f32_16x16x32_bf16 v[76:79], v[220:223], v[196:199], v[76:79]
  v_mfma_f32_16x16x32_bf16 v[80:83], v[220:223], v[200:203], v[80:83]
  v_mfma_f32_16x16x32_bf16 v[84:87], v[220:223], v[204:207], v[84:87]
  v_mfma_f32_16x16x32_bf16 v[88:91], v[220:223], v[208:211], v[88:91]
  v_mfma_f32_16x16x32_bf16 v[92:95], v[220:223], v[212:215], v[92:95]
  v_mfma_f32_16x16x32_bf16 v[96:99], v[224:227], v[192:195], v[96:99]
  v_mfma_f32_16x16x32_bf16 v[100:103], v[224:227], v[196:199], v[100:103]
  v_mfma_f32_16x16x32_bf16 v[104:107], v[224:227], v[200:203], v[104:107]
  v_mfma_f32_16x16x32_bf16 v[108:111], v[224:227], v[204:207], v[108:111]
  v_mfma_f32_16x16x32_bf16 v[112:115], v[224:227], v[208:211], v[112:115]
  v_mfma_f32_16x16x32_bf16 v[116:119], v[224:227], v[212:215], v[116:119]
  v_mfma_f32_16x16x32_bf16 v[120:123], v[228:231], v[192:195], v[120:123]
  v_mfma_f32_16x16x32_bf16 v[124:127], v[228:231], v[196:199], v[124:127]
  v_mfma_f32_16x16x32_bf16 v[128:131], v[228:231], v[200:203], v[128:131]
  v_mfma_f32_16x16x32_bf16 v[132:135], v[228:231], v[204:207], v[132:135]
  v_mfma_f32_16x16x32_bf16 v[136:139], v[228:231], v[208:211], v[136:139]
  v_mfma_f32_16x16x32_bf16 v[140:143], v[228:231], v[212:215], v[140:143]
  s_waitcnt lgkmcnt(9)
  v_mfma_f32_16x16x32_bf16 v[24:27], v[144:147], v[148:151], v[24:27]
  ds_read_b128 v[188:191], v14 offset:0
  s_waitcnt lgkmcnt(9)
  v_mfma_f32_16x16x32_bf16 v[28:31], v[144:147], v[152:155], v[28:31]
  ds_read_b128 v[192:195], v20 offset:0
  s_waitcnt lgkmcnt(9)
  v_mfma_f32_16x16x32_bf16 v[32:35], v[144:147], v[156:159], v[32:35]
  ds_read_b128 v[196:199], v20 offset:2048
  s_waitcnt lgkmcnt(9)
  v_mfma_f32_16x16x32_bf16 v[36:39], v[144:147], v[160:163], v[36:39]
  ds_read_b128 v[200:203], v20 offset:4096
  s_waitcnt lgkmcnt(9)
  v_mfma_f32_16x16x32_bf16 v[40:43], v[144:147], v[164:167], v[40:43]
  ds_read_b128 v[204:207], v20 offset:6144
  s_waitcnt lgkmcnt(9)
  v_mfma_f32_16x16x32_bf16 v[44:47], v[144:147], v[168:171], v[44:47]
  ds_read_b128 v[208:211], v20 offset:8192
  s_waitcnt lgkmcnt(9)
  v_mfma_f32_16x16x32_bf16 v[48:51], v[172:175], v[148:151], v[48:51]
  ds_read_b128 v[212:215], v20 offset:10240
  v_mfma_f32_16x16x32_bf16 v[52:55], v[172:175], v[152:155], v[52:55]
  ds_read_b128 v[216:219], v14 offset:2048
  v_mfma_f32_16x16x32_bf16 v[56:59], v[172:175], v[156:159], v[56:59]
  ds_read_b128 v[220:223], v14 offset:4096
  v_mfma_f32_16x16x32_bf16 v[60:63], v[172:175], v[160:163], v[60:63]
  ds_read_b128 v[224:227], v14 offset:6144
  v_mfma_f32_16x16x32_bf16 v[64:67], v[172:175], v[164:167], v[64:67]
  ds_read_b128 v[228:231], v14 offset:8192
  v_mfma_f32_16x16x32_bf16 v[68:71], v[172:175], v[168:171], v[68:71]
  s_waitcnt lgkmcnt(13)
  v_mfma_f32_16x16x32_bf16 v[72:75], v[176:179], v[148:151], v[72:75]
  v_mfma_f32_16x16x32_bf16 v[76:79], v[176:179], v[152:155], v[76:79]
  v_mfma_f32_16x16x32_bf16 v[80:83], v[176:179], v[156:159], v[80:83]
  v_mfma_f32_16x16x32_bf16 v[84:87], v[176:179], v[160:163], v[84:87]
  v_mfma_f32_16x16x32_bf16 v[88:91], v[176:179], v[164:167], v[88:91]
  v_mfma_f32_16x16x32_bf16 v[92:95], v[176:179], v[168:171], v[92:95]
  s_waitcnt lgkmcnt(12)
  v_mfma_f32_16x16x32_bf16 v[96:99], v[180:183], v[148:151], v[96:99]
  v_mfma_f32_16x16x32_bf16 v[100:103], v[180:183], v[152:155], v[100:103]
  v_mfma_f32_16x16x32_bf16 v[104:107], v[180:183], v[156:159], v[104:107]
  v_mfma_f32_16x16x32_bf16 v[108:111], v[180:183], v[160:163], v[108:111]
  v_mfma_f32_16x16x32_bf16 v[112:115], v[180:183], v[164:167], v[112:115]
  v_mfma_f32_16x16x32_bf16 v[116:119], v[180:183], v[168:171], v[116:119]
  s_waitcnt lgkmcnt(11)
  v_mfma_f32_16x16x32_bf16 v[120:123], v[184:187], v[148:151], v[120:123]
  v_mfma_f32_16x16x32_bf16 v[124:127], v[184:187], v[152:155], v[124:127]
  v_mfma_f32_16x16x32_bf16 v[128:131], v[184:187], v[156:159], v[128:131]
  v_mfma_f32_16x16x32_bf16 v[132:135], v[184:187], v[160:163], v[132:135]
  v_mfma_f32_16x16x32_bf16 v[136:139], v[184:187], v[164:167], v[136:139]
  v_mfma_f32_16x16x32_bf16 v[140:143], v[184:187], v[168:171], v[140:143]
  s_waitcnt lgkmcnt(9)
  v_mfma_f32_16x16x32_bf16 v[24:27], v[188:191], v[192:195], v[24:27]
  s_waitcnt lgkmcnt(8)
  v_mfma_f32_16x16x32_bf16 v[28:31], v[188:191], v[196:199], v[28:31]
  s_waitcnt lgkmcnt(0)
  s_barrier
  ds_read_b128 v[144:147], v15 offset:0
  v_mfma_f32_16x16x32_bf16 v[32:35], v[188:191], v[200:203], v[32:35]
  ds_read_b128 v[148:151], v21 offset:0
  v_mfma_f32_16x16x32_bf16 v[36:39], v[188:191], v[204:207], v[36:39]
  ds_read_b128 v[152:155], v21 offset:2048
  v_mfma_f32_16x16x32_bf16 v[40:43], v[188:191], v[208:211], v[40:43]
  ds_read_b128 v[156:159], v21 offset:4096
  v_mfma_f32_16x16x32_bf16 v[44:47], v[188:191], v[212:215], v[44:47]
  ds_read_b128 v[160:163], v21 offset:6144
  v_mfma_f32_16x16x32_bf16 v[48:51], v[216:219], v[192:195], v[48:51]
  ds_read_b128 v[164:167], v21 offset:8192
  v_mfma_f32_16x16x32_bf16 v[52:55], v[216:219], v[196:199], v[52:55]
  ds_read_b128 v[168:171], v21 offset:10240
  v_mfma_f32_16x16x32_bf16 v[56:59], v[216:219], v[200:203], v[56:59]
  ds_read_b128 v[172:175], v15 offset:2048
  v_mfma_f32_16x16x32_bf16 v[60:63], v[216:219], v[204:207], v[60:63]
  ds_read_b128 v[176:179], v15 offset:4096
  v_mfma_f32_16x16x32_bf16 v[64:67], v[216:219], v[208:211], v[64:67]
  ds_read_b128 v[180:183], v15 offset:6144
  v_mfma_f32_16x16x32_bf16 v[68:71], v[216:219], v[212:215], v[68:71]
  ds_read_b128 v[184:187], v15 offset:8192
  v_mfma_f32_16x16x32_bf16 v[72:75], v[220:223], v[192:195], v[72:75]
  v_mfma_f32_16x16x32_bf16 v[76:79], v[220:223], v[196:199], v[76:79]
  v_mfma_f32_16x16x32_bf16 v[80:83], v[220:223], v[200:203], v[80:83]
  v_mfma_f32_16x16x32_bf16 v[84:87], v[220:223], v[204:207], v[84:87]
  v_mfma_f32_16x16x32_bf16 v[88:91], v[220:223], v[208:211], v[88:91]
  v_mfma_f32_16x16x32_bf16 v[92:95], v[220:223], v[212:215], v[92:95]
  v_mfma_f32_16x16x32_bf16 v[96:99], v[224:227], v[192:195], v[96:99]
  v_mfma_f32_16x16x32_bf16 v[100:103], v[224:227], v[196:199], v[100:103]
  v_mfma_f32_16x16x32_bf16 v[104:107], v[224:227], v[200:203], v[104:107]
  v_mfma_f32_16x16x32_bf16 v[108:111], v[224:227], v[204:207], v[108:111]
  v_mfma_f32_16x16x32_bf16 v[112:115], v[224:227], v[208:211], v[112:115]
  v_mfma_f32_16x16x32_bf16 v[116:119], v[224:227], v[212:215], v[116:119]
  v_mfma_f32_16x16x32_bf16 v[120:123], v[228:231], v[192:195], v[120:123]
  v_mfma_f32_16x16x32_bf16 v[124:127], v[228:231], v[196:199], v[124:127]
  v_mfma_f32_16x16x32_bf16 v[128:131], v[228:231], v[200:203], v[128:131]
  v_mfma_f32_16x16x32_bf16 v[132:135], v[228:231], v[204:207], v[132:135]
  v_mfma_f32_16x16x32_bf16 v[136:139], v[228:231], v[208:211], v[136:139]
  v_mfma_f32_16x16x32_bf16 v[140:143], v[228:231], v[212:215], v[140:143]
  s_waitcnt lgkmcnt(9)
  v_mfma_f32_16x16x32_bf16 v[24:27], v[144:147], v[148:151], v[24:27]
  ds_read_b128 v[188:191], v16 offset:0
  s_waitcnt lgkmcnt(9)
  v_mfma_f32_16x16x32_bf16 v[28:31], v[144:147], v[152:155], v[28:31]
  ds_read_b128 v[192:195], v22 offset:0
  s_waitcnt lgkmcnt(9)
  v_mfma_f32_16x16x32_bf16 v[32:35], v[144:147], v[156:159], v[32:35]
  ds_read_b128 v[196:199], v22 offset:2048
  s_waitcnt lgkmcnt(9)
  v_mfma_f32_16x16x32_bf16 v[36:39], v[144:147], v[160:163], v[36:39]
  ds_read_b128 v[200:203], v22 offset:4096
  s_waitcnt lgkmcnt(9)
  v_mfma_f32_16x16x32_bf16 v[40:43], v[144:147], v[164:167], v[40:43]
  ds_read_b128 v[204:207], v22 offset:6144
  s_waitcnt lgkmcnt(9)
  v_mfma_f32_16x16x32_bf16 v[44:47], v[144:147], v[168:171], v[44:47]
  ds_read_b128 v[208:211], v22 offset:8192
  s_waitcnt lgkmcnt(9)
  v_mfma_f32_16x16x32_bf16 v[48:51], v[172:175], v[148:151], v[48:51]
  ds_read_b128 v[212:215], v22 offset:10240
  v_mfma_f32_16x16x32_bf16 v[52:55], v[172:175], v[152:155], v[52:55]
  ds_read_b128 v[216:219], v16 offset:2048
  v_mfma_f32_16x16x32_bf16 v[56:59], v[172:175], v[156:159], v[56:59]
  ds_read_b128 v[220:223], v16 offset:4096
  v_mfma_f32_16x16x32_bf16 v[60:63], v[172:175], v[160:163], v[60:63]
  ds_read_b128 v[224:227], v16 offset:6144
  v_mfma_f32_16x16x32_bf16 v[64:67], v[172:175], v[164:167], v[64:67]
  ds_read_b128 v[228:231], v16 offset:8192
  v_mfma_f32_16x16x32_bf16 v[68:71], v[172:175], v[168:171], v[68:71]
  s_waitcnt lgkmcnt(13)
  v_mfma_f32_16x16x32_bf16 v[72:75], v[176:179], v[148:151], v[72:75]
  v_mfma_f32_16x16x32_bf16 v[76:79], v[176:179], v[152:155], v[76:79]
  v_mfma_f32_16x16x32_bf16 v[80:83], v[176:179], v[156:159], v[80:83]
  v_mfma_f32_16x16x32_bf16 v[84:87], v[176:179], v[160:163], v[84:87]
  v_mfma_f32_16x16x32_bf16 v[88:91], v[176:179], v[164:167], v[88:91]
  v_mfma_f32_16x16x32_bf16 v[92:95], v[176:179], v[168:171], v[92:95]
  s_waitcnt lgkmcnt(12)
  v_mfma_f32_16x16x32_bf16 v[96:99], v[180:183], v[148:151], v[96:99]
  v_mfma_f32_16x16x32_bf16 v[100:103], v[180:183], v[152:155], v[100:103]
  v_mfma_f32_16x16x32_bf16 v[104:107], v[180:183], v[156:159], v[104:107]
  v_mfma_f32_16x16x32_bf16 v[108:111], v[180:183], v[160:163], v[108:111]
  v_mfma_f32_16x16x32_bf16 v[112:115], v[180:183], v[164:167], v[112:115]
  v_mfma_f32_16x16x32_bf16 v[116:119], v[180:183], v[168:171], v[116:119]
  s_waitcnt lgkmcnt(11)
  v_mfma_f32_16x16x32_bf16 v[120:123], v[184:187], v[148:151], v[120:123]
  v_mfma_f32_16x16x32_bf16 v[124:127], v[184:187], v[152:155], v[124:127]
  v_mfma_f32_16x16x32_bf16 v[128:131], v[184:187], v[156:159], v[128:131]
  v_mfma_f32_16x16x32_bf16 v[132:135], v[184:187], v[160:163], v[132:135]
  v_mfma_f32_16x16x32_bf16 v[136:139], v[184:187], v[164:167], v[136:139]
  v_mfma_f32_16x16x32_bf16 v[140:143], v[184:187], v[168:171], v[140:143]
  s_waitcnt lgkmcnt(9)
  v_mfma_f32_16x16x32_bf16 v[24:27], v[188:191], v[192:195], v[24:27]
  s_waitcnt lgkmcnt(8)
  v_mfma_f32_16x16x32_bf16 v[28:31], v[188:191], v[196:199], v[28:31]
  s_waitcnt lgkmcnt(0)
  s_barrier
  ds_read_b128 v[144:147], v11 offset:0
  v_mfma_f32_16x16x32_bf16 v[32:35], v[188:191], v[200:203], v[32:35]
  ds_read_b128 v[148:151], v17 offset:0
  v_mfma_f32_16x16x32_bf16 v[36:39], v[188:191], v[204:207], v[36:39]
  ds_read_b128 v[152:155], v17 offset:2048
  v_mfma_f32_16x16x32_bf16 v[40:43], v[188:191], v[208:211], v[40:43]
  ds_read_b128 v[156:159], v17 offset:4096
  v_mfma_f32_16x16x32_bf16 v[44:47], v[188:191], v[212:215], v[44:47]
  ds_read_b128 v[160:163], v17 offset:6144
  v_mfma_f32_16x16x32_bf16 v[48:51], v[216:219], v[192:195], v[48:51]
  ds_read_b128 v[164:167], v17 offset:8192
  v_mfma_f32_16x16x32_bf16 v[52:55], v[216:219], v[196:199], v[52:55]
  ds_read_b128 v[168:171], v17 offset:10240
  v_mfma_f32_16x16x32_bf16 v[56:59], v[216:219], v[200:203], v[56:59]
  ds_read_b128 v[172:175], v11 offset:2048
  v_mfma_f32_16x16x32_bf16 v[60:63], v[216:219], v[204:207], v[60:63]
  ds_read_b128 v[176:179], v11 offset:4096
  v_mfma_f32_16x16x32_bf16 v[64:67], v[216:219], v[208:211], v[64:67]
  ds_read_b128 v[180:183], v11 offset:6144
  v_mfma_f32_16x16x32_bf16 v[68:71], v[216:219], v[212:215], v[68:71]
  ds_read_b128 v[184:187], v11 offset:8192
  v_mfma_f32_16x16x32_bf16 v[72:75], v[220:223], v[192:195], v[72:75]
  v_mfma_f32_16x16x32_bf16 v[76:79], v[220:223], v[196:199], v[76:79]
  v_mfma_f32_16x16x32_bf16 v[80:83], v[220:223], v[200:203], v[80:83]
  v_mfma_f32_16x16x32_bf16 v[84:87], v[220:223], v[204:207], v[84:87]
  v_mfma_f32_16x16x32_bf16 v[88:91], v[220:223], v[208:211], v[88:91]
  v_mfma_f32_16x16x32_bf16 v[92:95], v[220:223], v[212:215], v[92:95]
  v_mfma_f32_16x16x32_bf16 v[96:99], v[224:227], v[192:195], v[96:99]
  v_mfma_f32_16x16x32_bf16 v[100:103], v[224:227], v[196:199], v[100:103]
  v_mfma_f32_16x16x32_bf16 v[104:107], v[224:227], v[200:203], v[104:107]
  v_mfma_f32_16x16x32_bf16 v[108:111], v[224:227], v[204:207], v[108:111]
  v_mfma_f32_16x16x32_bf16 v[112:115], v[224:227], v[208:211], v[112:115]
  v_mfma_f32_16x16x32_bf16 v[116:119], v[224:227], v[212:215], v[116:119]
  v_mfma_f32_16x16x32_bf16 v[120:123], v[228:231], v[192:195], v[120:123]
  v_mfma_f32_16x16x32_bf16 v[124:127], v[228:231], v[196:199], v[124:127]
  v_mfma_f32_16x16x32_bf16 v[128:131], v[228:231], v[200:203], v[128:131]
  v_mfma_f32_16x16x32_bf16 v[132:135], v[228:231], v[204:207], v[132:135]
  v_mfma_f32_16x16x32_bf16 v[136:139], v[228:231], v[208:211], v[136:139]
  v_mfma_f32_16x16x32_bf16 v[140:143], v[228:231], v[212:215], v[140:143]
  s_waitcnt lgkmcnt(9)
  v_mfma_f32_16x16x32_bf16 v[24:27], v[144:147], v[148:151], v[24:27]
  ds_read_b128 v[188:191], v12 offset:0
  s_waitcnt lgkmcnt(9)
  v_mfma_f32_16x16x32_bf16 v[28:31], v[144:147], v[152:155], v[28:31]
  ds_read_b128 v[192:195], v18 offset:0
  s_waitcnt lgkmcnt(9)
  v_mfma_f32_16x16x32_bf16 v[32:35], v[144:147], v[156:159], v[32:35]
  ds_read_b128 v[196:199], v18 offset:2048
  s_waitcnt lgkmcnt(9)
  v_mfma_f32_16x16x32_bf16 v[36:39], v[144:147], v[160:163], v[36:39]
  ds_read_b128 v[200:203], v18 offset:4096
  s_waitcnt lgkmcnt(9)
  v_mfma_f32_16x16x32_bf16 v[40:43], v[144:147], v[164:167], v[40:43]
  ds_read_b128 v[204:207], v18 offset:6144
  s_waitcnt lgkmcnt(9)
  v_mfma_f32_16x16x32_bf16 v[44:47], v[144:147], v[168:171], v[44:47]
  ds_read_b128 v[208:211], v18 offset:8192
  s_waitcnt lgkmcnt(9)
  v_mfma_f32_16x16x32_bf16 v[48:51], v[172:175], v[148:151], v[48:51]
  ds_read_b128 v[212:215], v18 offset:10240
  v_mfma_f32_16x16x32_bf16 v[52:55], v[172:175], v[152:155], v[52:55]
  ds_read_b128 v[216:219], v12 offset:2048
  v_mfma_f32_16x16x32_bf16 v[56:59], v[172:175], v[156:159], v[56:59]
  ds_read_b128 v[220:223], v12 offset:4096
  v_mfma_f32_16x16x32_bf16 v[60:63], v[172:175], v[160:163], v[60:63]
  ds_read_b128 v[224:227], v12 offset:6144
  v_mfma_f32_16x16x32_bf16 v[64:67], v[172:175], v[164:167], v[64:67]
  ds_read_b128 v[228:231], v12 offset:8192
  v_mfma_f32_16x16x32_bf16 v[68:71], v[172:175], v[168:171], v[68:71]
  s_waitcnt lgkmcnt(13)
  v_mfma_f32_16x16x32_bf16 v[72:75], v[176:179], v[148:151], v[72:75]
  v_mfma_f32_16x16x32_bf16 v[76:79], v[176:179], v[152:155], v[76:79]
  v_mfma_f32_16x16x32_bf16 v[80:83], v[176:179], v[156:159], v[80:83]
  v_mfma_f32_16x16x32_bf16 v[84:87], v[176:179], v[160:163], v[84:87]
  v_mfma_f32_16x16x32_bf16 v[88:91], v[176:179], v[164:167], v[88:91]
  v_mfma_f32_16x16x32_bf16 v[92:95], v[176:179], v[168:171], v[92:95]
  s_waitcnt lgkmcnt(12)
  v_mfma_f32_16x16x32_bf16 v[96:99], v[180:183], v[148:151], v[96:99]
  v_mfma_f32_16x16x32_bf16 v[100:103], v[180:183], v[152:155], v[100:103]
  v_mfma_f32_16x16x32_bf16 v[104:107], v[180:183], v[156:159], v[104:107]
  v_mfma_f32_16x16x32_bf16 v[108:111], v[180:183], v[160:163], v[108:111]
  v_mfma_f32_16x16x32_bf16 v[112:115], v[180:183], v[164:167], v[112:115]
  v_mfma_f32_16x16x32_bf16 v[116:119], v[180:183], v[168:171], v[116:119]
  s_waitcnt lgkmcnt(11)
  v_mfma_f32_16x16x32_bf16 v[120:123], v[184:187], v[148:151], v[120:123]
  v_mfma_f32_16x16x32_bf16 v[124:127], v[184:187], v[152:155], v[124:127]
  v_mfma_f32_16x16x32_bf16 v[128:131], v[184:187], v[156:159], v[128:131]
  v_mfma_f32_16x16x32_bf16 v[132:135], v[184:187], v[160:163], v[132:135]
  v_mfma_f32_16x16x32_bf16 v[136:139], v[184:187], v[164:167], v[136:139]
  v_mfma_f32_16x16x32_bf16 v[140:143], v[184:187], v[168:171], v[140:143]
  s_waitcnt lgkmcnt(9)
  v_mfma_f32_16x16x32_bf16 v[24:27], v[188:191], v[192:195], v[24:27]
  s_waitcnt lgkmcnt(8)
  v_mfma_f32_16x16x32_bf16 v[28:31], v[188:191], v[196:199], v[28:31]
  s_waitcnt lgkmcnt(0)
  s_barrier
  ds_read_b128 v[144:147], v13 offset:0
  v_mfma_f32_16x16x32_bf16 v[32:35], v[188:191], v[200:203], v[32:35]
  ds_read_b128 v[148:151], v19 offset:0
  v_mfma_f32_16x16x32_bf16 v[36:39], v[188:191], v[204:207], v[36:39]
  ds_read_b128 v[152:155], v19 offset:2048
  v_mfma_f32_16x16x32_bf16 v[40:43], v[188:191], v[208:211], v[40:43]
  ds_read_b128 v[156:159], v19 offset:4096
  v_mfma_f32_16x16x32_bf16 v[44:47], v[188:191], v[212:215], v[44:47]
  ds_read_b128 v[160:163], v19 offset:6144
  v_mfma_f32_16x16x32_bf16 v[48:51], v[216:219], v[192:195], v[48:51]
  ds_read_b128 v[164:167], v19 offset:8192
  v_mfma_f32_16x16x32_bf16 v[52:55], v[216:219], v[196:199], v[52:55]
  ds_read_b128 v[168:171], v19 offset:10240
  v_mfma_f32_16x16x32_bf16 v[56:59], v[216:219], v[200:203], v[56:59]
  ds_read_b128 v[172:175], v13 offset:2048
  v_mfma_f32_16x16x32_bf16 v[60:63], v[216:219], v[204:207], v[60:63]
  ds_read_b128 v[176:179], v13 offset:4096
  v_mfma_f32_16x16x32_bf16 v[64:67], v[216:219], v[208:211], v[64:67]
  ds_read_b128 v[180:183], v13 offset:6144
  v_mfma_f32_16x16x32_bf16 v[68:71], v[216:219], v[212:215], v[68:71]
  ds_read_b128 v[184:187], v13 offset:8192
  v_mfma_f32_16x16x32_bf16 v[72:75], v[220:223], v[192:195], v[72:75]
  v_mfma_f32_16x16x32_bf16 v[76:79], v[220:223], v[196:199], v[76:79]
  v_mfma_f32_16x16x32_bf16 v[80:83], v[220:223], v[200:203], v[80:83]
  v_mfma_f32_16x16x32_bf16 v[84:87], v[220:223], v[204:207], v[84:87]
  v_mfma_f32_16x16x32_bf16 v[88:91], v[220:223], v[208:211], v[88:91]
  v_mfma_f32_16x16x32_bf16 v[92:95], v[220:223], v[212:215], v[92:95]
  v_mfma_f32_16x16x32_bf16 v[96:99], v[224:227], v[192:195], v[96:99]
  v_mfma_f32_16x16x32_bf16 v[100:103], v[224:227], v[196:199], v[100:103]
  v_mfma_f32_16x16x32_bf16 v[104:107], v[224:227], v[200:203], v[104:107]
  v_mfma_f32_16x16x32_bf16 v[108:111], v[224:227], v[204:207], v[108:111]
  v_mfma_f32_16x16x32_bf16 v[112:115], v[224:227], v[208:211], v[112:115]
  v_mfma_f32_16x16x32_bf16 v[116:119], v[224:227], v[212:215], v[116:119]
  v_mfma_f32_16x16x32_bf16 v[120:123], v[228:231], v[192:195], v[120:123]
  v_mfma_f32_16x16x32_bf16 v[124:127], v[228:231], v[196:199], v[124:127]
  v_mfma_f32_16x16x32_bf16 v[128:131], v[228:231], v[200:203], v[128:131]
  v_mfma_f32_16x16x32_bf16 v[132:135], v[228:231], v[204:207], v[132:135]
  v_mfma_f32_16x16x32_bf16 v[136:139], v[228:231], v[208:211], v[136:139]
  v_mfma_f32_16x16x32_bf16 v[140:143], v[228:231], v[212:215], v[140:143]
  s_waitcnt lgkmcnt(9)
  v_mfma_f32_16x16x32_bf16 v[24:27], v[144:147], v[148:151], v[24:27]
  ds_read_b128 v[188:191], v14 offset:0
  s_waitcnt lgkmcnt(9)
  v_mfma_f32_16x16x32_bf16 v[28:31], v[144:147], v[152:155], v[28:31]
  ds_read_b128 v[192:195], v20 offset:0
  s_waitcnt lgkmcnt(9)
  v_mfma_f32_16x16x32_bf16 v[32:35], v[144:147], v[156:159], v[32:35]
  ds_read_b128 v[196:199], v20 offset:2048
  s_waitcnt lgkmcnt(9)
  v_mfma_f32_16x16x32_bf16 v[36:39], v[144:147], v[160:163], v[36:39]
  ds_read_b128 v[200:203], v20 offset:4096
  s_waitcnt lgkmcnt(9)
  v_mfma_f32_16x16x32_bf16 v[40:43], v[144:147], v[164:167], v[40:43]
  ds_read_b128 v[204:207], v20 offset:6144
  s_waitcnt lgkmcnt(9)
  v_mfma_f32_16x16x32_bf16 v[44:47], v[144:147], v[168:171], v[44:47]
  ds_read_b128 v[208:211], v20 offset:8192
  s_waitcnt lgkmcnt(9)
  v_mfma_f32_16x16x32_bf16 v[48:51], v[172:175], v[148:151], v[48:51]
  ds_read_b128 v[212:215], v20 offset:10240
  v_mfma_f32_16x16x32_bf16 v[52:55], v[172:175], v[152:155], v[52:55]
  ds_read_b128 v[216:219], v14 offset:2048
  v_mfma_f32_16x16x32_bf16 v[56:59], v[172:175], v[156:159], v[56:59]
  ds_read_b128 v[220:223], v14 offset:4096
  v_mfma_f32_16x16x32_bf16 v[60:63], v[172:175], v[160:163], v[60:63]
  ds_read_b128 v[224:227], v14 offset:6144
  v_mfma_f32_16x16x32_bf16 v[64:67], v[172:175], v[164:167], v[64:67]
  ds_read_b128 v[228:231], v14 offset:8192
  v_mfma_f32_16x16x32_bf16 v[68:71], v[172:175], v[168:171], v[68:71]
  s_waitcnt lgkmcnt(13)
  v_mfma_f32_16x16x32_bf16 v[72:75], v[176:179], v[148:151], v[72:75]
  v_mfma_f32_16x16x32_bf16 v[76:79], v[176:179], v[152:155], v[76:79]
  v_mfma_f32_16x16x32_bf16 v[80:83], v[176:179], v[156:159], v[80:83]
  v_mfma_f32_16x16x32_bf16 v[84:87], v[176:179], v[160:163], v[84:87]
  v_mfma_f32_16x16x32_bf16 v[88:91], v[176:179], v[164:167], v[88:91]
  v_mfma_f32_16x16x32_bf16 v[92:95], v[176:179], v[168:171], v[92:95]
  s_waitcnt lgkmcnt(12)
  v_mfma_f32_16x16x32_bf16 v[96:99], v[180:183], v[148:151], v[96:99]
  v_mfma_f32_16x16x32_bf16 v[100:103], v[180:183], v[152:155], v[100:103]
  v_mfma_f32_16x16x32_bf16 v[104:107], v[180:183], v[156:159], v[104:107]
  v_mfma_f32_16x16x32_bf16 v[108:111], v[180:183], v[160:163], v[108:111]
  v_mfma_f32_16x16x32_bf16 v[112:115], v[180:183], v[164:167], v[112:115]
  v_mfma_f32_16x16x32_bf16 v[116:119], v[180:183], v[168:171], v[116:119]
  s_waitcnt lgkmcnt(11)
  v_mfma_f32_16x16x32_bf16 v[120:123], v[184:187], v[148:151], v[120:123]
  v_mfma_f32_16x16x32_bf16 v[124:127], v[184:187], v[152:155], v[124:127]
  v_mfma_f32_16x16x32_bf16 v[128:131], v[184:187], v[156:159], v[128:131]
  v_mfma_f32_16x16x32_bf16 v[132:135], v[184:187], v[160:163], v[132:135]
  v_mfma_f32_16x16x32_bf16 v[136:139], v[184:187], v[164:167], v[136:139]
  v_mfma_f32_16x16x32_bf16 v[140:143], v[184:187], v[168:171], v[140:143]
  s_waitcnt lgkmcnt(9)
  v_mfma_f32_16x16x32_bf16 v[24:27], v[188:191], v[192:195], v[24:27]
  s_waitcnt lgkmcnt(8)
  v_mfma_f32_16x16x32_bf16 v[28:31], v[188:191], v[196:199], v[28:31]
  s_waitcnt lgkmcnt(0)
  s_barrier
  ds_read_b128 v[144:147], v15 offset:0
  v_mfma_f32_16x16x32_bf16 v[32:35], v[188:191], v[200:203], v[32:35]
  ds_read_b128 v[148:151], v21 offset:0
  v_mfma_f32_16x16x32_bf16 v[36:39], v[188:191], v[204:207], v[36:39]
  ds_read_b128 v[152:155], v21 offset:2048
  v_mfma_f32_16x16x32_bf16 v[40:43], v[188:191], v[208:211], v[40:43]
  ds_read_b128 v[156:159], v21 offset:4096
  v_mfma_f32_16x16x32_bf16 v[44:47], v[188:191], v[212:215], v[44:47]
  ds_read_b128 v[160:163], v21 offset:6144
  v_mfma_f32_16x16x32_bf16 v[48:51], v[216:219], v[192:195], v[48:51]
  ds_read_b128 v[164:167], v21 offset:8192
  v_mfma_f32_16x16x32_bf16 v[52:55], v[216:219], v[196:199], v[52:55]
  ds_read_b128 v[168:171], v21 offset:10240
  v_mfma_f32_16x16x32_bf16 v[56:59], v[216:219], v[200:203], v[56:59]
  ds_read_b128 v[172:175], v15 offset:2048
  v_mfma_f32_16x16x32_bf16 v[60:63], v[216:219], v[204:207], v[60:63]
  ds_read_b128 v[176:179], v15 offset:4096
  v_mfma_f32_16x16x32_bf16 v[64:67], v[216:219], v[208:211], v[64:67]
  ds_read_b128 v[180:183], v15 offset:6144
  v_mfma_f32_16x16x32_bf16 v[68:71], v[216:219], v[212:215], v[68:71]
  ds_read_b128 v[184:187], v15 offset:8192
  v_mfma_f32_16x16x32_bf16 v[72:75], v[220:223], v[192:195], v[72:75]
  v_mfma_f32_16x16x32_bf16 v[76:79], v[220:223], v[196:199], v[76:79]
  v_mfma_f32_16x16x32_bf16 v[80:83], v[220:223], v[200:203], v[80:83]
  v_mfma_f32_16x16x32_bf16 v[84:87], v[220:223], v[204:207], v[84:87]
  v_mfma_f32_16x16x32_bf16 v[88:91], v[220:223], v[208:211], v[88:91]
  v_mfma_f32_16x16x32_bf16 v[92:95], v[220:223], v[212:215], v[92:95]
  v_mfma_f32_16x16x32_bf16 v[96:99], v[224:227], v[192:195], v[96:99]
  v_mfma_f32_16x16x32_bf16 v[100:103], v[224:227], v[196:199], v[100:103]
  v_mfma_f32_16x16x32_bf16 v[104:107], v[224:227], v[200:203], v[104:107]
  v_mfma_f32_16x16x32_bf16 v[108:111], v[224:227], v[204:207], v[108:111]
  v_mfma_f32_16x16x32_bf16 v[112:115], v[224:227], v[208:211], v[112:115]
  v_mfma_f32_16x16x32_bf16 v[116:119], v[224:227], v[212:215], v[116:119]
  v_mfma_f32_16x16x32_bf16 v[120:123], v[228:231], v[192:195], v[120:123]
  v_mfma_f32_16x16x32_bf16 v[124:127], v[228:231], v[196:199], v[124:127]
  v_mfma_f32_16x16x32_bf16 v[128:131], v[228:231], v[200:203], v[128:131]
  v_mfma_f32_16x16x32_bf16 v[132:135], v[228:231], v[204:207], v[132:135]
  v_mfma_f32_16x16x32_bf16 v[136:139], v[228:231], v[208:211], v[136:139]
  v_mfma_f32_16x16x32_bf16 v[140:143], v[228:231], v[212:215], v[140:143]
  s_waitcnt lgkmcnt(9)
  v_mfma_f32_16x16x32_bf16 v[24:27], v[144:147], v[148:151], v[24:27]
  ds_read_b128 v[188:191], v16 offset:0
  s_waitcnt lgkmcnt(9)
  v_mfma_f32_16x16x32_bf16 v[28:31], v[144:147], v[152:155], v[28:31]
  ds_read_b128 v[192:195], v22 offset:0
  s_waitcnt lgkmcnt(9)
  v_mfma_f32_16x16x32_bf16 v[32:35], v[144:147], v[156:159], v[32:35]
  ds_read_b128 v[196:199], v22 offset:2048
  s_waitcnt lgkmcnt(9)
  v_mfma_f32_16x16x32_bf16 v[36:39], v[144:147], v[160:163], v[36:39]
  ds_read_b128 v[200:203], v22 offset:4096
  s_waitcnt lgkmcnt(9)
  v_mfma_f32_16x16x32_bf16 v[40:43], v[144:147], v[164:167], v[40:43]
  ds_read_b128 v[204:207], v22 offset:6144
  s_waitcnt lgkmcnt(9)
  v_mfma_f32_16x16x32_bf16 v[44:47], v[144:147], v[168:171], v[44:47]
  ds_read_b128 v[208:211], v22 offset:8192
  s_waitcnt lgkmcnt(9)
  v_mfma_f32_16x16x32_bf16 v[48:51], v[172:175], v[148:151], v[48:51]
  ds_read_b128 v[212:215], v22 offset:10240
  v_mfma_f32_16x16x32_bf16 v[52:55], v[172:175], v[152:155], v[52:55]
  ds_read_b128 v[216:219], v16 offset:2048
  v_mfma_f32_16x16x32_bf16 v[56:59], v[172:175], v[156:159], v[56:59]
  ds_read_b128 v[220:223], v16 offset:4096
  v_mfma_f32_16x16x32_bf16 v[60:63], v[172:175], v[160:163], v[60:63]
  ds_read_b128 v[224:227], v16 offset:6144
  v_mfma_f32_16x16x32_bf16 v[64:67], v[172:175], v[164:167], v[64:67]
  ds_read_b128 v[228:231], v16 offset:8192
  v_mfma_f32_16x16x32_bf16 v[68:71], v[172:175], v[168:171], v[68:71]
  s_waitcnt lgkmcnt(13)
  v_mfma_f32_16x16x32_bf16 v[72:75], v[176:179], v[148:151], v[72:75]
  v_mfma_f32_16x16x32_bf16 v[76:79], v[176:179], v[152:155], v[76:79]
  v_mfma_f32_16x16x32_bf16 v[80:83], v[176:179], v[156:159], v[80:83]
  v_mfma_f32_16x16x32_bf16 v[84:87], v[176:179], v[160:163], v[84:87]
  v_mfma_f32_16x16x32_bf16 v[88:91], v[176:179], v[164:167], v[88:91]
  v_mfma_f32_16x16x32_bf16 v[92:95], v[176:179], v[168:171], v[92:95]
  s_waitcnt lgkmcnt(12)
  v_mfma_f32_16x16x32_bf16 v[96:99], v[180:183], v[148:151], v[96:99]
  v_mfma_f32_16x16x32_bf16 v[100:103], v[180:183], v[152:155], v[100:103]
  v_mfma_f32_16x16x32_bf16 v[104:107], v[180:183], v[156:159], v[104:107]
  v_mfma_f32_16x16x32_bf16 v[108:111], v[180:183], v[160:163], v[108:111]
  v_mfma_f32_16x16x32_bf16 v[112:115], v[180:183], v[164:167], v[112:115]
  v_mfma_f32_16x16x32_bf16 v[116:119], v[180:183], v[168:171], v[116:119]
  s_waitcnt lgkmcnt(11)
  v_mfma_f32_16x16x32_bf16 v[120:123], v[184:187], v[148:151], v[120:123]
  v_mfma_f32_16x16x32_bf16 v[124:127], v[184:187], v[152:155], v[124:127]
  v_mfma_f32_16x16x32_bf16 v[128:131], v[184:187], v[156:159], v[128:131]
  v_mfma_f32_16x16x32_bf16 v[132:135], v[184:187], v[160:163], v[132:135]
  v_mfma_f32_16x16x32_bf16 v[136:139], v[184:187], v[164:167], v[136:139]
  v_mfma_f32_16x16x32_bf16 v[140:143], v[184:187], v[168:171], v[140:143]
  s_waitcnt lgkmcnt(9)
  v_mfma_f32_16x16x32_bf16 v[24:27], v[188:191], v[192:195], v[24:27]
  s_waitcnt lgkmcnt(8)
  v_mfma_f32_16x16x32_bf16 v[28:31], v[188:191], v[196:199], v[28:31]
  s_waitcnt lgkmcnt(7)
  v_mfma_f32_16x16x32_bf16 v[32:35], v[188:191], v[200:203], v[32:35]
  s_waitcnt lgkmcnt(6)
  v_mfma_f32_16x16x32_bf16 v[36:39], v[188:191], v[204:207], v[36:39]
  s_waitcnt lgkmcnt(5)
  v_mfma_f32_16x16x32_bf16 v[40:43], v[188:191], v[208:211], v[40:43]
  s_waitcnt lgkmcnt(4)
  v_mfma_f32_16x16x32_bf16 v[44:47], v[188:191], v[212:215], v[44:47]
  s_waitcnt lgkmcnt(3)
  v_mfma_f32_16x16x32_bf16 v[48:51], v[216:219], v[192:195], v[48:51]
  v_mfma_f32_16x16x32_bf16 v[52:55], v[216:219], v[196:199], v[52:55]
  v_mfma_f32_16x16x32_bf16 v[56:59], v[216:219], v[200:203], v[56:59]
  v_mfma_f32_16x16x32_bf16 v[60:63], v[216:219], v[204:207], v[60:63]
  v_mfma_f32_16x16x32_bf16 v[64:67], v[216:219], v[208:211], v[64:67]
  v_mfma_f32_16x16x32_bf16 v[68:71], v[216:219], v[212:215], v[68:71]
  s_waitcnt lgkmcnt(2)
  v_mfma_f32_16x16x32_bf16 v[72:75], v[220:223], v[192:195], v[72:75]
  v_mfma_f32_16x16x32_bf16 v[76:79], v[220:223], v[196:199], v[76:79]
  v_mfma_f32_16x16x32_bf16 v[80:83], v[220:223], v[200:203], v[80:83]
  v_mfma_f32_16x16x32_bf16 v[84:87], v[220:223], v[204:207], v[84:87]
  v_mfma_f32_16x16x32_bf16 v[88:91], v[220:223], v[208:211], v[88:91]
  v_mfma_f32_16x16x32_bf16 v[92:95], v[220:223], v[212:215], v[92:95]
  s_waitcnt lgkmcnt(1)
  v_mfma_f32_16x16x32_bf16 v[96:99], v[224:227], v[192:195], v[96:99]
  v_mfma_f32_16x16x32_bf16 v[100:103], v[224:227], v[196:199], v[100:103]
  v_mfma_f32_16x16x32_bf16 v[104:107], v[224:227], v[200:203], v[104:107]
  v_mfma_f32_16x16x32_bf16 v[108:111], v[224:227], v[204:207], v[108:111]
  v_mfma_f32_16x16x32_bf16 v[112:115], v[224:227], v[208:211], v[112:115]
  v_mfma_f32_16x16x32_bf16 v[116:119], v[224:227], v[212:215], v[116:119]
  s_waitcnt lgkmcnt(0)
  v_mfma_f32_16x16x32_bf16 v[120:123], v[228:231], v[192:195], v[120:123]
  v_mfma_f32_16x16x32_bf16 v[124:127], v[228:231], v[196:199], v[124:127]
  v_mfma_f32_16x16x32_bf16 v[128:131], v[228:231], v[200:203], v[128:131]
  v_mfma_f32_16x16x32_bf16 v[132:135], v[228:231], v[204:207], v[132:135]
  v_mfma_f32_16x16x32_bf16 v[136:139], v[228:231], v[208:211], v[136:139]
  v_mfma_f32_16x16x32_bf16 v[140:143], v[228:231], v[212:215], v[140:143]
  s_nop 4
  v_sub_f32 v156, v24, v25
  v_add_f32 v156, v156, v26
  v_sub_f32 v156, v156, v27
  v_add_f32 v156, v156, v48
  v_sub_f32 v156, v156, v49
  v_add_f32 v156, v156, v50
  v_sub_f32 v156, v156, v51
  v_add_f32 v156, v156, v72
  v_sub_f32 v156, v156, v73
  v_add_f32 v156, v156, v74
  v_sub_f32 v156, v156, v75
  v_sub_f32 v162, v96, v97
  v_add_f32 v162, v162, v98
  v_sub_f32 v162, v162, v99
  v_add_f32 v162, v162, v120
  v_sub_f32 v162, v162, v121
  v_add_f32 v162, v162, v122
  v_sub_f32 v162, v162, v123
  v_sub_f32 v157, v28, v29
  v_add_f32 v157, v157, v30
  v_sub_f32 v157, v157, v31
  v_add_f32 v157, v157, v52
  v_sub_f32 v157, v157, v53
  v_add_f32 v157, v157, v54
  v_sub_f32 v157, v157, v55
  v_add_f32 v157, v157, v76
  v_sub_f32 v157, v157, v77
  v_add_f32 v157, v157, v78
  v_sub_f32 v157, v157, v79
  v_sub_f32 v163, v100, v101
  v_add_f32 v163, v163, v102
  v_sub_f32 v163, v163, v103
  v_add_f32 v163, v163, v124
  v_sub_f32 v163, v163, v125
  v_add_f32 v163, v163, v126
  v_sub_f32 v163, v163, v127
  v_sub_f32 v158, v32, v33
  v_add_f32 v158, v158, v34
  v_sub_f32 v158, v158, v35
  v_add_f32 v158, v158, v56
  v_sub_f32 v158, v158, v57
  v_add_f32 v158, v158, v58
  v_sub_f32 v158, v158, v59
  v_add_f32 v158, v158, v80
  v_sub_f32 v158, v158, v81
  v_add_f32 v158, v158, v82
  v_sub_f32 v158, v158, v83
  v_sub_f32 v164, v104, v105
  v_add_f32 v164, v164, v106
  v_sub_f32 v164, v164, v107
  v_add_f32 v164, v164, v128
  v_sub_f32 v164, v164, v129
  v_add_f32 v164, v164, v130
  v_sub_f32 v164, v164, v131
  v_sub_f32 v159, v36, v37
  v_add_f32 v159, v159, v38
  v_sub_f32 v159, v159, v39
  v_add_f32 v159, v159, v60
  v_sub_f32 v159, v159, v61
  v_add_f32 v159, v159, v62
  v_sub_f32 v159, v159, v63
  v_add_f32 v159, v159, v84
  v_sub_f32 v159, v159, v85
  v_add_f32 v159, v159, v86
  v_sub_f32 v159, v159, v87
  v_sub_f32 v165, v108, v109
  v_add_f32 v165, v165, v110
  v_sub_f32 v165, v165, v111
  v_add_f32 v165, v165, v132
  v_sub_f32 v165, v165, v133
  v_add_f32 v165, v165, v134
  v_sub_f32 v165, v165, v135
  v_sub_f32 v160, v40, v41
  v_add_f32 v160, v160, v42
  v_sub_f32 v160, v160, v43
  v_add_f32 v160, v160, v64
  v_sub_f32 v160, v160, v65
  v_add_f32 v160, v160, v66
  v_sub_f32 v160, v160, v67
  v_add_f32 v160, v160, v88
  v_sub_f32 v160, v160, v89
  v_add_f32 v160, v160, v90
  v_sub_f32 v160, v160, v91
  v_sub_f32 v166, v112, v113
  v_add_f32 v166, v166, v114
  v_sub_f32 v166, v166, v115
  v_add_f32 v166, v166, v136
  v_sub_f32 v166, v166, v137
  v_add_f32 v166, v166, v138
  v_sub_f32 v166, v166, v139
  v_sub_f32 v161, v44, v45
  v_add_f32 v161, v161, v46
  v_sub_f32 v161, v161, v47
  v_add_f32 v161, v161, v68
  v_sub_f32 v161, v161, v69
  v_add_f32 v161, v161, v70
  v_sub_f32 v161, v161, v71
  v_add_f32 v161, v161, v92
  v_sub_f32 v161, v161, v93
  v_add_f32 v161, v161, v94
  v_sub_f32 v161, v161, v95
  v_sub_f32 v167, v116, v117
  v_add_f32 v167, v167, v118
  v_sub_f32 v167, v167, v119
  v_add_f32 v167, v167, v140
  v_sub_f32 v167, v167, v141
  v_add_f32 v167, v167, v142
  v_sub_f32 v167, v167, v143
  v_cvt_pk_bf16_f32 v144, v24, v25
  v_cvt_pk_bf16_f32 v145, v26, v27
  v_cvt_pk_bf16_f32 v146, v28, v29
  v_cvt_pk_bf16_f32 v147, v30, v31
  v_cvt_pk_bf16_f32 v148, v32, v33
  v_cvt_pk_bf16_f32 v149, v34, v35
  v_cvt_pk_bf16_f32 v150, v36, v37
  v_cvt_pk_bf16_f32 v151, v38, v39
  v_cvt_pk_bf16_f32 v152, v40, v41
  v_cvt_pk_bf16_f32 v153, v42, v43
  v_cvt_pk_bf16_f32 v154, v44, v45
  v_cvt_pk_bf16_f32 v155, v46, v47
  v_permlane16_swap_b32 v144, v146
  v_permlane16_swap_b32 v145, v147
  v_permlane16_swap_b32 v148, v150
  v_permlane16_swap_b32 v149, v151
  v_permlane16_swap_b32 v152, v154
  v_permlane16_swap_b32 v153, v155
  s_add_u32 s38, s37, 0
  buffer_store_dwordx4 v[144:147], v23, s[24:27], s38 offen offset:0 sc1
  buffer_store_dwordx4 v[148:151], v23, s[24:27], s38 offen offset:512 sc1
  buffer_store_dwordx4 v[152:155], v23, s[24:27], s38 offen offset:1024 sc1
  s_nop 1
  v_cvt_pk_bf16_f32 v144, v48, v49
  v_cvt_pk_bf16_f32 v145, v50, v51
  v_cvt_pk_bf16_f32 v146, v52, v53
  v_cvt_pk_bf16_f32 v147, v54, v55
  v_cvt_pk_bf16_f32 v148, v56, v57
  v_cvt_pk_bf16_f32 v149, v58, v59
  v_cvt_pk_bf16_f32 v150, v60, v61
  v_cvt_pk_bf16_f32 v151, v62, v63
  v_cvt_pk_bf16_f32 v152, v64, v65
  v_cvt_pk_bf16_f32 v153, v66, v67
  v_cvt_pk_bf16_f32 v154, v68, v69
  v_cvt_pk_bf16_f32 v155, v70, v71
  v_permlane16_swap_b32 v144, v146
  v_permlane16_swap_b32 v145, v147
  v_permlane16_swap_b32 v148, v150
  v_permlane16_swap_b32 v149, v151
  v_permlane16_swap_b32 v152, v154
  v_permlane16_swap_b32 v153, v155
  s_add_u32 s38, s37, 11264
  buffer_store_dwordx4 v[144:147], v23, s[24:27], s38 offen offset:0 sc1
  buffer_store_dwordx4 v[148:151], v23, s[24:27], s38 offen offset:512 sc1
  buffer_store_dwordx4 v[152:155], v23, s[24:27], s38 offen offset:1024 sc1
  s_nop 1
  v_cvt_pk_bf16_f32 v144, v72, v73
  v_cvt_pk_bf16_f32 v145, v74, v75
  v_cvt_pk_bf16_f32 v146, v76, v77
  v_cvt_pk_bf16_f32 v147, v78, v79
  v_cvt_pk_bf16_f32 v148, v80, v81
  v_cvt_pk_bf16_f32 v149, v82, v83
  v_cvt_pk_bf16_f32 v150, v84, v85
  v_cvt_pk_bf16_f32 v151, v86, v87
  v_cvt_pk_bf16_f32 v152, v88, v89
  v_cvt_pk_bf16_f32 v153, v90, v91
  v_cvt_pk_bf16_f32 v154, v92, v93
  v_cvt_pk_bf16_f32 v155, v94, v95
  v_permlane16_swap_b32 v144, v146
  v_permlane16_swap_b32 v145, v147
  v_permlane16_swap_b32 v148, v150
  v_permlane16_swap_b32 v149, v151
  v_permlane16_swap_b32 v152, v154
  v_permlane16_swap_b32 v153, v155
  s_add_u32 s38, s37, 22528
  buffer_store_dwordx4 v[144:147], v23, s[24:27], s38 offen offset:0 sc1
  buffer_store_dwordx4 v[148:151], v23, s[24:27], s38 offen offset:512 sc1
  buffer_store_dwordx4 v[152:155], v23, s[24:27], s38 offen offset:1024 sc1
  s_nop 1
  v_cvt_pk_bf16_f32 v144, v96, v97
  v_cvt_pk_bf16_f32 v145, v98, v99
  v_cvt_pk_bf16_f32 v146, v100, v101
  v_cvt_pk_bf16_f32 v147, v102, v103
  v_cvt_pk_bf16_f32 v148, v104, v105
  v_cvt_pk_bf16_f32 v149, v106, v107
  v_cvt_pk_bf16_f32 v150, v108, v109
  v_cvt_pk_bf16_f32 v151, v110, v111
  v_cvt_pk_bf16_f32 v152, v112, v113
  v_cvt_pk_bf16_f32 v153, v114, v115
  v_cvt_pk_bf16_f32 v154, v116, v117
  v_cvt_pk_bf16_f32 v155, v118, v119
  v_permlane16_swap_b32 v144, v146
  v_permlane16_swap_b32 v145, v147
  v_permlane16_swap_b32 v148, v150
  v_permlane16_swap_b32 v149, v151
  v_permlane16_swap_b32 v152, v154
  v_permlane16_swap_b32 v153, v155
  s_add_u32 s38, s37, 33792
  buffer_store_dwordx4 v[144:147], v23, s[24:27], s38 offen offset:0 sc1
  buffer_store_dwordx4 v[148:151], v23, s[24:27], s38 offen offset:512 sc1
  buffer_store_dwordx4 v[152:155], v23, s[24:27], s38 offen offset:1024 sc1
  s_nop 1
  v_cvt_pk_bf16_f32 v144, v120, v121
  v_cvt_pk_bf16_f32 v145, v122, v123
  v_cvt_pk_bf16_f32 v146, v124, v125
  v_cvt_pk_bf16_f32 v147, v126, v127
  v_cvt_pk_bf16_f32 v148, v128, v129
  v_cvt_pk_bf16_f32 v149, v130, v131
  v_cvt_pk_bf16_f32 v150, v132, v133
  v_cvt_pk_bf16_f32 v151, v134, v135
  v_cvt_pk_bf16_f32 v152, v136, v137
  v_cvt_pk_bf16_f32 v153, v138, v139
  v_cvt_pk_bf16_f32 v154, v140, v141
  v_cvt_pk_bf16_f32 v155, v142, v143
  v_permlane16_swap_b32 v144, v146
  v_permlane16_swap_b32 v145, v147
  v_permlane16_swap_b32 v148, v150
  v_permlane16_swap_b32 v149, v151
  v_permlane16_swap_b32 v152, v154
  v_permlane16_swap_b32 v153, v155
  s_add_u32 s38, s37, 45056
  buffer_store_dwordx4 v[144:147], v23, s[24:27], s38 offen offset:0 sc1
  buffer_store_dwordx4 v[148:151], v23, s[24:27], s38 offen offset:512 sc1
  buffer_store_dwordx4 v[152:155], v23, s[24:27], s38 offen offset:1024 sc1
  s_nop 1
  s_cmp_lg_u32 s18, 0
  s_cbranch_scc1 P1_dft_noalt
  s_add_u32 s28, s6, 31457280
  s_addc_u32 s29, s7, 0
  s_mov_b32 s30, 15488
  s_mov_b32 s31, 0x20000
  s_lshr_b32 s38, s16, 1
  s_cmp_eq_u32 s38, 0
  s_cselect_b32 s39, 1.0, 0
  s_cmp_eq_u32 s19, 3
  s_cselect_b32 s39, 1.0, s39
  v_fma_f32 v156, v162, s39, v156
  v_fma_f32 v157, v163, s39, v157
  v_fma_f32 v158, v164, s39, v158
  v_fma_f32 v159, v165, s39, v159
  v_fma_f32 v160, v166, s39, v160
  v_fma_f32 v161, v167, s39, v161
  s_nop 1
  v_permlane16_swap_b32 v156, v157
  v_permlane16_swap_b32 v158, v159
  v_permlane16_swap_b32 v160, v161
  s_nop 0
  v_add_f32 v156, v156, v157
  v_add_f32 v158, v158, v159
  v_add_f32 v160, v160, v161
  v_mov_b32 v157, v156
  v_mov_b32 v159, v158
  v_mov_b32 v161, v160
  s_nop 1
  v_permlane32_swap_b32 v156, v157
  v_permlane32_swap_b32 v158, v159
  v_permlane32_swap_b32 v160, v161
  s_nop 0
  v_add_f32 v156, v156, v157
  v_add_f32 v158, v158, v159
  v_add_f32 v160, v160, v161
  v_lshrrev_b32 v4, 1, v2
  v_mul_u32_u24 v4, 1408, v4
  v_and_b32 v3, 31, v1
  v_add_u32 v3, v3, v10
  v_lshl_add_u32 v4, v3, 2, v4
  v_mov_b32 v5, 0x40000000
  v_cmp_gt_u32 vcc, 32, v1
  s_nop 1
  v_cndmask_b32 v4, v5, v4, vcc
  s_mul_i32 s37, s19, 2816
  s_mul_i32 s38, s20, 640
  s_add_u32 s37, s37, s38
  buffer_store_dword v156, v4, s[28:31], s37 offen offset:0 sc1
  buffer_store_dword v158, v4, s[28:31], s37 offen offset:128 sc1
  buffer_store_dword v160, v4, s[28:31], s37 offen offset:256 sc1
P1_dft_noalt:
  s_add_u32 s64, s92, 33030144
  s_addc_u32 s65, s93, 0
  s_mov_b32 s66, 20480
  s_mov_b32 s67, 0x20000
  s_add_u32 s98, s94, 2
  v_mov_b32 v144, s98
  v_mov_b32 v145, 0x40000000
  v_cmp_gt_u32 vcc, 16, v0
  s_lshl_b32 s98, s2, 2
  v_mul_u32_u24 v146, 1280, v0
  v_cndmask_b32 v145, v145, v146, vcc
  v_readfirstlane_b32 s99, v0
  s_waitcnt vmcnt(0)
  s_barrier
  s_cmp_lg_u32 s99, 0
  s_cbranch_scc1 noflag_15
  buffer_store_dword v144, v145, s[64:67], s98 offen sc1
noflag_15:
  s_branch PH2
P1_dft_ld:
  v_and_b32 v1, 63, v0
  v_bfe_u32 v2, v0, 6, 2
  s_nop 0
  v_readfirstlane_b32 s16, v2
  s_mul_i32 s21, s19, 128*768
  v_mul_u32_u24 v3, 40, v2
  v_lshrrev_b32 v4, 3, v1
  v_add3_u32 v3, v3, v4, 0
  v_bfe_u32 v4, v3, 1, 3
  v_and_b32 v8, 7, v1
  v_xor_b32 v4, v4, v8
  v_mul_u32_u24 v9, 768, v3
  v_lshl_add_u32 v9, v4, 4, v9
  v_add_u32 v9, s21, v9
  v_mul_u32_u24 v3, 40, v2
  v_lshrrev_b32 v4, 3, v1
  v_add3_u32 v3, v3, v4, 8
  v_bfe_u32 v4, v3, 1, 3
  v_and_b32 v8, 7, v1
  v_xor_b32 v4, v4, v8
  v_mul_u32_u24 v10, 768, v3
  v_lshl_add_u32 v10, v4, 4, v10
  v_add_u32 v10, s21, v10
  v_mul_u32_u24 v3, 40, v2
  v_lshrrev_b32 v4, 3, v1
  v_add3_u32 v3, v3, v4, 16
  v_bfe_u32 v4, v3, 1, 3
  v_and_b32 v8, 7, v1
  v_xor_b32 v4, v4, v8
  v_mul_u32_u24 v11, 768, v3
  v_lshl_add_u32 v11, v4, 4, v11
  v_add_u32 v11, s21, v11
  v_mul_u32_u24 v3, 40, v2
  v_lshrrev_b32 v4, 3, v1
  v_add3_u32 v3, v3, v4, 24
  v_bfe_u32 v4, v3, 1, 3
  v_and_b32 v8, 7, v1
  v_xor_b32 v4, v4, v8
  v_mul_u32_u24 v12, 768, v3
  v_lshl_add_u32 v12, v4, 4, v12
  v_add_u32 v12, s21, v12
  v_mul_u32_u24 v3, 40, v2
  v_lshrrev_b32 v4, 3, v1
  v_add3_u32 v3, v3, v4, 32
  v_bfe_u32 v4, v3, 1, 3
  v_and_b32 v8, 7, v1
  v_xor_b32 v4, v4, v8
  v_mul_u32_u24 v13, 768, v3
  v_lshl_add_u32 v13, v4, 4, v13
  v_add_u32 v13, s21, v13
  s_mul_i32 s22, s20, 160*1280
  v_mul_u32_u24 v3, 48, v2
  v_lshrrev_b32 v4, 3, v1
  v_add3_u32 v3, v3, v4, 0
  v_bfe_u32 v4, v3, 1, 3
  v_and_b32 v8, 7, v1
  v_xor_b32 v4, v4, v8
  v_mul_u32_u24 v14, 1280, v3
  v_lshl_add_u32 v14, v4, 4, v14
  v_add_u32 v14, s22, v14
  v_mul_u32_u24 v3, 48, v2
  v_lshrrev_b32 v4, 3, v1
  v_add3_u32 v3, v3, v4, 8
  v_bfe_u32 v4, v3, 1, 3
  v_and_b32 v8, 7, v1
  v_xor_b32 v4, v4, v8
  v_mul_u32_u24 v15, 1280, v3
  v_lshl_add_u32 v15, v4, 4, v15
  v_add_u32 v15, s22, v15
  v_mul_u32_u24 v3, 48, v2
  v_lshrrev_b32 v4, 3, v1
  v_add3_u32 v3, v3, v4, 16
  v_bfe_u32 v4, v3, 1, 3
  v_and_b32 v8, 7, v1
  v_xor_b32 v4, v4, v8
  v_mul_u32_u24 v16, 1280, v3
  v_lshl_add_u32 v16, v4, 4, v16
  v_add_u32 v16, s22, v16
  v_mul_u32_u24 v3, 48, v2
  v_lshrrev_b32 v4, 3, v1
  v_add3_u32 v3, v3, v4, 24
  v_bfe_u32 v4, v3, 1, 3
  v_and_b32 v8, 7, v1
  v_xor_b32 v4, v4, v8
  v_mul_u32_u24 v17, 1280, v3
  v_lshl_add_u32 v17, v4, 4, v17
  v_add_u32 v17, s22, v17
  v_mul_u32_u24 v3, 48, v2
  v_lshrrev_b32 v4, 3, v1
  v_add3_u32 v3, v3, v4, 32
  v_bfe_u32 v4, v3, 1, 3
  v_and_b32 v8, 7, v1
  v_xor_b32 v4, v4, v8
  v_mul_u32_u24 v18, 1280, v3
  v_lshl_add_u32 v18, v4, 4, v18
  v_add_u32 v18, s22, v18
  v_mul_u32_u24 v3, 48, v2
  v_lshrrev_b32 v4, 3, v1
  v_add3_u32 v3, v3, v4, 40
  v_bfe_u32 v4, v3, 1, 3
  v_and_b32 v8, 7, v1
  v_xor_b32 v4, v4, v8
  v_mul_u32_u24 v19, 1280, v3
  v_lshl_add_u32 v19, v4, 4, v19
  v_add_u32 v19, s22, v19
  s_mul_i32 s34, s16, 5120
  s_mul_i32 s35, s16, 6144
  s_mov_b32 s32, 0
  s_mov_b32 s33, 0
  s_waitcnt lgkmcnt(0)
  s_mul_i32 s36, s18, 524288
  s_add_u32 s36, s36, 3145728
  s_add_u32 s24, s6, s36
  s_addc_u32 s25, s7, 0
  s_mov_b32 s26, 393984
  s_mov_b32 s27, 0x20000
  s_cmp_ge_u32 s18, 2
  s_cselect_b32 s28, s10, s8
  s_cselect_b32 s29, s11, s9
  s_mov_b32 s30, 819200
  s_mov_b32 s31, 0x20000
  s_mov_b32 s97, 1
  s_cmp_lg_u32 s16, 0
  s_cbranch_scc1 pre_16
  s_add_u32 s64, s92, 33030144
  s_addc_u32 s65, s93, 0
  s_mov_b32 s66, 20480
  s_mov_b32 s67, 0x20000
  v_lshlrev_b32 v24, 4, v1
  s_and_b32 s98, s2, 15
  s_mul_i32 s98, s98, 1280
  v_add_u32 v24, s98, v24
  s_add_u32 s98, s94, 1
  s_mov_b32 s97, 0
pre_16:
  s_waitcnt vmcnt(0)
  s_barrier
  s_add_u32 m0, s35, 20480
  s_nop 0
  buffer_load_dwordx4 v14, s[28:31], s33 offen  lds
  s_add_u32 m0, s35, 21504
  s_nop 0
  buffer_load_dwordx4 v15, s[28:31], s33 offen  lds
  s_add_u32 m0, s35, 22528
  s_nop 0
  buffer_load_dwordx4 v16, s[28:31], s33 offen  lds
  s_add_u32 m0, s35, 23552
  s_nop 0
  buffer_load_dwordx4 v17, s[28:31], s33 offen  lds
  s_add_u32 m0, s35, 24576
  s_nop 0
  buffer_load_dwordx4 v18, s[28:31], s33 offen  lds
  s_add_u32 m0, s35, 25600
  s_nop 0
  buffer_load_dwordx4 v19, s[28:31], s33 offen  lds
  s_add_u32 s33, s33, 128
  s_add_u32 m0, s35, 65536
  s_nop 0
  buffer_load_dwordx4 v14, s[28:31], s33 offen  lds
  s_add_u32 m0, s35, 66560
  s_nop 0
  buffer_load_dwordx4 v15, s[28:31], s33 offen  lds
  s_add_u32 m0, s35, 67584
  s_nop 0
  buffer_load_dwordx4 v16, s[28:31], s33 offen  lds
  s_add_u32 m0, s35, 68608
  s_nop 0
  buffer_load_dwordx4 v17, s[28:31], s33 offen  lds
  s_add_u32 m0, s35, 69632
  s_nop 0
  buffer_load_dwordx4 v18, s[28:31], s33 offen  lds
  s_add_u32 m0, s35, 70656
  s_nop 0
  buffer_load_dwordx4 v19, s[28:31], s33 offen  lds
  s_add_u32 s33, s33, 128
  s_add_u32 m0, s35, 110592
  s_nop 0
  buffer_load_dwordx4 v14, s[28:31], s33 offen  lds
  s_add_u32 m0, s35, 111616
  s_nop 0
  buffer_load_dwordx4 v15, s[28:31], s33 offen  lds
  s_add_u32 m0, s35, 112640
  s_nop 0
  buffer_load_dwordx4 v16, s[28:31], s33 offen  lds
  s_add_u32 m0, s35, 113664
  s_nop 0
  buffer_load_dwordx4 v17, s[28:31], s33 offen  lds
  s_add_u32 m0, s35, 114688
  s_nop 0
  buffer_load_dwordx4 v18, s[28:31], s33 offen  lds
  s_add_u32 m0, s35, 115712
  s_nop 0
  buffer_load_dwordx4 v19, s[28:31], s33 offen  lds
  s_add_u32 s33, s33, 128
  s_cmp_eq_u32 s97, 1
  s_cbranch_scc1 pollskip_18
  s_mov_b32 s99, 0
poll_17:
  buffer_load_dwordx4 v[20:23], v24, s[64:67], 0 offen sc1
  s_waitcnt vmcnt(0)
  v_subrev_u32 v20, s98, v20
  v_subrev_u32 v21, s98, v21
  v_subrev_u32 v22, s98, v22
  v_subrev_u32 v23, s98, v23
  v_max_u32 v20, v20, v21
  v_max_u32 v22, v22, v23
  v_max_u32 v20, v20, v22
  v_cmp_ge_u32 vcc, 2, v20
  s_add_u32 s99, s99, 1
  s_cmp_eq_u64 vcc, exec
  s_cbranch_scc1 pollskip_18
  s_cmp_lt_u32 s99, 40000
  s_cbranch_scc1 poll_17
pollskip_18:
  s_barrier
  s_add_u32 m0, s34, 0
  s_nop 0
  buffer_load_dwordx4 v9, s[24:27], s32 offen sc1 lds
  s_add_u32 m0, s34, 1024
  s_nop 0
  buffer_load_dwordx4 v10, s[24:27], s32 offen sc1 lds
  s_add_u32 m0, s34, 2048
  s_nop 0
  buffer_load_dwordx4 v11, s[24:27], s32 offen sc1 lds
  s_add_u32 m0, s34, 3072
  s_nop 0
  buffer_load_dwordx4 v12, s[24:27], s32 offen sc1 lds
  s_add_u32 m0, s34, 4096
  s_nop 0
  buffer_load_dwordx4 v13, s[24:27], s32 offen sc1 lds
  s_add_u32 s32, s32, 128
  s_add_u32 m0, s34, 45056
  s_nop 0
  buffer_load_dwordx4 v9, s[24:27], s32 offen sc1 lds
  s_add_u32 m0, s34, 46080
  s_nop 0
  buffer_load_dwordx4 v10, s[24:27], s32 offen sc1 lds
  s_add_u32 m0, s34, 47104
  s_nop 0
  buffer_load_dwordx4 v11, s[24:27], s32 offen sc1 lds
  s_add_u32 m0, s34, 48128
  s_nop 0
  buffer_load_dwordx4 v12, s[24:27], s32 offen sc1 lds
  s_add_u32 m0, s34, 49152
  s_nop 0
  buffer_load_dwordx4 v13, s[24:27], s32 offen sc1 lds
  s_add_u32 s32, s32, 128
  s_waitcnt vmcnt(5)
  s_barrier
  s_add_u32 m0, s34, 90112
  s_nop 0
  buffer_load_dwordx4 v9, s[24:27], s32 offen sc1 lds
  s_add_u32 m0, s34, 91136
  s_nop 0
  buffer_load_dwordx4 v10, s[24:27], s32 offen sc1 lds
  s_add_u32 m0, s34, 92160
  s_nop 0
  buffer_load_dwordx4 v11, s[24:27], s32 offen sc1 lds
  s_add_u32 m0, s34, 93184
  s_nop 0
  buffer_load_dwordx4 v12, s[24:27], s32 offen sc1 lds
  s_add_u32 m0, s34, 94208
  s_nop 0
  buffer_load_dwordx4 v13, s[24:27], s32 offen sc1 lds
  s_add_u32 s32, s32, 128
  s_waitcnt vmcnt(5)
  s_barrier
  s_add_u32 m0, s34, 0
  s_nop 0
  buffer_load_dwordx4 v9, s[24:27], s32 offen sc1 lds
  s_add_u32 m0, s34, 1024
  s_nop 0
  buffer_load_dwordx4 v10, s[24:27], s32 offen sc1 lds
  s_add_u32 m0, s34, 2048
  s_nop 0
  buffer_load_dwordx4 v11, s[24:27], s32 offen sc1 lds
  s_add_u32 m0, s34, 3072
  s_nop 0
  buffer_load_dwordx4 v12, s[24:27], s32 offen sc1 lds
  s_add_u32 m0, s34, 4096
  s_nop 0
  buffer_load_dwordx4 v13, s[24:27], s32 offen sc1 lds
  s_add_u32 s32, s32, 128
  s_add_u32 m0, s35, 20480
  s_nop 0
  buffer_load_dwordx4 v14, s[28:31], s33 offen  lds
  s_add_u32 m0, s35, 21504
  s_nop 0
  buffer_load_dwordx4 v15, s[28:31], s33 offen  lds
  s_add_u32 m0, s35, 22528
  s_nop 0
  buffer_load_dwordx4 v16, s[28:31], s33 offen  lds
  s_add_u32 m0, s35, 23552
  s_nop 0
  buffer_load_dwordx4 v17, s[28:31], s33 offen  lds
  s_add_u32 m0, s35, 24576
  s_nop 0
  buffer_load_dwordx4 v18, s[28:31], s33 offen  lds
  s_add_u32 m0, s35, 25600
  s_nop 0
  buffer_load_dwordx4 v19, s[28:31], s33 offen  lds
  s_add_u32 s33, s33, 128
  s_waitcnt vmcnt(11)
  s_barrier
  s_add_u32 m0, s34, 45056
  s_nop 0
  buffer_load_dwordx4 v9, s[24:27], s32 offen sc1 lds
  s_add_u32 m0, s34, 46080
  s_nop 0
  buffer_load_dwordx4 v10, s[24:27], s32 offen sc1 lds
  s_add_u32 m0, s34, 47104
  s_nop 0
  buffer_load_dwordx4 v11, s[24:27], s32 offen sc1 lds
  s_add_u32 m0, s34, 48128
  s_nop 0
  buffer_load_dwordx4 v12, s[24:27], s32 offen sc1 lds
  s_add_u32 m0, s34, 49152
  s_nop 0
  buffer_load_dwordx4 v13, s[24:27], s32 offen sc1 lds
  s_add_u32 s32, s32, 128
  s_add_u32 m0, s35, 65536
  s_nop 0
  buffer_load_dwordx4 v14, s[28:31], s33 offen  lds
  s_add_u32 m0, s35, 66560
  s_nop 0
  buffer_load_dwordx4 v15, s[28:31], s33 offen  lds
  s_add_u32 m0, s35, 67584
  s_nop 0
  buffer_load_dwordx4 v16, s[28:31], s33 offen  lds
  s_add_u32 m0, s35, 68608
  s_nop 0
  buffer_load_dwordx4 v17, s[28:31], s33 offen  lds
  s_add_u32 m0, s35, 69632
  s_nop 0
  buffer_load_dwordx4 v18, s[28:31], s33 offen  lds
  s_add_u32 m0, s35, 70656
  s_nop 0
  buffer_load_dwordx4 v19, s[28:31], s33 offen  lds
  s_add_u32 s33, s33, 128
  s_waitcnt vmcnt(11)
  s_barrier
  s_add_u32 m0, s34, 90112
  s_nop 0
  buffer_load_dwordx4 v9, s[24:27], s32 offen sc1 lds
  s_add_u32 m0, s34, 91136
  s_nop 0
  buffer_load_dwordx4 v10, s[24:27], s32 offen sc1 lds
  s_add_u32 m0, s34, 92160
  s_nop 0
  buffer_load_dwordx4 v11, s[24:27], s32 offen sc1 lds
  s_add_u32 m0, s34, 93184
  s_nop 0
  buffer_load_dwordx4 v12, s[24:27], s32 offen sc1 lds
  s_add_u32 m0, s34, 94208
  s_nop 0
  buffer_load_dwordx4 v13, s[24:27], s32 offen sc1 lds
  s_add_u32 s32, s32, 128
  s_add_u32 m0, s35, 110592
  s_nop 0
  buffer_load_dwordx4 v14, s[28:31], s33 offen  lds
  s_add_u32 m0, s35, 111616
  s_nop 0
  buffer_load_dwordx4 v15, s[28:31], s33 offen  lds
  s_add_u32 m0, s35, 112640
  s_nop 0
  buffer_load_dwordx4 v16, s[28:31], s33 offen  lds
  s_add_u32 m0, s35, 113664
  s_nop 0
  buffer_load_dwordx4 v17, s[28:31], s33 offen  lds
  s_add_u32 m0, s35, 114688
  s_nop 0
  buffer_load_dwordx4 v18, s[28:31], s33 offen  lds
  s_add_u32 m0, s35, 115712
  s_nop 0
  buffer_load_dwordx4 v19, s[28:31], s33 offen  lds
  s_add_u32 s33, s33, 128
  s_waitcnt vmcnt(11)
  s_barrier
  s_waitcnt vmcnt(0)
  s_barrier
  s_branch PH2
PH2:
  s_mov_b32 s4, s82
  s_mov_b32 s5, s83
  s_mov_b32 s6, s92
  s_mov_b32 s7, s93
  s_mov_b32 s8, s70
  s_mov_b32 s9, s71
  s_mov_b32 s10, s72
  s_mov_b32 s11, s73
  s_mov_b32 s12, s84
  s_mov_b32 s13, s85
  s_and_b32 s14, s2, 7
  s_lshr_b32 s15, s2, 3
  s_cmp_ge_u32 s15, 28
  s_cbranch_scc1 P2_dft
  s_and_b32 s17, s14, 1
  s_lshr_b32 s18, s14, 1
  s_lshl_b32 s18, s18, 2
  s_mul_i32 s19, s15, 37
  s_lshr_b32 s19, s19, 8
  s_add_u32 s18, s18, s19
  s_mul_i32 s19, s19, 7
  s_sub_u32 s19, s15, s19
  s_mul_i32 s20, s19, 557056
  v_readfirstlane_b32 s98, v0
  s_nop 3
  s_cmp_ge_u32 s98, 256
  s_cbranch_scc1 P2_g_ld
  v_and_b32 v1, 63, v0
  v_bfe_u32 v2, v0, 6, 2
  s_nop 0
  v_readfirstlane_b32 s16, v2
  v_lshrrev_b32 v9, 1, v2
  v_lshlrev_b32 v9, 2, v9
  v_and_b32 v10, 1, v2
  v_lshlrev_b32 v10, 6, v10
  v_lshrrev_b32 v3, 4, v1
  v_mul_u32_u24 v4, 2048, v3
  v_bfe_u32 v6, v1, 1, 1
  v_lshl_add_u32 v4, v6, 7, v4
  v_and_b32 v6, 1, v1
  v_lshl_add_u32 v4, v6, 3, v4
  v_bfe_u32 v5, v1, 2, 2
  v_and_b32 v3, 1, v3
  v_lshl_add_u32 v5, v3, 2, v5
  v_lshl_add_u32 v4, v5, 4, v4
  v_lshl_add_u32 v4, v9, 8, v4
  v_add_u32 v80, 0, v4
  v_xor_b32 v81, 64, v80
  v_add_u32 v82, 65536, v80
  v_add_u32 v83, 65536, v81
  v_add_u32 v84, 131072, v80
  v_add_u32 v85, 131072, v81
  v_and_b32 v3, 15, v1
  v_add_u32 v3, v3, v10
  v_bfe_u32 v4, v3, 1, 3
  v_lshrrev_b32 v5, 4, v1
  v_xor_b32 v4, v4, v5
  v_lshlrev_b32 v4, 4, v4
  v_lshl_add_u32 v4, v3, 7, v4
  v_xor_b32 v86, 0, v4
  v_add_u32 v86, 16384, v86
  v_xor_b32 v87, 64, v4
  v_add_u32 v87, 16384, v87
  v_add_u32 v88, 65536, v86
  v_add_u32 v89, 65536, v87
  v_add_u32 v90, 131072, v86
  v_add_u32 v91, 131072, v87
  v_lshrrev_b32 v3, 5, v1
  v_lshl_add_u32 v3, v9, 1, v3
  v_mul_u32_u24 v11, 34816, v3
  v_and_b32 v3, 31, v1
  v_add_u32 v3, v3, v10
  v_lshl_add_u32 v11, v3, 4, v11
  s_lshl_b32 s45, s18, 11
  s_add_u32 s45, s45, s20
  s_waitcnt lgkmcnt(0)
  s_add_u32 s36, s6, 8388608
  s_addc_u32 s37, s7, 0
  s_mov_b32 s38, 3760128
  s_mov_b32 s39, 0x20000
  s_mov_b32 s40, s12
  s_mov_b32 s41, s13
  s_mov_b32 s42, 4096
  s_mov_b32 s43, 0x20000
  s_mul_i32 s48, s17, 4194304
  s_add_u32 s48, s48, 16777216
  s_add_u32 s52, s6, s48
  s_addc_u32 s53, s7, 0
  s_mov_b32 s54, 3760128
  s_mov_b32 s55, 0x20000
  v_and_b32 v3, 15, v1
  v_add_u32 v3, v3, v10
  s_lshl_b32 s48, s18, 7
  v_add_u32 v3, s48, v3
  v_lshlrev_b32 v3, 1, v3
  buffer_load_ushort v76, v3, s[40:43], 0 offen offset:0
  buffer_load_ushort v77, v3, s[40:43], 0 offen offset:32
  buffer_load_ushort v78, v3, s[40:43], 0 offen offset:64
  buffer_load_ushort v79, v3, s[40:43], 0 offen offset:96
  s_cmp_eq_u32 s17, 1
  s_cselect_b32 s48, -1, 0
  s_waitcnt vmcnt(0)
  v_lshlrev_b32 v76, 16, v76
  v_and_b32 v76, s48, v76
  v_lshlrev_b32 v77, 16, v77
  v_and_b32 v77, s48, v77
  v_lshlrev_b32 v78, 16, v78
  v_and_b32 v78, s48, v78
  v_lshlrev_b32 v79, 16, v79
  v_and_b32 v79, s48, v79
  v_mov_b32 v92, v76
  v_mov_b32 v93, v76
  v_mov_b32 v94, v76
  v_mov_b32 v95, v76
  v_mov_b32 v96, v77
  v_mov_b32 v97, v77
  v_mov_b32 v98, v77
  v_mov_b32 v99, v77
  v_mov_b32 v100, v78
  v_mov_b32 v101, v78
  v_mov_b32 v102, v78
  v_mov_b32 v103, v78
  v_mov_b32 v104, v79
  v_mov_b32 v105, v79
  v_mov_b32 v106, v79
  v_mov_b32 v107, v79
  v_mov_b32 v108, v76
  v_mov_b32 v109, v76
  v_mov_b32 v110, v76
  v_mov_b32 v111, v76
  v_mov_b32 v112, v77
  v_mov_b32 v113, v77
  v_mov_b32 v114, v77
  v_mov_b32 v115, v77
  v_mov_b32 v116, v78
  v_mov_b32 v117, v78
  v_mov_b32 v118, v78
  v_mov_b32 v119, v78
  v_mov_b32 v120, v79
  v_mov_b32 v121, v79
  v_mov_b32 v122, v79
  v_mov_b32 v123, v79
  v_mov_b32 v124, v76
  v_mov_b32 v125, v76
  v_mov_b32 v126, v76
  v_mov_b32 v127, v76
  v_mov_b32 v128, v77
  v_mov_b32 v129, v77
  v_mov_b32 v130, v77
  v_mov_b32 v131, v77
  v_mov_b32 v132, v78
  v_mov_b32 v133, v78
  v_mov_b32 v134, v78
  v_mov_b32 v135, v78
  v_mov_b32 v136, v79
  v_mov_b32 v137, v79
  v_mov_b32 v138, v79
  v_mov_b32 v139, v79
  v_mov_b32 v140, v76
  v_mov_b32 v141, v76
  v_mov_b32 v142, v76
  v_mov_b32 v143, v76
  v_mov_b32 v144, v77
  v_mov_b32 v145, v77
  v_mov_b32 v146, v77
  v_mov_b32 v147, v77
  v_mov_b32 v148, v78
  v_mov_b32 v149, v78
  v_mov_b32 v150, v78
  v_mov_b32 v151, v78
  v_mov_b32 v152, v79
  v_mov_b32 v153, v79
  v_mov_b32 v154, v79
  v_mov_b32 v155, v79
  s_barrier
  s_barrier
  ds_read_b64_tr_b16 v[156:157], v80 offset:0
  ds_read_b64_tr_b16 v[158:159], v81 offset:0
  ds_read_b128 v[160:163], v86 offset:0
  ds_read_b128 v[164:167], v86 offset:2048
  ds_read_b64_tr_b16 v[168:169], v81 offset:256
  ds_read_b64_tr_b16 v[170:171], v80 offset:256
  ds_read_b128 v[172:175], v86 offset:4096
  ds_read_b128 v[176:179], v86 offset:6144
  ds_read_b64_tr_b16 v[180:181], v80 offset:512
  ds_read_b64_tr_b16 v[182:183], v81 offset:512
  ds_read_b64_tr_b16 v[184:185], v81 offset:768
  ds_read_b64_tr_b16 v[186:187], v80 offset:768
  s_waitcnt lgkmcnt(9)
  v_mfma_f32_16x16x32_bf16 v[92:95], v[156:159], v[160:163], v[92:95]
  ds_read_b64_tr_b16 v[188:189], v80 offset:8192
  s_waitcnt lgkmcnt(9)
  v_mfma_f32_16x16x32_bf16 v[96:99], v[156:159], v[164:167], v[96:99]
  ds_read_b64_tr_b16 v[190:191], v81 offset:8192
  s_waitcnt lgkmcnt(8)
  v_mfma_f32_16x16x32_bf16 v[108:111], v[168:171], v[160:163], v[108:111]
  ds_read_b128 v[192:195], v87 offset:0
  v_mfma_f32_16x16x32_bf16 v[112:115], v[168:171], v[164:167], v[112:115]
  ds_read_b128 v[196:199], v87 offset:2048
  s_waitcnt lgkmcnt(9)
  v_mfma_f32_16x16x32_bf16 v[100:103], v[156:159], v[172:175], v[100:103]
  ds_read_b64_tr_b16 v[200:201], v81 offset:8448
  s_waitcnt lgkmcnt(9)
  v_mfma_f32_16x16x32_bf16 v[104:107], v[156:159], v[176:179], v[104:107]
  ds_read_b64_tr_b16 v[202:203], v80 offset:8448
  v_mfma_f32_16x16x32_bf16 v[116:119], v[168:171], v[172:175], v[116:119]
  ds_read_b128 v[204:207], v87 offset:4096
  v_mfma_f32_16x16x32_bf16 v[120:123], v[168:171], v[176:179], v[120:123]
  ds_read_b128 v[208:211], v87 offset:6144
  s_waitcnt lgkmcnt(10)
  v_mfma_f32_16x16x32_bf16 v[124:127], v[180:183], v[160:163], v[124:127]
  ds_read_b64_tr_b16 v[212:213], v80 offset:8704
  v_mfma_f32_16x16x32_bf16 v[128:131], v[180:183], v[164:167], v[128:131]
  ds_read_b64_tr_b16 v[214:215], v81 offset:8704
  s_waitcnt lgkmcnt(10)
  v_mfma_f32_16x16x32_bf16 v[140:143], v[184:187], v[160:163], v[140:143]
  ds_read_b64_tr_b16 v[216:217], v81 offset:8960
  v_mfma_f32_16x16x32_bf16 v[144:147], v[184:187], v[164:167], v[144:147]
  ds_read_b64_tr_b16 v[218:219], v80 offset:8960
  v_mfma_f32_16x16x32_bf16 v[132:135], v[180:183], v[172:175], v[132:135]
  v_mfma_f32_16x16x32_bf16 v[136:139], v[180:183], v[176:179], v[136:139]
  v_mfma_f32_16x16x32_bf16 v[148:151], v[184:187], v[172:175], v[148:151]
  v_mfma_f32_16x16x32_bf16 v[152:155], v[184:187], v[176:179], v[152:155]
  s_waitcnt lgkmcnt(9)
  v_mfma_f32_16x16x32_bf16 v[92:95], v[188:191], v[192:195], v[92:95]
  s_waitcnt lgkmcnt(8)
  v_mfma_f32_16x16x32_bf16 v[96:99], v[188:191], v[196:199], v[96:99]
  s_waitcnt lgkmcnt(0)
  s_barrier
  ds_read_b64_tr_b16 v[156:157], v80 offset:32768
  v_mfma_f32_16x16x32_bf16 v[108:111], v[200:203], v[192:195], v[108:111]
  ds_read_b64_tr_b16 v[158:159], v81 offset:32768
  v_mfma_f32_16x16x32_bf16 v[112:115], v[200:203], v[196:199], v[112:115]
  ds_read_b128 v[160:163], v86 offset:32768
  v_mfma_f32_16x16x32_bf16 v[100:103], v[188:191], v[204:207], v[100:103]
  ds_read_b128 v[164:167], v86 offset:34816
  v_mfma_f32_16x16x32_bf16 v[104:107], v[188:191], v[208:211], v[104:107]
  ds_read_b64_tr_b16 v[168:169], v81 offset:33024
  v_mfma_f32_16x16x32_bf16 v[116:119], v[200:203], v[204:207], v[116:119]
  ds_read_b64_tr_b16 v[170:171], v80 offset:33024
  v_mfma_f32_16x16x32_bf16 v[120:123], v[200:203], v[208:211], v[120:123]
  ds_read_b128 v[172:175], v86 offset:36864
  v_mfma_f32_16x16x32_bf16 v[124:127], v[212:215], v[192:195], v[124:127]
  ds_read_b128 v[176:179], v86 offset:38912
  v_mfma_f32_16x16x32_bf16 v[128:131], v[212:215], v[196:199], v[128:131]
  ds_read_b64_tr_b16 v[180:181], v80 offset:33280
  v_mfma_f32_16x16x32_bf16 v[140:143], v[216:219], v[192:195], v[140:143]
  ds_read_b64_tr_b16 v[182:183], v81 offset:33280
  v_mfma_f32_16x16x32_bf16 v[144:147], v[216:219], v[196:199], v[144:147]
  ds_read_b64_tr_b16 v[184:185], v81 offset:33536
  v_mfma_f32_16x16x32_bf16 v[132:135], v[212:215], v[204:207], v[132:135]
  ds_read_b64_tr_b16 v[186:187], v80 offset:33536
  v_mfma_f32_16x16x32_bf16 v[136:139], v[212:215], v[208:211], v[136:139]
  v_mfma_f32_16x16x32_bf16 v[148:151], v[216:219], v[204:207], v[148:151]
  v_mfma_f32_16x16x32_bf16 v[152:155], v[216:219], v[208:211], v[152:155]
  s_waitcnt lgkmcnt(9)
  v_mfma_f32_16x16x32_bf16 v[92:95], v[156:159], v[160:163], v[92:95]
  ds_read_b64_tr_b16 v[188:189], v80 offset:40960
  s_waitcnt lgkmcnt(9)
  v_mfma_f32_16x16x32_bf16 v[96:99], v[156:159], v[164:167], v[96:99]
  ds_read_b64_tr_b16 v[190:191], v81 offset:40960
  s_waitcnt lgkmcnt(8)
  v_mfma_f32_16x16x32_bf16 v[108:111], v[168:171], v[160:163], v[108:111]
  ds_read_b128 v[192:195], v87 offset:32768
  v_mfma_f32_16x16x32_bf16 v[112:115], v[168:171], v[164:167], v[112:115]
  ds_read_b128 v[196:199], v87 offset:34816
  s_waitcnt lgkmcnt(9)
  v_mfma_f32_16x16x32_bf16 v[100:103], v[156:159], v[172:175], v[100:103]
  ds_read_b64_tr_b16 v[200:201], v81 offset:41216
  s_waitcnt lgkmcnt(9)
  v_mfma_f32_16x16x32_bf16 v[104:107], v[156:159], v[176:179], v[104:107]
  ds_read_b64_tr_b16 v[202:203], v80 offset:41216
  v_mfma_f32_16x16x32_bf16 v[116:119], v[168:171], v[172:175], v[116:119]
  ds_read_b128 v[204:207], v87 offset:36864
  v_mfma_f32_16x16x32_bf16 v[120:123], v[168:171], v[176:179], v[120:123]
  ds_read_b128 v[208:211], v87 offset:38912
  s_waitcnt lgkmcnt(10)
  v_mfma_f32_16x16x32_bf16 v[124:127], v[180:183], v[160:163], v[124:127]
  ds_read_b64_tr_b16 v[212:213], v80 offset:41472
  v_mfma_f32_16x16x32_bf16 v[128:131], v[180:183], v[164:167], v[128:131]
  ds_read_b64_tr_b16 v[214:215], v81 offset:41472
  s_waitcnt lgkmcnt(10)
  v_mfma_f32_16x16x32_bf16 v[140:143], v[184:187], v[160:163], v[140:143]
  ds_read_b64_tr_b16 v[216:217], v81 offset:41728
  v_mfma_f32_16x16x32_bf16 v[144:147], v[184:187], v[164:167], v[144:147]
  ds_read_b64_tr_b16 v[218:219], v80 offset:41728
  v_mfma_f32_16x16x32_bf16 v[132:135], v[180:183], v[172:175], v[132:135]
  v_mfma_f32_16x16x32_bf16 v[136:139], v[180:183], v[176:179], v[136:139]
  v_mfma_f32_16x16x32_bf16 v[148:151], v[184:187], v[172:175], v[148:151]
  v_mfma_f32_16x16x32_bf16 v[152:155], v[184:187], v[176:179], v[152:155]
  s_waitcnt lgkmcnt(9)
  v_mfma_f32_16x16x32_bf16 v[92:95], v[188:191], v[192:195], v[92:95]
  s_waitcnt lgkmcnt(8)
  v_mfma_f32_16x16x32_bf16 v[96:99], v[188:191], v[196:199], v[96:99]
  s_waitcnt lgkmcnt(0)
  s_barrier
  ds_read_b64_tr_b16 v[156:157], v82 offset:0
  v_mfma_f32_16x16x32_bf16 v[108:111], v[200:203], v[192:195], v[108:111]
  ds_read_b64_tr_b16 v[158:159], v83 offset:0
  v_mfma_f32_16x16x32_bf16 v[112:115], v[200:203], v[196:199], v[112:115]
  ds_read_b128 v[160:163], v88 offset:0
  v_mfma_f32_16x16x32_bf16 v[100:103], v[188:191], v[204:207], v[100:103]
  ds_read_b128 v[164:167], v88 offset:2048
  v_mfma_f32_16x16x32_bf16 v[104:107], v[188:191], v[208:211], v[104:107]
  ds_read_b64_tr_b16 v[168:169], v83 offset:256
  v_mfma_f32_16x16x32_bf16 v[116:119], v[200:203], v[204:207], v[116:119]
  ds_read_b64_tr_b16 v[170:171], v82 offset:256
  v_mfma_f32_16x16x32_bf16 v[120:123], v[200:203], v[208:211], v[120:123]
  ds_read_b128 v[172:175], v88 offset:4096
  v_mfma_f32_16x16x32_bf16 v[124:127], v[212:215], v[192:195], v[124:127]
  ds_read_b128 v[176:179], v88 offset:6144
  v_mfma_f32_16x16x32_bf16 v[128:131], v[212:215], v[196:199], v[128:131]
  ds_read_b64_tr_b16 v[180:181], v82 offset:512
  v_mfma_f32_16x16x32_bf16 v[140:143], v[216:219], v[192:195], v[140:143]
  ds_read_b64_tr_b16 v[182:183], v83 offset:512
  v_mfma_f32_16x16x32_bf16 v[144:147], v[216:219], v[196:199], v[144:147]
  ds_read_b64_tr_b16 v[184:185], v83 offset:768
  v_mfma_f32_16x16x32_bf16 v[132:135], v[212:215], v[204:207], v[132:135]
  ds_read_b64_tr_b16 v[186:187], v82 offset:768
  v_mfma_f32_16x16x32_bf16 v[136:139], v[212:215], v[208:211], v[136:139]
  v_mfma_f32_16x16x32_bf16 v[148:151], v[216:219], v[204:207], v[148:151]
  v_mfma_f32_16x16x32_bf16 v[152:155], v[216:219], v[208:211], v[152:155]
  s_waitcnt lgkmcnt(9)
  v_mfma_f32_16x16x32_bf16 v[92:95], v[156:159], v[160:163], v[92:95]
  ds_read_b64_tr_b16 v[188:189], v82 offset:8192
  s_waitcnt lgkmcnt(9)
  v_mfma_f32_16x16x32_bf16 v[96:99], v[156:159], v[164:167], v[96:99]
  ds_read_b64_tr_b16 v[190:191], v83 offset:8192
  s_waitcnt lgkmcnt(8)
  v_mfma_f32_16x16x32_bf16 v[108:111], v[168:171], v[160:163], v[108:111]
  ds_read_b128 v[192:195], v89 offset:0
  v_mfma_f32_16x16x32_bf16 v[112:115], v[168:171], v[164:167], v[112:115]
  ds_read_b128 v[196:199], v89 offset:2048
  s_waitcnt lgkmcnt(9)
  v_mfma_f32_16x16x32_bf16 v[100:103], v[156:159], v[172:175], v[100:103]
  ds_read_b64_tr_b16 v[200:201], v83 offset:8448
  s_waitcnt lgkmcnt(9)
  v_mfma_f32_16x16x32_bf16 v[104:107], v[156:159], v[176:179], v[104:107]
  ds_read_b64_tr_b16 v[202:203], v82 offset:8448
  v_mfma_f32_16x16x32_bf16 v[116:119], v[168:171], v[172:175], v[116:119]
  ds_read_b128 v[204:207], v89 offset:4096
  v_mfma_f32_16x16x32_bf16 v[120:123], v[168:171], v[176:179], v[120:123]
  ds_read_b128 v[208:211], v89 offset:6144
  s_waitcnt lgkmcnt(10)
  v_mfma_f32_16x16x32_bf16 v[124:127], v[180:183], v[160:163], v[124:127]
  ds_read_b64_tr_b16 v[212:213], v82 offset:8704
  v_mfma_f32_16x16x32_bf16 v[128:131], v[180:183], v[164:167], v[128:131]
  ds_read_b64_tr_b16 v[214:215], v83 offset:8704
  s_waitcnt lgkmcnt(10)
  v_mfma_f32_16x16x32_bf16 v[140:143], v[184:187], v[160:163], v[140:143]
  ds_read_b64_tr_b16 v[216:217], v83 offset:8960
  v_mfma_f32_16x16x32_bf16 v[144:147], v[184:187], v[164:167], v[144:147]
  ds_read_b64_tr_b16 v[218:219], v82 offset:8960
  v_mfma_f32_16x16x32_bf16 v[132:135], v[180:183], v[172:175], v[132:135]
  v_mfma_f32_16x16x32_bf16 v[136:139], v[180:183], v[176:179], v[136:139]
  v_mfma_f32_16x16x32_bf16 v[148:151], v[184:187], v[172:175], v[148:151]
  v_mfma_f32_16x16x32_bf16 v[152:155], v[184:187], v[176:179], v[152:155]
  s_waitcnt lgkmcnt(9)
  v_mfma_f32_16x16x32_bf16 v[92:95], v[188:191], v[192:195], v[92:95]
  s_waitcnt lgkmcnt(8)
  v_mfma_f32_16x16x32_bf16 v[96:99], v[188:191], v[196:199], v[96:99]
  s_waitcnt lgkmcnt(0)
  s_barrier
  ds_read_b64_tr_b16 v[156:157], v82 offset:32768
  v_mfma_f32_16x16x32_bf16 v[108:111], v[200:203], v[192:195], v[108:111]
  ds_read_b64_tr_b16 v[158:159], v83 offset:32768
  v_mfma_f32_16x16x32_bf16 v[112:115], v[200:203], v[196:199], v[112:115]
  ds_read_b128 v[160:163], v88 offset:32768
  v_mfma_f32_16x16x32_bf16 v[100:103], v[188:191], v[204:207], v[100:103]
  ds_read_b128 v[164:167], v88 offset:34816
  v_mfma_f32_16x16x32_bf16 v[104:107], v[188:191], v[208:211], v[104:107]
  ds_read_b64_tr_b16 v[168:169], v83 offset:33024
  v_mfma_f32_16x16x32_bf16 v[116:119], v[200:203], v[204:207], v[116:119]
  ds_read_b64_tr_b16 v[170:171], v82 offset:33024
  v_mfma_f32_16x16x32_bf16 v[120:123], v[200:203], v[208:211], v[120:123]
  ds_read_b128 v[172:175], v88 offset:36864
  v_mfma_f32_16x16x32_bf16 v[124:127], v[212:215], v[192:195], v[124:127]
  ds_read_b128 v[176:179], v88 offset:38912
  v_mfma_f32_16x16x32_bf16 v[128:131], v[212:215], v[196:199], v[128:131]
  ds_read_b64_tr_b16 v[180:181], v82 offset:33280
  v_mfma_f32_16x16x32_bf16 v[140:143], v[216:219], v[192:195], v[140:143]
  ds_read_b64_tr_b16 v[182:183], v83 offset:33280
  v_mfma_f32_16x16x32_bf16 v[144:147], v[216:219], v[196:199], v[144:147]
  ds_read_b64_tr_b16 v[184:185], v83 offset:33536
  v_mfma_f32_16x16x32_bf16 v[132:135], v[212:215], v[204:207], v[132:135]
  ds_read_b64_tr_b16 v[186:187], v82 offset:33536
  v_mfma_f32_16x16x32_bf16 v[136:139], v[212:215], v[208:211], v[136:139]
  v_mfma_f32_16x16x32_bf16 v[148:151], v[216:219], v[204:207], v[148:151]
  v_mfma_f32_16x16x32_bf16 v[152:155], v[216:219], v[208:211], v[152:155]
  s_waitcnt lgkmcnt(9)
  v_mfma_f32_16x16x32_bf16 v[92:95], v[156:159], v[160:163], v[92:95]
  ds_read_b64_tr_b16 v[188:189], v82 offset:40960
  s_waitcnt lgkmcnt(9)
  v_mfma_f32_16x16x32_bf16 v[96:99], v[156:159], v[164:167], v[96:99]
  ds_read_b64_tr_b16 v[190:191], v83 offset:40960
  s_waitcnt lgkmcnt(8)
  v_mfma_f32_16x16x32_bf16 v[108:111], v[168:171], v[160:163], v[108:111]
  ds_read_b128 v[192:195], v89 offset:32768
  v_mfma_f32_16x16x32_bf16 v[112:115], v[168:171], v[164:167], v[112:115]
  ds_read_b128 v[196:199], v89 offset:34816
  s_waitcnt lgkmcnt(9)
  v_mfma_f32_16x16x32_bf16 v[100:103], v[156:159], v[172:175], v[100:103]
  ds_read_b64_tr_b16 v[200:201], v83 offset:41216
  s_waitcnt lgkmcnt(9)
  v_mfma_f32_16x16x32_bf16 v[104:107], v[156:159], v[176:179], v[104:107]
  ds_read_b64_tr_b16 v[202:203], v82 offset:41216
  v_mfma_f32_16x16x32_bf16 v[116:119], v[168:171], v[172:175], v[116:119]
  ds_read_b128 v[204:207], v89 offset:36864
  v_mfma_f32_16x16x32_bf16 v[120:123], v[168:171], v[176:179], v[120:123]
  ds_read_b128 v[208:211], v89 offset:38912
  s_waitcnt lgkmcnt(10)
  v_mfma_f32_16x16x32_bf16 v[124:127], v[180:183], v[160:163], v[124:127]
  ds_read_b64_tr_b16 v[212:213], v82 offset:41472
  v_mfma_f32_16x16x32_bf16 v[128:131], v[180:183], v[164:167], v[128:131]
  ds_read_b64_tr_b16 v[214:215], v83 offset:41472
  s_waitcnt lgkmcnt(10)
  v_mfma_f32_16x16x32_bf16 v[140:143], v[184:187], v[160:163], v[140:143]
  ds_read_b64_tr_b16 v[216:217], v83 offset:41728
  v_mfma_f32_16x16x32_bf16 v[144:147], v[184:187], v[164:167], v[144:147]
  ds_read_b64_tr_b16 v[218:219], v82 offset:41728
  v_mfma_f32_16x16x32_bf16 v[132:135], v[180:183], v[172:175], v[132:135]
  v_mfma_f32_16x16x32_bf16 v[136:139], v[180:183], v[176:179], v[136:139]
  v_mfma_f32_16x16x32_bf16 v[148:151], v[184:187], v[172:175], v[148:151]
  v_mfma_f32_16x16x32_bf16 v[152:155], v[184:187], v[176:179], v[152:155]
  s_waitcnt lgkmcnt(9)
  v_mfma_f32_16x16x32_bf16 v[92:95], v[188:191], v[192:195], v[92:95]
  s_waitcnt lgkmcnt(8)
  v_mfma_f32_16x16x32_bf16 v[96:99], v[188:191], v[196:199], v[96:99]
  s_waitcnt lgkmcnt(0)
  s_barrier
  ds_read_b64_tr_b16 v[156:157], v84 offset:0
  v_mfma_f32_16x16x32_bf16 v[108:111], v[200:203], v[192:195], v[108:111]
  ds_read_b64_tr_b16 v[158:159], v85 offset:0
  v_mfma_f32_16x16x32_bf16 v[112:115], v[200:203], v[196:199], v[112:115]
  ds_read_b128 v[160:163], v90 offset:0
  v_mfma_f32_16x16x32_bf16 v[100:103], v[188:191], v[204:207], v[100:103]
  ds_read_b128 v[164:167], v90 offset:2048
  v_mfma_f32_16x16x32_bf16 v[104:107], v[188:191], v[208:211], v[104:107]
  ds_read_b64_tr_b16 v[168:169], v85 offset:256
  v_mfma_f32_16x16x32_bf16 v[116:119], v[200:203], v[204:207], v[116:119]
  ds_read_b64_tr_b16 v[170:171], v84 offset:256
  v_mfma_f32_16x16x32_bf16 v[120:123], v[200:203], v[208:211], v[120:123]
  ds_read_b128 v[172:175], v90 offset:4096
  v_mfma_f32_16x16x32_bf16 v[124:127], v[212:215], v[192:195], v[124:127]
  ds_read_b128 v[176:179], v90 offset:6144
  v_mfma_f32_16x16x32_bf16 v[128:131], v[212:215], v[196:199], v[128:131]
  ds_read_b64_tr_b16 v[180:181], v84 offset:512
  v_mfma_f32_16x16x32_bf16 v[140:143], v[216:219], v[192:195], v[140:143]
  ds_read_b64_tr_b16 v[182:183], v85 offset:512
  v_mfma_f32_16x16x32_bf16 v[144:147], v[216:219], v[196:199], v[144:147]
  ds_read_b64_tr_b16 v[184:185], v85 offset:768
  v_mfma_f32_16x16x32_bf16 v[132:135], v[212:215], v[204:207], v[132:135]
  ds_read_b64_tr_b16 v[186:187], v84 offset:768
  v_mfma_f32_16x16x32_bf16 v[136:139], v[212:215], v[208:211], v[136:139]
  v_mfma_f32_16x16x32_bf16 v[148:151], v[216:219], v[204:207], v[148:151]
  v_mfma_f32_16x16x32_bf16 v[152:155], v[216:219], v[208:211], v[152:155]
  s_waitcnt lgkmcnt(9)
  v_mfma_f32_16x16x32_bf16 v[92:95], v[156:159], v[160:163], v[92:95]
  ds_read_b64_tr_b16 v[188:189], v84 offset:8192
  s_waitcnt lgkmcnt(9)
  v_mfma_f32_16x16x32_bf16 v[96:99], v[156:159], v[164:167], v[96:99]
  ds_read_b64_tr_b16 v[190:191], v85 offset:8192
  s_waitcnt lgkmcnt(8)
  v_mfma_f32_16x16x32_bf16 v[108:111], v[168:171], v[160:163], v[108:111]
  ds_read_b128 v[192:195], v91 offset:0
  v_mfma_f32_16x16x32_bf16 v[112:115], v[168:171], v[164:167], v[112:115]
  ds_read_b128 v[196:199], v91 offset:2048
  s_waitcnt lgkmcnt(9)
  v_mfma_f32_16x16x32_bf16 v[100:103], v[156:159], v[172:175], v[100:103]
  ds_read_b64_tr_b16 v[200:201], v85 offset:8448
  s_waitcnt lgkmcnt(9)
  v_mfma_f32_16x16x32_bf16 v[104:107], v[156:159], v[176:179], v[104:107]
  ds_read_b64_tr_b16 v[202:203], v84 offset:8448
  v_mfma_f32_16x16x32_bf16 v[116:119], v[168:171], v[172:175], v[116:119]
  ds_read_b128 v[204:207], v91 offset:4096
  v_mfma_f32_16x16x32_bf16 v[120:123], v[168:171], v[176:179], v[120:123]
  ds_read_b128 v[208:211], v91 offset:6144
  s_waitcnt lgkmcnt(10)
  v_mfma_f32_16x16x32_bf16 v[124:127], v[180:183], v[160:163], v[124:127]
  ds_read_b64_tr_b16 v[212:213], v84 offset:8704
  v_mfma_f32_16x16x32_bf16 v[128:131], v[180:183], v[164:167], v[128:131]
  ds_read_b64_tr_b16 v[214:215], v85 offset:8704
  s_waitcnt lgkmcnt(10)
  v_mfma_f32_16x16x32_bf16 v[140:143], v[184:187], v[160:163], v[140:143]
  ds_read_b64_tr_b16 v[216:217], v85 offset:8960
  v_mfma_f32_16x16x32_bf16 v[144:147], v[184:187], v[164:167], v[144:147]
  ds_read_b64_tr_b16 v[218:219], v84 offset:8960
  v_mfma_f32_16x16x32_bf16 v[132:135], v[180:183], v[172:175], v[132:135]
  v_mfma_f32_16x16x32_bf16 v[136:139], v[180:183], v[176:179], v[136:139]
  v_mfma_f32_16x16x32_bf16 v[148:151], v[184:187], v[172:175], v[148:151]
  v_mfma_f32_16x16x32_bf16 v[152:155], v[184:187], v[176:179], v[152:155]
  s_waitcnt lgkmcnt(9)
  v_mfma_f32_16x16x32_bf16 v[92:95], v[188:191], v[192:195], v[92:95]
  s_waitcnt lgkmcnt(8)
  v_mfma_f32_16x16x32_bf16 v[96:99], v[188:191], v[196:199], v[96:99]
  s_waitcnt lgkmcnt(0)
  s_barrier
  ds_read_b64_tr_b16 v[156:157], v80 offset:0
  v_mfma_f32_16x16x32_bf16 v[108:111], v[200:203], v[192:195], v[108:111]
  ds_read_b64_tr_b16 v[158:159], v81 offset:0
  v_mfma_f32_16x16x32_bf16 v[112:115], v[200:203], v[196:199], v[112:115]
  ds_read_b128 v[160:163], v86 offset:0
  v_mfma_f32_16x16x32_bf16 v[100:103], v[188:191], v[204:207], v[100:103]
  ds_read_b128 v[164:167], v86 offset:2048
  v_mfma_f32_16x16x32_bf16 v[104:107], v[188:191], v[208:211], v[104:107]
  ds_read_b64_tr_b16 v[168:169], v81 offset:256
  v_mfma_f32_16x16x32_bf16 v[116:119], v[200:203], v[204:207], v[116:119]
  ds_read_b64_tr_b16 v[170:171], v80 offset:256
  v_mfma_f32_16x16x32_bf16 v[120:123], v[200:203], v[208:211], v[120:123]
  ds_read_b128 v[172:175], v86 offset:4096
  v_mfma_f32_16x16x32_bf16 v[124:127], v[212:215], v[192:195], v[124:127]
  ds_read_b128 v[176:179], v86 offset:6144
  v_mfma_f32_16x16x32_bf16 v[128:131], v[212:215], v[196:199], v[128:131]
  ds_read_b64_tr_b16 v[180:181], v80 offset:512
  v_mfma_f32_16x16x32_bf16 v[140:143], v[216:219], v[192:195], v[140:143]
  ds_read_b64_tr_b16 v[182:183], v81 offset:512
  v_mfma_f32_16x16x32_bf16 v[144:147], v[216:219], v[196:199], v[144:147]
  ds_read_b64_tr_b16 v[184:185], v81 offset:768
  v_mfma_f32_16x16x32_bf16 v[132:135], v[212:215], v[204:207], v[132:135]
  ds_read_b64_tr_b16 v[186:187], v80 offset:768
  v_mfma_f32_16x16x32_bf16 v[136:139], v[212:215], v[208:211], v[136:139]
  v_mfma_f32_16x16x32_bf16 v[148:151], v[216:219], v[204:207], v[148:151]
  v_mfma_f32_16x16x32_bf16 v[152:155], v[216:219], v[208:211], v[152:155]
  s_waitcnt lgkmcnt(9)
  v_mfma_f32_16x16x32_bf16 v[92:95], v[156:159], v[160:163], v[92:95]
  ds_read_b64_tr_b16 v[188:189], v80 offset:8192
  s_waitcnt lgkmcnt(9)
  v_mfma_f32_16x16x32_bf16 v[96:99], v[156:159], v[164:167], v[96:99]
  ds_read_b64_tr_b16 v[190:191], v81 offset:8192
  s_waitcnt lgkmcnt(8)
  v_mfma_f32_16x16x32_bf16 v[108:111], v[168:171], v[160:163], v[108:111]
  ds_read_b128 v[192:195], v87 offset:0
  v_mfma_f32_16x16x32_bf16 v[112:115], v[168:171], v[164:167], v[112:115]
  ds_read_b128 v[196:199], v87 offset:2048
  s_waitcnt lgkmcnt(9)
  v_mfma_f32_16x16x32_bf16 v[100:103], v[156:159], v[172:175], v[100:103]
  ds_read_b64_tr_b16 v[200:201], v81 offset:8448
  s_waitcnt lgkmcnt(9)
  v_mfma_f32_16x16x32_bf16 v[104:107], v[156:159], v[176:179], v[104:107]
  ds_read_b64_tr_b16 v[202:203], v80 offset:8448
  v_mfma_f32_16x16x32_bf16 v[116:119], v[168:171], v[172:175], v[116:119]
  ds_read_b128 v[204:207], v87 offset:4096
  v_mfma_f32_16x16x32_bf16 v[120:123], v[168:171], v[176:179], v[120:123]
  ds_read_b128 v[208:211], v87 offset:6144
  s_waitcnt lgkmcnt(10)
  v_mfma_f32_16x16x32_bf16 v[124:127], v[180:183], v[160:163], v[124:127]
  ds_read_b64_tr_b16 v[212:213], v80 offset:8704
  v_mfma_f32_16x16x32_bf16 v[128:131], v[180:183], v[164:167], v[128:131]
  ds_read_b64_tr_b16 v[214:215], v81 offset:8704
  s_waitcnt lgkmcnt(10)
  v_mfma_f32_16x16x32_bf16 v[140:143], v[184:187], v[160:163], v[140:143]
  ds_read_b64_tr_b16 v[216:217], v81 offset:8960
  v_mfma_f32_16x16x32_bf16 v[144:147], v[184:187], v[164:167], v[144:147]
  ds_read_b64_tr_b16 v[218:219], v80 offset:8960
  v_mfma_f32_16x16x32_bf16 v[132:135], v[180:183], v[172:175], v[132:135]
  v_mfma_f32_16x16x32_bf16 v[136:139], v[180:183], v[176:179], v[136:139]
  v_mfma_f32_16x16x32_bf16 v[148:151], v[184:187], v[172:175], v[148:151]
  v_mfma_f32_16x16x32_bf16 v[152:155], v[184:187], v[176:179], v[152:155]
  s_waitcnt lgkmcnt(9)
  v_mfma_f32_16x16x32_bf16 v[92:95], v[188:191], v[192:195], v[92:95]
  s_waitcnt lgkmcnt(8)
  v_mfma_f32_16x16x32_bf16 v[96:99], v[188:191], v[196:199], v[96:99]
  s_waitcnt lgkmcnt(0)
  s_barrier
  ds_read_b64_tr_b16 v[156:157], v80 offset:32768
  v_mfma_f32_16x16x32_bf16 v[108:111], v[200:203], v[192:195], v[108:111]
  ds_read_b64_tr_b16 v[158:159], v81 offset:32768
  v_mfma_f32_16x16x32_bf16 v[112:115], v[200:203], v[196:199], v[112:115]
  ds_read_b128 v[160:163], v86 offset:32768
  v_mfma_f32_16x16x32_bf16 v[100:103], v[188:191], v[204:207], v[100:103]
  ds_read_b128 v[164:167], v86 offset:34816
  v_mfma_f32_16x16x32_bf16 v[104:107], v[188:191], v[208:211], v[104:107]
  ds_read_b64_tr_b16 v[168:169], v81 offset:33024
  v_mfma_f32_16x16x32_bf16 v[116:119], v[200:203], v[204:207], v[116:119]
  ds_read_b64_tr_b16 v[170:171], v80 offset:33024
  v_mfma_f32_16x16x32_bf16 v[120:123], v[200:203], v[208:211], v[120:123]
  ds_read_b128 v[172:175], v86 offset:36864
  v_mfma_f32_16x16x32_bf16 v[124:127], v[212:215], v[192:195], v[124:127]
  ds_read_b128 v[176:179], v86 offset:38912
  v_mfma_f32_16x16x32_bf16 v[128:131], v[212:215], v[196:199], v[128:131]
  ds_read_b64_tr_b16 v[180:181], v80 offset:33280
  v_mfma_f32_16x16x32_bf16 v[140:143], v[216:219], v[192:195], v[140:143]
  ds_read_b64_tr_b16 v[182:183], v81 offset:33280
  v_mfma_f32_16x16x32_bf16 v[144:147], v[216:219], v[196:199], v[144:147]
  ds_read_b64_tr_b16 v[184:185], v81 offset:33536
  v_mfma_f32_16x16x32_bf16 v[132:135], v[212:215], v[204:207], v[132:135]
  ds_read_b64_tr_b16 v[186:187], v80 offset:33536
  v_mfma_f32_16x16x32_bf16 v[136:139], v[212:215], v[208:211], v[136:139]
  v_mfma_f32_16x16x32_bf16 v[148:151], v[216:219], v[204:207], v[148:151]
  v_mfma_f32_16x16x32_bf16 v[152:155], v[216:219], v[208:211], v[152:155]
  s_waitcnt lgkmcnt(9)
  v_mfma_f32_16x16x32_bf16 v[92:95], v[156:159], v[160:163], v[92:95]
  ds_read_b64_tr_b16 v[188:189], v80 offset:40960
  s_waitcnt lgkmcnt(9)
  v_mfma_f32_16x16x32_bf16 v[96:99], v[156:159], v[164:167], v[96:99]
  ds_read_b64_tr_b16 v[190:191], v81 offset:40960
  s_waitcnt lgkmcnt(8)
  v_mfma_f32_16x16x32_bf16 v[108:111], v[168:171], v[160:163], v[108:111]
  ds_read_b128 v[192:195], v87 offset:32768
  v_mfma_f32_16x16x32_bf16 v[112:115], v[168:171], v[164:167], v[112:115]
  ds_read_b128 v[196:199], v87 offset:34816
  s_waitcnt lgkmcnt(9)
  v_mfma_f32_16x16x32_bf16 v[100:103], v[156:159], v[172:175], v[100:103]
  ds_read_b64_tr_b16 v[200:201], v81 offset:41216
  s_waitcnt lgkmcnt(9)
  v_mfma_f32_16x16x32_bf16 v[104:107], v[156:159], v[176:179], v[104:107]
  ds_read_b64_tr_b16 v[202:203], v80 offset:41216
  v_mfma_f32_16x16x32_bf16 v[116:119], v[168:171], v[172:175], v[116:119]
  ds_read_b128 v[204:207], v87 offset:36864
  v_mfma_f32_16x16x32_bf16 v[120:123], v[168:171], v[176:179], v[120:123]
  ds_read_b128 v[208:211], v87 offset:38912
  s_waitcnt lgkmcnt(10)
  v_mfma_f32_16x16x32_bf16 v[124:127], v[180:183], v[160:163], v[124:127]
  ds_read_b64_tr_b16 v[212:213], v80 offset:41472
  v_mfma_f32_16x16x32_bf16 v[128:131], v[180:183], v[164:167], v[128:131]
  ds_read_b64_tr_b16 v[214:215], v81 offset:41472
  s_waitcnt lgkmcnt(10)
  v_mfma_f32_16x16x32_bf16 v[140:143], v[184:187], v[160:163], v[140:143]
  ds_read_b64_tr_b16 v[216:217], v81 offset:41728
  v_mfma_f32_16x16x32_bf16 v[144:147], v[184:187], v[164:167], v[144:147]
  ds_read_b64_tr_b16 v[218:219], v80 offset:41728
  v_mfma_f32_16x16x32_bf16 v[132:135], v[180:183], v[172:175], v[132:135]
  v_mfma_f32_16x16x32_bf16 v[136:139], v[180:183], v[176:179], v[136:139]
  v_mfma_f32_16x16x32_bf16 v[148:151], v[184:187], v[172:175], v[148:151]
  v_mfma_f32_16x16x32_bf16 v[152:155], v[184:187], v[176:179], v[152:155]
  s_waitcnt lgkmcnt(9)
  v_mfma_f32_16x16x32_bf16 v[92:95], v[188:191], v[192:195], v[92:95]
  s_waitcnt lgkmcnt(8)
  v_mfma_f32_16x16x32_bf16 v[96:99], v[188:191], v[196:199], v[96:99]
  s_waitcnt lgkmcnt(0)
  s_barrier
  ds_read_b64_tr_b16 v[156:157], v82 offset:0
  v_mfma_f32_16x16x32_bf16 v[108:111], v[200:203], v[192:195], v[108:111]
  ds_read_b64_tr_b16 v[158:159], v83 offset:0
  v_mfma_f32_16x16x32_bf16 v[112:115], v[200:203], v[196:199], v[112:115]
  ds_read_b128 v[160:163], v88 offset:0
  v_mfma_f32_16x16x32_bf16 v[100:103], v[188:191], v[204:207], v[100:103]
  ds_read_b128 v[164:167], v88 offset:2048
  v_mfma_f32_16x16x32_bf16 v[104:107], v[188:191], v[208:211], v[104:107]
  ds_read_b64_tr_b16 v[168:169], v83 offset:256
  v_mfma_f32_16x16x32_bf16 v[116:119], v[200:203], v[204:207], v[116:119]
  ds_read_b64_tr_b16 v[170:171], v82 offset:256
  v_mfma_f32_16x16x32_bf16 v[120:123], v[200:203], v[208:211], v[120:123]
  ds_read_b128 v[172:175], v88 offset:4096
  v_mfma_f32_16x16x32_bf16 v[124:127], v[212:215], v[192:195], v[124:127]
  ds_read_b128 v[176:179], v88 offset:6144
  v_mfma_f32_16x16x32_bf16 v[128:131], v[212:215], v[196:199], v[128:131]
  ds_read_b64_tr_b16 v[180:181], v82 offset:512
  v_mfma_f32_16x16x32_bf16 v[140:143], v[216:219], v[192:195], v[140:143]
  ds_read_b64_tr_b16 v[182:183], v83 offset:512
  v_mfma_f32_16x16x32_bf16 v[144:147], v[216:219], v[196:199], v[144:147]
  ds_read_b64_tr_b16 v[184:185], v83 offset:768
  v_mfma_f32_16x16x32_bf16 v[132:135], v[212:215], v[204:207], v[132:135]
  ds_read_b64_tr_b16 v[186:187], v82 offset:768
  v_mfma_f32_16x16x32_bf16 v[136:139], v[212:215], v[208:211], v[136:139]
  v_mfma_f32_16x16x32_bf16 v[148:151], v[216:219], v[204:207], v[148:151]
  v_mfma_f32_16x16x32_bf16 v[152:155], v[216:219], v[208:211], v[152:155]
  s_waitcnt lgkmcnt(9)
  v_mfma_f32_16x16x32_bf16 v[92:95], v[156:159], v[160:163], v[92:95]
  ds_read_b64_tr_b16 v[188:189], v82 offset:8192
  s_waitcnt lgkmcnt(9)
  v_mfma_f32_16x16x32_bf16 v[96:99], v[156:159], v[164:167], v[96:99]
  ds_read_b64_tr_b16 v[190:191], v83 offset:8192
  s_waitcnt lgkmcnt(8)
  v_mfma_f32_16x16x32_bf16 v[108:111], v[168:171], v[160:163], v[108:111]
  ds_read_b128 v[192:195], v89 offset:0
  v_mfma_f32_16x16x32_bf16 v[112:115], v[168:171], v[164:167], v[112:115]
  ds_read_b128 v[196:199], v89 offset:2048
  s_waitcnt lgkmcnt(9)
  v_mfma_f32_16x16x32_bf16 v[100:103], v[156:159], v[172:175], v[100:103]
  ds_read_b64_tr_b16 v[200:201], v83 offset:8448
  s_waitcnt lgkmcnt(9)
  v_mfma_f32_16x16x32_bf16 v[104:107], v[156:159], v[176:179], v[104:107]
  ds_read_b64_tr_b16 v[202:203], v82 offset:8448
  v_mfma_f32_16x16x32_bf16 v[116:119], v[168:171], v[172:175], v[116:119]
  ds_read_b128 v[204:207], v89 offset:4096
  v_mfma_f32_16x16x32_bf16 v[120:123], v[168:171], v[176:179], v[120:123]
  ds_read_b128 v[208:211], v89 offset:6144
  s_waitcnt lgkmcnt(10)
  v_mfma_f32_16x16x32_bf16 v[124:127], v[180:183], v[160:163], v[124:127]
  ds_read_b64_tr_b16 v[212:213], v82 offset:8704
  v_mfma_f32_16x16x32_bf16 v[128:131], v[180:183], v[164:167], v[128:131]
  ds_read_b64_tr_b16 v[214:215], v83 offset:8704
  s_waitcnt lgkmcnt(10)
  v_mfma_f32_16x16x32_bf16 v[140:143], v[184:187], v[160:163], v[140:143]
  ds_read_b64_tr_b16 v[216:217], v83 offset:8960
  v_mfma_f32_16x16x32_bf16 v[144:147], v[184:187], v[164:167], v[144:147]
  ds_read_b64_tr_b16 v[218:219], v82 offset:8960
  v_mfma_f32_16x16x32_bf16 v[132:135], v[180:183], v[172:175], v[132:135]
  v_mfma_f32_16x16x32_bf16 v[136:139], v[180:183], v[176:179], v[136:139]
  v_mfma_f32_16x16x32_bf16 v[148:151], v[184:187], v[172:175], v[148:151]
  v_mfma_f32_16x16x32_bf16 v[152:155], v[184:187], v[176:179], v[152:155]
  s_waitcnt lgkmcnt(9)
  v_mfma_f32_16x16x32_bf16 v[92:95], v[188:191], v[192:195], v[92:95]
  s_waitcnt lgkmcnt(8)
  v_mfma_f32_16x16x32_bf16 v[96:99], v[188:191], v[196:199], v[96:99]
  s_waitcnt lgkmcnt(0)
  s_barrier
  ds_read_b64_tr_b16 v[156:157], v82 offset:32768
  v_mfma_f32_16x16x32_bf16 v[108:111], v[200:203], v[192:195], v[108:111]
  ds_read_b64_tr_b16 v[158:159], v83 offset:32768
  v_mfma_f32_16x16x32_bf16 v[112:115], v[200:203], v[196:199], v[112:115]
  ds_read_b128 v[160:163], v88 offset:32768
  v_mfma_f32_16x16x32_bf16 v[100:103], v[188:191], v[204:207], v[100:103]
  ds_read_b128 v[164:167], v88 offset:34816
  v_mfma_f32_16x16x32_bf16 v[104:107], v[188:191], v[208:211], v[104:107]
  ds_read_b64_tr_b16 v[168:169], v83 offset:33024
  v_mfma_f32_16x16x32_bf16 v[116:119], v[200:203], v[204:207], v[116:119]
  ds_read_b64_tr_b16 v[170:171], v82 offset:33024
  v_mfma_f32_16x16x32_bf16 v[120:123], v[200:203], v[208:211], v[120:123]
  ds_read_b128 v[172:175], v88 offset:36864
  v_mfma_f32_16x16x32_bf16 v[124:127], v[212:215], v[192:195], v[124:127]
  ds_read_b128 v[176:179], v88 offset:38912
  v_mfma_f32_16x16x32_bf16 v[128:131], v[212:215], v[196:199], v[128:131]
  ds_read_b64_tr_b16 v[180:181], v82 offset:33280
  v_mfma_f32_16x16x32_bf16 v[140:143], v[216:219], v[192:195], v[140:143]
  ds_read_b64_tr_b16 v[182:183], v83 offset:33280
  v_mfma_f32_16x16x32_bf16 v[144:147], v[216:219], v[196:199], v[144:147]
  ds_read_b64_tr_b16 v[184:185], v83 offset:33536
  v_mfma_f32_16x16x32_bf16 v[132:135], v[212:215], v[204:207], v[132:135]
  ds_read_b64_tr_b16 v[186:187], v82 offset:33536
  v_mfma_f32_16x16x32_bf16 v[136:139], v[212:215], v[208:211], v[136:139]
  v_mfma_f32_16x16x32_bf16 v[148:151], v[216:219], v[204:207], v[148:151]
  v_mfma_f32_16x16x32_bf16 v[152:155], v[216:219], v[208:211], v[152:155]
  s_waitcnt lgkmcnt(9)
  v_mfma_f32_16x16x32_bf16 v[92:95], v[156:159], v[160:163], v[92:95]
  ds_read_b64_tr_b16 v[188:189], v82 offset:40960
  s_waitcnt lgkmcnt(9)
  v_mfma_f32_16x16x32_bf16 v[96:99], v[156:159], v[164:167], v[96:99]
  ds_read_b64_tr_b16 v[190:191], v83 offset:40960
  s_waitcnt lgkmcnt(8)
  v_mfma_f32_16x16x32_bf16 v[108:111], v[168:171], v[160:163], v[108:111]
  ds_read_b128 v[192:195], v89 offset:32768
  v_mfma_f32_16x16x32_bf16 v[112:115], v[168:171], v[164:167], v[112:115]
  ds_read_b128 v[196:199], v89 offset:34816
  s_waitcnt lgkmcnt(9)
  v_mfma_f32_16x16x32_bf16 v[100:103], v[156:159], v[172:175], v[100:103]
  ds_read_b64_tr_b16 v[200:201], v83 offset:41216
  s_waitcnt lgkmcnt(9)
  v_mfma_f32_16x16x32_bf16 v[104:107], v[156:159], v[176:179], v[104:107]
  ds_read_b64_tr_b16 v[202:203], v82 offset:41216
  v_mfma_f32_16x16x32_bf16 v[116:119], v[168:171], v[172:175], v[116:119]
  ds_read_b128 v[204:207], v89 offset:36864
  v_mfma_f32_16x16x32_bf16 v[120:123], v[168:171], v[176:179], v[120:123]
  ds_read_b128 v[208:211], v89 offset:38912
  s_waitcnt lgkmcnt(10)
  v_mfma_f32_16x16x32_bf16 v[124:127], v[180:183], v[160:163], v[124:127]
  ds_read_b64_tr_b16 v[212:213], v82 offset:41472
  v_mfma_f32_16x16x32_bf16 v[128:131], v[180:183], v[164:167], v[128:131]
  ds_read_b64_tr_b16 v[214:215], v83 offset:41472
  s_waitcnt lgkmcnt(10)
  v_mfma_f32_16x16x32_bf16 v[140:143], v[184:187], v[160:163], v[140:143]
  ds_read_b64_tr_b16 v[216:217], v83 offset:41728
  v_mfma_f32_16x16x32_bf16 v[144:147], v[184:187], v[164:167], v[144:147]
  ds_read_b64_tr_b16 v[218:219], v82 offset:41728
  v_mfma_f32_16x16x32_bf16 v[132:135], v[180:183], v[172:175], v[132:135]
  v_mfma_f32_16x16x32_bf16 v[136:139], v[180:183], v[176:179], v[136:139]
  v_mfma_f32_16x16x32_bf16 v[148:151], v[184:187], v[172:175], v[148:151]
  v_mfma_f32_16x16x32_bf16 v[152:155], v[184:187], v[176:179], v[152:155]
  s_waitcnt lgkmcnt(9)
  v_mfma_f32_16x16x32_bf16 v[92:95], v[188:191], v[192:195], v[92:95]
  s_waitcnt lgkmcnt(8)
  v_mfma_f32_16x16x32_bf16 v[96:99], v[188:191], v[196:199], v[96:99]
  s_waitcnt lgkmcnt(0)
  s_barrier
  ds_read_b64_tr_b16 v[156:157], v84 offset:0
  v_mfma_f32_16x16x32_bf16 v[108:111], v[200:203], v[192:195], v[108:111]
  ds_read_b64_tr_b16 v[158:159], v85 offset:0
  v_mfma_f32_16x16x32_bf16 v[112:115], v[200:203], v[196:199], v[112:115]
  ds_read_b128 v[160:163], v90 offset:0
  v_mfma_f32_16x16x32_bf16 v[100:103], v[188:191], v[204:207], v[100:103]
  ds_read_b128 v[164:167], v90 offset:2048
  v_mfma_f32_16x16x32_bf16 v[104:107], v[188:191], v[208:211], v[104:107]
  ds_read_b64_tr_b16 v[168:169], v85 offset:256
  v_mfma_f32_16x16x32_bf16 v[116:119], v[200:203], v[204:207], v[116:119]
  ds_read_b64_tr_b16 v[170:171], v84 offset:256
  v_mfma_f32_16x16x32_bf16 v[120:123], v[200:203], v[208:211], v[120:123]
  ds_read_b128 v[172:175], v90 offset:4096
  v_mfma_f32_16x16x32_bf16 v[124:127], v[212:215], v[192:195], v[124:127]
  ds_read_b128 v[176:179], v90 offset:6144
  v_mfma_f32_16x16x32_bf16 v[128:131], v[212:215], v[196:199], v[128:131]
  ds_read_b64_tr_b16 v[180:181], v84 offset:512
  v_mfma_f32_16x16x32_bf16 v[140:143], v[216:219], v[192:195], v[140:143]
  ds_read_b64_tr_b16 v[182:183], v85 offset:512
  v_mfma_f32_16x16x32_bf16 v[144:147], v[216:219], v[196:199], v[144:147]
  ds_read_b64_tr_b16 v[184:185], v85 offset:768
  v_mfma_f32_16x16x32_bf16 v[132:135], v[212:215], v[204:207], v[132:135]
  ds_read_b64_tr_b16 v[186:187], v84 offset:768
  v_mfma_f32_16x16x32_bf16 v[136:139], v[212:215], v[208:211], v[136:139]
  v_mfma_f32_16x16x32_bf16 v[148:151], v[216:219], v[204:207], v[148:151]
  v_mfma_f32_16x16x32_bf16 v[152:155], v[216:219], v[208:211], v[152:155]
  s_waitcnt lgkmcnt(9)
  v_mfma_f32_16x16x32_bf16 v[92:95], v[156:159], v[160:163], v[92:95]
  ds_read_b64_tr_b16 v[188:189], v84 offset:8192
  s_waitcnt lgkmcnt(9)
  v_mfma_f32_16x16x32_bf16 v[96:99], v[156:159], v[164:167], v[96:99]
  ds_read_b64_tr_b16 v[190:191], v85 offset:8192
  s_waitcnt lgkmcnt(8)
  v_mfma_f32_16x16x32_bf16 v[108:111], v[168:171], v[160:163], v[108:111]
  ds_read_b128 v[192:195], v91 offset:0
  v_mfma_f32_16x16x32_bf16 v[112:115], v[168:171], v[164:167], v[112:115]
  ds_read_b128 v[196:199], v91 offset:2048
  s_waitcnt lgkmcnt(9)
  v_mfma_f32_16x16x32_bf16 v[100:103], v[156:159], v[172:175], v[100:103]
  ds_read_b64_tr_b16 v[200:201], v85 offset:8448
  s_waitcnt lgkmcnt(9)
  v_mfma_f32_16x16x32_bf16 v[104:107], v[156:159], v[176:179], v[104:107]
  ds_read_b64_tr_b16 v[202:203], v84 offset:8448
  v_mfma_f32_16x16x32_bf16 v[116:119], v[168:171], v[172:175], v[116:119]
  ds_read_b128 v[204:207], v91 offset:4096
  v_mfma_f32_16x16x32_bf16 v[120:123], v[168:171], v[176:179], v[120:123]
  ds_read_b128 v[208:211], v91 offset:6144
  s_waitcnt lgkmcnt(10)
  v_mfma_f32_16x16x32_bf16 v[124:127], v[180:183], v[160:163], v[124:127]
  ds_read_b64_tr_b16 v[212:213], v84 offset:8704
  v_mfma_f32_16x16x32_bf16 v[128:131], v[180:183], v[164:167], v[128:131]
  ds_read_b64_tr_b16 v[214:215], v85 offset:8704
  s_waitcnt lgkmcnt(10)
  v_mfma_f32_16x16x32_bf16 v[140:143], v[184:187], v[160:163], v[140:143]
  ds_read_b64_tr_b16 v[216:217], v85 offset:8960
  v_mfma_f32_16x16x32_bf16 v[144:147], v[184:187], v[164:167], v[144:147]
  ds_read_b64_tr_b16 v[218:219], v84 offset:8960
  v_mfma_f32_16x16x32_bf16 v[132:135], v[180:183], v[172:175], v[132:135]
  v_mfma_f32_16x16x32_bf16 v[136:139], v[180:183], v[176:179], v[136:139]
  v_mfma_f32_16x16x32_bf16 v[148:151], v[184:187], v[172:175], v[148:151]
  v_mfma_f32_16x16x32_bf16 v[152:155], v[184:187], v[176:179], v[152:155]
  s_waitcnt lgkmcnt(9)
  v_mfma_f32_16x16x32_bf16 v[92:95], v[188:191], v[192:195], v[92:95]
  s_waitcnt lgkmcnt(8)
  v_mfma_f32_16x16x32_bf16 v[96:99], v[188:191], v[196:199], v[96:99]
  s_waitcnt lgkmcnt(0)
  s_barrier
  ds_read_b64_tr_b16 v[156:157], v80 offset:0
  v_mfma_f32_16x16x32_bf16 v[108:111], v[200:203], v[192:195], v[108:111]
  ds_read_b64_tr_b16 v[158:159], v81 offset:0
  v_mfma_f32_16x16x32_bf16 v[112:115], v[200:203], v[196:199], v[112:115]
  ds_read_b128 v[160:163], v86 offset:0
  v_mfma_f32_16x16x32_bf16 v[100:103], v[188:191], v[204:207], v[100:103]
  ds_read_b128 v[164:167], v86 offset:2048
  v_mfma_f32_16x16x32_bf16 v[104:107], v[188:191], v[208:211], v[104:107]
  ds_read_b64_tr_b16 v[168:169], v81 offset:256
  v_mfma_f32_16x16x32_bf16 v[116:119], v[200:203], v[204:207], v[116:119]
  ds_read_b64_tr_b16 v[170:171], v80 offset:256
  v_mfma_f32_16x16x32_bf16 v[120:123], v[200:203], v[208:211], v[120:123]
  ds_read_b128 v[172:175], v86 offset:4096
  v_mfma_f32_16x16x32_bf16 v[124:127], v[212:215], v[192:195], v[124:127]
  ds_read_b128 v[176:179], v86 offset:6144
  v_mfma_f32_16x16x32_bf16 v[128:131], v[212:215], v[196:199], v[128:131]
  ds_read_b64_tr_b16 v[180:181], v80 offset:512
  v_mfma_f32_16x16x32_bf16 v[140:143], v[216:219], v[192:195], v[140:143]
  ds_read_b64_tr_b16 v[182:183], v81 offset:512
  v_mfma_f32_16x16x32_bf16 v[144:147], v[216:219], v[196:199], v[144:147]
  ds_read_b64_tr_b16 v[184:185], v81 offset:768
  v_mfma_f32_16x16x32_bf16 v[132:135], v[212:215], v[204:207], v[132:135]
  ds_read_b64_tr_b16 v[186:187], v80 offset:768
  v_mfma_f32_16x16x32_bf16 v[136:139], v[212:215], v[208:211], v[136:139]
  v_mfma_f32_16x16x32_bf16 v[148:151], v[216:219], v[204:207], v[148:151]
  v_mfma_f32_16x16x32_bf16 v[152:155], v[216:219], v[208:211], v[152:155]
  s_waitcnt lgkmcnt(9)
  v_mfma_f32_16x16x32_bf16 v[92:95], v[156:159], v[160:163], v[92:95]
  ds_read_b64_tr_b16 v[188:189], v80 offset:8192
  s_waitcnt lgkmcnt(9)
  v_mfma_f32_16x16x32_bf16 v[96:99], v[156:159], v[164:167], v[96:99]
  ds_read_b64_tr_b16 v[190:191], v81 offset:8192
  s_waitcnt lgkmcnt(8)
  v_mfma_f32_16x16x32_bf16 v[108:111], v[168:171], v[160:163], v[108:111]
  ds_read_b128 v[192:195], v87 offset:0
  v_mfma_f32_16x16x32_bf16 v[112:115], v[168:171], v[164:167], v[112:115]
  ds_read_b128 v[196:199], v87 offset:2048
  s_waitcnt lgkmcnt(9)
  v_mfma_f32_16x16x32_bf16 v[100:103], v[156:159], v[172:175], v[100:103]
  ds_read_b64_tr_b16 v[200:201], v81 offset:8448
  s_waitcnt lgkmcnt(9)
  v_mfma_f32_16x16x32_bf16 v[104:107], v[156:159], v[176:179], v[104:107]
  ds_read_b64_tr_b16 v[202:203], v80 offset:8448
  v_mfma_f32_16x16x32_bf16 v[116:119], v[168:171], v[172:175], v[116:119]
  ds_read_b128 v[204:207], v87 offset:4096
  v_mfma_f32_16x16x32_bf16 v[120:123], v[168:171], v[176:179], v[120:123]
  ds_read_b128 v[208:211], v87 offset:6144
  s_waitcnt lgkmcnt(10)
  v_mfma_f32_16x16x32_bf16 v[124:127], v[180:183], v[160:163], v[124:127]
  ds_read_b64_tr_b16 v[212:213], v80 offset:8704
  v_mfma_f32_16x16x32_bf16 v[128:131], v[180:183], v[164:167], v[128:131]
  ds_read_b64_tr_b16 v[214:215], v81 offset:8704
  s_waitcnt lgkmcnt(10)
  v_mfma_f32_16x16x32_bf16 v[140:143], v[184:187], v[160:163], v[140:143]
  ds_read_b64_tr_b16 v[216:217], v81 offset:8960
  v_mfma_f32_16x16x32_bf16 v[144:147], v[184:187], v[164:167], v[144:147]
  ds_read_b64_tr_b16 v[218:219], v80 offset:8960
  v_mfma_f32_16x16x32_bf16 v[132:135], v[180:183], v[172:175], v[132:135]
  v_mfma_f32_16x16x32_bf16 v[136:139], v[180:183], v[176:179], v[136:139]
  v_mfma_f32_16x16x32_bf16 v[148:151], v[184:187], v[172:175], v[148:151]
  v_mfma_f32_16x16x32_bf16 v[152:155], v[184:187], v[176:179], v[152:155]
  s_waitcnt lgkmcnt(9)
  v_mfma_f32_16x16x32_bf16 v[92:95], v[188:191], v[192:195], v[92:95]
  s_waitcnt lgkmcnt(8)
  v_mfma_f32_16x16x32_bf16 v[96:99], v[188:191], v[196:199], v[96:99]
  s_waitcnt lgkmcnt(0)
  s_barrier
  ds_read_b64_tr_b16 v[156:157], v80 offset:32768
  v_mfma_f32_16x16x32_bf16 v[108:111], v[200:203], v[192:195], v[108:111]
  ds_read_b64_tr_b16 v[158:159], v81 offset:32768
  v_mfma_f32_16x16x32_bf16 v[112:115], v[200:203], v[196:199], v[112:115]
  ds_read_b128 v[160:163], v86 offset:32768
  v_mfma_f32_16x16x32_bf16 v[100:103], v[188:191], v[204:207], v[100:103]
  ds_read_b128 v[164:167], v86 offset:34816
  v_mfma_f32_16x16x32_bf16 v[104:107], v[188:191], v[208:211], v[104:107]
  ds_read_b64_tr_b16 v[168:169], v81 offset:33024
  v_mfma_f32_16x16x32_bf16 v[116:119], v[200:203], v[204:207], v[116:119]
  ds_read_b64_tr_b16 v[170:171], v80 offset:33024
  v_mfma_f32_16x16x32_bf16 v[120:123], v[200:203], v[208:211], v[120:123]
  ds_read_b128 v[172:175], v86 offset:36864
  v_mfma_f32_16x16x32_bf16 v[124:127], v[212:215], v[192:195], v[124:127]
  ds_read_b128 v[176:179], v86 offset:38912
  v_mfma_f32_16x16x32_bf16 v[128:131], v[212:215], v[196:199], v[128:131]
  ds_read_b64_tr_b16 v[180:181], v80 offset:33280
  v_mfma_f32_16x16x32_bf16 v[140:143], v[216:219], v[192:195], v[140:143]
  ds_read_b64_tr_b16 v[182:183], v81 offset:33280
  v_mfma_f32_16x16x32_bf16 v[144:147], v[216:219], v[196:199], v[144:147]
  ds_read_b64_tr_b16 v[184:185], v81 offset:33536
  v_mfma_f32_16x16x32_bf16 v[132:135], v[212:215], v[204:207], v[132:135]
  ds_read_b64_tr_b16 v[186:187], v80 offset:33536
  v_mfma_f32_16x16x32_bf16 v[136:139], v[212:215], v[208:211], v[136:139]
  v_mfma_f32_16x16x32_bf16 v[148:151], v[216:219], v[204:207], v[148:151]
  v_mfma_f32_16x16x32_bf16 v[152:155], v[216:219], v[208:211], v[152:155]
  s_waitcnt lgkmcnt(9)
  v_mfma_f32_16x16x32_bf16 v[92:95], v[156:159], v[160:163], v[92:95]
  ds_read_b64_tr_b16 v[188:189], v80 offset:40960
  s_waitcnt lgkmcnt(9)
  v_mfma_f32_16x16x32_bf16 v[96:99], v[156:159], v[164:167], v[96:99]
  ds_read_b64_tr_b16 v[190:191], v81 offset:40960
  s_waitcnt lgkmcnt(8)
  v_mfma_f32_16x16x32_bf16 v[108:111], v[168:171], v[160:163], v[108:111]
  ds_read_b128 v[192:195], v87 offset:32768
  v_mfma_f32_16x16x32_bf16 v[112:115], v[168:171], v[164:167], v[112:115]
  ds_read_b128 v[196:199], v87 offset:34816
  s_waitcnt lgkmcnt(9)
  v_mfma_f32_16x16x32_bf16 v[100:103], v[156:159], v[172:175], v[100:103]
  ds_read_b64_tr_b16 v[200:201], v81 offset:41216
  s_waitcnt lgkmcnt(9)
  v_mfma_f32_16x16x32_bf16 v[104:107], v[156:159], v[176:179], v[104:107]
  ds_read_b64_tr_b16 v[202:203], v80 offset:41216
  v_mfma_f32_16x16x32_bf16 v[116:119], v[168:171], v[172:175], v[116:119]
  ds_read_b128 v[204:207], v87 offset:36864
  v_mfma_f32_16x16x32_bf16 v[120:123], v[168:171], v[176:179], v[120:123]
  ds_read_b128 v[208:211], v87 offset:38912
  s_waitcnt lgkmcnt(10)
  v_mfma_f32_16x16x32_bf16 v[124:127], v[180:183], v[160:163], v[124:127]
  ds_read_b64_tr_b16 v[212:213], v80 offset:41472
  v_mfma_f32_16x16x32_bf16 v[128:131], v[180:183], v[164:167], v[128:131]
  ds_read_b64_tr_b16 v[214:215], v81 offset:41472
  s_waitcnt lgkmcnt(10)
  v_mfma_f32_16x16x32_bf16 v[140:143], v[184:187], v[160:163], v[140:143]
  ds_read_b64_tr_b16 v[216:217], v81 offset:41728
  v_mfma_f32_16x16x32_bf16 v[144:147], v[184:187], v[164:167], v[144:147]
  ds_read_b64_tr_b16 v[218:219], v80 offset:41728
  v_mfma_f32_16x16x32_bf16 v[132:135], v[180:183], v[172:175], v[132:135]
  v_mfma_f32_16x16x32_bf16 v[136:139], v[180:183], v[176:179], v[136:139]
  v_mfma_f32_16x16x32_bf16 v[148:151], v[184:187], v[172:175], v[148:151]
  v_mfma_f32_16x16x32_bf16 v[152:155], v[184:187], v[176:179], v[152:155]
  s_add_u32 s48, s45, 0
  buffer_load_dwordx4 v[44:47], v11, s[36:39], s48 offen offset:0 sc1
  buffer_load_dwordx4 v[48:51], v11, s[36:39], s48 offen offset:512 sc1
  s_add_u32 s48, s45, 69632
  buffer_load_dwordx4 v[52:55], v11, s[36:39], s48 offen offset:0 sc1
  buffer_load_dwordx4 v[56:59], v11, s[36:39], s48 offen offset:512 sc1
  s_add_u32 s48, s45, 139264
  buffer_load_dwordx4 v[60:63], v11, s[36:39], s48 offen offset:0 sc1
  buffer_load_dwordx4 v[64:67], v11, s[36:39], s48 offen offset:512 sc1
  s_add_u32 s48, s45, 208896
  buffer_load_dwordx4 v[68:71], v11, s[36:39], s48 offen offset:0 sc1
  buffer_load_dwordx4 v[72:75], v11, s[36:39], s48 offen offset:512 sc1
  s_waitcnt lgkmcnt(9)
  v_mfma_f32_16x16x32_bf16 v[92:95], v[188:191], v[192:195], v[92:95]
  s_waitcnt lgkmcnt(8)
  v_mfma_f32_16x16x32_bf16 v[96:99], v[188:191], v[196:199], v[96:99]
  s_waitcnt lgkmcnt(0)
  s_barrier
  ds_read_b64_tr_b16 v[156:157], v82 offset:0
  v_mfma_f32_16x16x32_bf16 v[108:111], v[200:203], v[192:195], v[108:111]
  ds_read_b64_tr_b16 v[158:159], v83 offset:0
  v_mfma_f32_16x16x32_bf16 v[112:115], v[200:203], v[196:199], v[112:115]
  ds_read_b128 v[160:163], v88 offset:0
  v_mfma_f32_16x16x32_bf16 v[100:103], v[188:191], v[204:207], v[100:103]
  ds_read_b128 v[164:167], v88 offset:2048
  v_mfma_f32_16x16x32_bf16 v[104:107], v[188:191], v[208:211], v[104:107]
  ds_read_b64_tr_b16 v[168:169], v83 offset:256
  v_mfma_f32_16x16x32_bf16 v[116:119], v[200:203], v[204:207], v[116:119]
  ds_read_b64_tr_b16 v[170:171], v82 offset:256
  v_mfma_f32_16x16x32_bf16 v[120:123], v[200:203], v[208:211], v[120:123]
  ds_read_b128 v[172:175], v88 offset:4096
  v_mfma_f32_16x16x32_bf16 v[124:127], v[212:215], v[192:195], v[124:127]
  ds_read_b128 v[176:179], v88 offset:6144
  v_mfma_f32_16x16x32_bf16 v[128:131], v[212:215], v[196:199], v[128:131]
  ds_read_b64_tr_b16 v[180:181], v82 offset:512
  v_mfma_f32_16x16x32_bf16 v[140:143], v[216:219], v[192:195], v[140:143]
  ds_read_b64_tr_b16 v[182:183], v83 offset:512
  v_mfma_f32_16x16x32_bf16 v[144:147], v[216:219], v[196:199], v[144:147]
  ds_read_b64_tr_b16 v[184:185], v83 offset:768
  v_mfma_f32_16x16x32_bf16 v[132:135], v[212:215], v[204:207], v[132:135]
  ds_read_b64_tr_b16 v[186:187], v82 offset:768
  v_mfma_f32_16x16x32_bf16 v[136:139], v[212:215], v[208:211], v[136:139]
  v_mfma_f32_16x16x32_bf16 v[148:151], v[216:219], v[204:207], v[148:151]
  v_mfma_f32_16x16x32_bf16 v[152:155], v[216:219], v[208:211], v[152:155]
  s_waitcnt lgkmcnt(9)
  v_mfma_f32_16x16x32_bf16 v[92:95], v[156:159], v[160:163], v[92:95]
  ds_read_b64_tr_b16 v[188:189], v82 offset:8192
  s_waitcnt lgkmcnt(9)
  v_mfma_f32_16x16x32_bf16 v[96:99], v[156:159], v[164:167], v[96:99]
  ds_read_b64_tr_b16 v[190:191], v83 offset:8192
  s_waitcnt lgkmcnt(8)
  v_mfma_f32_16x16x32_bf16 v[108:111], v[168:171], v[160:163], v[108:111]
  ds_read_b128 v[192:195], v89 offset:0
  v_mfma_f32_16x16x32_bf16 v[112:115], v[168:171], v[164:167], v[112:115]
  ds_read_b128 v[196:199], v89 offset:2048
  s_waitcnt lgkmcnt(9)
  v_mfma_f32_16x16x32_bf16 v[100:103], v[156:159], v[172:175], v[100:103]
  ds_read_b64_tr_b16 v[200:201], v83 offset:8448
  s_waitcnt lgkmcnt(9)
  v_mfma_f32_16x16x32_bf16 v[104:107], v[156:159], v[176:179], v[104:107]
  ds_read_b64_tr_b16 v[202:203], v82 offset:8448
  v_mfma_f32_16x16x32_bf16 v[116:119], v[168:171], v[172:175], v[116:119]
  ds_read_b128 v[204:207], v89 offset:4096
  v_mfma_f32_16x16x32_bf16 v[120:123], v[168:171], v[176:179], v[120:123]
  ds_read_b128 v[208:211], v89 offset:6144
  s_waitcnt lgkmcnt(10)
  v_mfma_f32_16x16x32_bf16 v[124:127], v[180:183], v[160:163], v[124:127]
  ds_read_b64_tr_b16 v[212:213], v82 offset:8704
  v_mfma_f32_16x16x32_bf16 v[128:131], v[180:183], v[164:167], v[128:131]
  ds_read_b64_tr_b16 v[214:215], v83 offset:8704
  s_waitcnt lgkmcnt(10)
  v_mfma_f32_16x16x32_bf16 v[140:143], v[184:187], v[160:163], v[140:143]
  ds_read_b64_tr_b16 v[216:217], v83 offset:8960
  v_mfma_f32_16x16x32_bf16 v[144:147], v[184:187], v[164:167], v[144:147]
  ds_read_b64_tr_b16 v[218:219], v82 offset:8960
  v_mfma_f32_16x16x32_bf16 v[132:135], v[180:183], v[172:175], v[132:135]
  v_mfma_f32_16x16x32_bf16 v[136:139], v[180:183], v[176:179], v[136:139]
  v_mfma_f32_16x16x32_bf16 v[148:151], v[184:187], v[172:175], v[148:151]
  v_mfma_f32_16x16x32_bf16 v[152:155], v[184:187], v[176:179], v[152:155]
  s_waitcnt lgkmcnt(9)
  v_mfma_f32_16x16x32_bf16 v[92:95], v[188:191], v[192:195], v[92:95]
  s_waitcnt lgkmcnt(8)
  v_mfma_f32_16x16x32_bf16 v[96:99], v[188:191], v[196:199], v[96:99]
  s_waitcnt lgkmcnt(0)
  s_barrier
  ds_read_b64_tr_b16 v[156:157], v82 offset:32768
  v_mfma_f32_16x16x32_bf16 v[108:111], v[200:203], v[192:195], v[108:111]
  ds_read_b64_tr_b16 v[158:159], v83 offset:32768
  v_mfma_f32_16x16x32_bf16 v[112:115], v[200:203], v[196:199], v[112:115]
  ds_read_b128 v[160:163], v88 offset:32768
  v_mfma_f32_16x16x32_bf16 v[100:103], v[188:191], v[204:207], v[100:103]
  ds_read_b128 v[164:167], v88 offset:34816
  v_mfma_f32_16x16x32_bf16 v[104:107], v[188:191], v[208:211], v[104:107]
  ds_read_b64_tr_b16 v[168:169], v83 offset:33024
  v_mfma_f32_16x16x32_bf16 v[116:119], v[200:203], v[204:207], v[116:119]
  ds_read_b64_tr_b16 v[170:171], v82 offset:33024
  v_mfma_f32_16x16x32_bf16 v[120:123], v[200:203], v[208:211], v[120:123]
  ds_read_b128 v[172:175], v88 offset:36864
  v_mfma_f32_16x16x32_bf16 v[124:127], v[212:215], v[192:195], v[124:127]
  ds_read_b128 v[176:179], v88 offset:38912
  v_mfma_f32_16x16x32_bf16 v[128:131], v[212:215], v[196:199], v[128:131]
  ds_read_b64_tr_b16 v[180:181], v82 offset:33280
  v_mfma_f32_16x16x32_bf16 v[140:143], v[216:219], v[192:195], v[140:143]
  ds_read_b64_tr_b16 v[182:183], v83 offset:33280
  v_mfma_f32_16x16x32_bf16 v[144:147], v[216:219], v[196:199], v[144:147]
  ds_read_b64_tr_b16 v[184:185], v83 offset:33536
  v_mfma_f32_16x16x32_bf16 v[132:135], v[212:215], v[204:207], v[132:135]
  ds_read_b64_tr_b16 v[186:187], v82 offset:33536
  v_mfma_f32_16x16x32_bf16 v[136:139], v[212:215], v[208:211], v[136:139]
  v_mfma_f32_16x16x32_bf16 v[148:151], v[216:219], v[204:207], v[148:151]
  v_mfma_f32_16x16x32_bf16 v[152:155], v[216:219], v[208:211], v[152:155]
  s_waitcnt lgkmcnt(9)
  v_mfma_f32_16x16x32_bf16 v[92:95], v[156:159], v[160:163], v[92:95]
  ds_read_b64_tr_b16 v[188:189], v82 offset:40960
  s_waitcnt lgkmcnt(9)
  v_mfma_f32_16x16x32_bf16 v[96:99], v[156:159], v[164:167], v[96:99]
  ds_read_b64_tr_b16 v[190:191], v83 offset:40960
  s_waitcnt lgkmcnt(8)
  v_mfma_f32_16x16x32_bf16 v[108:111], v[168:171], v[160:163], v[108:111]
  ds_read_b128 v[192:195], v89 offset:32768
  v_mfma_f32_16x16x32_bf16 v[112:115], v[168:171], v[164:167], v[112:115]
  ds_read_b128 v[196:199], v89 offset:34816
  s_waitcnt lgkmcnt(9)
  v_mfma_f32_16x16x32_bf16 v[100:103], v[156:159], v[172:175], v[100:103]
  ds_read_b64_tr_b16 v[200:201], v83 offset:41216
  s_waitcnt lgkmcnt(9)
  v_mfma_f32_16x16x32_bf16 v[104:107], v[156:159], v[176:179], v[104:107]
  ds_read_b64_tr_b16 v[202:203], v82 offset:41216
  v_mfma_f32_16x16x32_bf16 v[116:119], v[168:171], v[172:175], v[116:119]
  ds_read_b128 v[204:207], v89 offset:36864
  v_mfma_f32_16x16x32_bf16 v[120:123], v[168:171], v[176:179], v[120:123]
  ds_read_b128 v[208:211], v89 offset:38912
  s_waitcnt lgkmcnt(10)
  v_mfma_f32_16x16x32_bf16 v[124:127], v[180:183], v[160:163], v[124:127]
  ds_read_b64_tr_b16 v[212:213], v82 offset:41472
  v_mfma_f32_16x16x32_bf16 v[128:131], v[180:183], v[164:167], v[128:131]
  ds_read_b64_tr_b16 v[214:215], v83 offset:41472
  s_waitcnt lgkmcnt(10)
  v_mfma_f32_16x16x32_bf16 v[140:143], v[184:187], v[160:163], v[140:143]
  ds_read_b64_tr_b16 v[216:217], v83 offset:41728
  v_mfma_f32_16x16x32_bf16 v[144:147], v[184:187], v[164:167], v[144:147]
  ds_read_b64_tr_b16 v[218:219], v82 offset:41728
  v_mfma_f32_16x16x32_bf16 v[132:135], v[180:183], v[172:175], v[132:135]
  v_mfma_f32_16x16x32_bf16 v[136:139], v[180:183], v[176:179], v[136:139]
  v_mfma_f32_16x16x32_bf16 v[148:151], v[184:187], v[172:175], v[148:151]
  v_mfma_f32_16x16x32_bf16 v[152:155], v[184:187], v[176:179], v[152:155]
  s_waitcnt lgkmcnt(9)
  v_mfma_f32_16x16x32_bf16 v[92:95], v[188:191], v[192:195], v[92:95]
  s_waitcnt lgkmcnt(8)
  v_mfma_f32_16x16x32_bf16 v[96:99], v[188:191], v[196:199], v[96:99]
  s_waitcnt lgkmcnt(0)
  s_barrier
  ds_read_b64_tr_b16 v[156:157], v84 offset:0
  v_mfma_f32_16x16x32_bf16 v[108:111], v[200:203], v[192:195], v[108:111]
  ds_read_b64_tr_b16 v[158:159], v85 offset:0
  v_mfma_f32_16x16x32_bf16 v[112:115], v[200:203], v[196:199], v[112:115]
  ds_read_b128 v[160:163], v90 offset:0
  v_mfma_f32_16x16x32_bf16 v[100:103], v[188:191], v[204:207], v[100:103]
  ds_read_b128 v[164:167], v90 offset:2048
  v_mfma_f32_16x16x32_bf16 v[104:107], v[188:191], v[208:211], v[104:107]
  ds_read_b64_tr_b16 v[168:169], v85 offset:256
  v_mfma_f32_16x16x32_bf16 v[116:119], v[200:203], v[204:207], v[116:119]
  ds_read_b64_tr_b16 v[170:171], v84 offset:256
  v_mfma_f32_16x16x32_bf16 v[120:123], v[200:203], v[208:211], v[120:123]
  ds_read_b128 v[172:175], v90 offset:4096
  v_mfma_f32_16x16x32_bf16 v[124:127], v[212:215], v[192:195], v[124:127]
  ds_read_b128 v[176:179], v90 offset:6144
  v_mfma_f32_16x16x32_bf16 v[128:131], v[212:215], v[196:199], v[128:131]
  ds_read_b64_tr_b16 v[180:181], v84 offset:512
  v_mfma_f32_16x16x32_bf16 v[140:143], v[216:219], v[192:195], v[140:143]
  ds_read_b64_tr_b16 v[182:183], v85 offset:512
  v_mfma_f32_16x16x32_bf16 v[144:147], v[216:219], v[196:199], v[144:147]
  ds_read_b64_tr_b16 v[184:185], v85 offset:768
  v_mfma_f32_16x16x32_bf16 v[132:135], v[212:215], v[204:207], v[132:135]
  ds_read_b64_tr_b16 v[186:187], v84 offset:768
  v_mfma_f32_16x16x32_bf16 v[136:139], v[212:215], v[208:211], v[136:139]
  v_mfma_f32_16x16x32_bf16 v[148:151], v[216:219], v[204:207], v[148:151]
  v_mfma_f32_16x16x32_bf16 v[152:155], v[216:219], v[208:211], v[152:155]
  s_waitcnt vmcnt(0)
  s_waitcnt lgkmcnt(9)
  v_mfma_f32_16x16x32_bf16 v[92:95], v[156:159], v[160:163], v[92:95]
  v_permlane16_swap_b32 v44, v46
  v_permlane16_swap_b32 v45, v47
  ds_read_b64_tr_b16 v[188:189], v84 offset:8192
  s_waitcnt lgkmcnt(9)
  v_mfma_f32_16x16x32_bf16 v[96:99], v[156:159], v[164:167], v[96:99]
  v_permlane16_swap_b32 v48, v50
  v_permlane16_swap_b32 v49, v51
  ds_read_b64_tr_b16 v[190:191], v85 offset:8192
  s_waitcnt lgkmcnt(8)
  v_mfma_f32_16x16x32_bf16 v[108:111], v[168:171], v[160:163], v[108:111]
  v_permlane16_swap_b32 v52, v54
  v_permlane16_swap_b32 v53, v55
  ds_read_b128 v[192:195], v91 offset:0
  v_mfma_f32_16x16x32_bf16 v[112:115], v[168:171], v[164:167], v[112:115]
  v_permlane16_swap_b32 v56, v58
  v_permlane16_swap_b32 v57, v59
  ds_read_b128 v[196:199], v91 offset:2048
  s_waitcnt lgkmcnt(9)
  v_mfma_f32_16x16x32_bf16 v[100:103], v[156:159], v[172:175], v[100:103]
  v_permlane16_swap_b32 v60, v62
  v_permlane16_swap_b32 v61, v63
  ds_read_b64_tr_b16 v[200:201], v85 offset:8448
  s_waitcnt lgkmcnt(9)
  v_mfma_f32_16x16x32_bf16 v[104:107], v[156:159], v[176:179], v[104:107]
  v_permlane16_swap_b32 v64, v66
  v_permlane16_swap_b32 v65, v67
  ds_read_b64_tr_b16 v[202:203], v84 offset:8448
  v_mfma_f32_16x16x32_bf16 v[116:119], v[168:171], v[172:175], v[116:119]
  v_permlane16_swap_b32 v68, v70
  v_permlane16_swap_b32 v69, v71
  ds_read_b128 v[204:207], v91 offset:4096
  v_mfma_f32_16x16x32_bf16 v[120:123], v[168:171], v[176:179], v[120:123]
  v_permlane16_swap_b32 v72, v74
  v_permlane16_swap_b32 v73, v75
  ds_read_b128 v[208:211], v91 offset:6144
  s_waitcnt lgkmcnt(10)
  v_mfma_f32_16x16x32_bf16 v[124:127], v[180:183], v[160:163], v[124:127]
  v_lshlrev_b32 v12, 16, v44
  v_and_b32 v13, 0xffff0000, v44
  ds_read_b64_tr_b16 v[212:213], v84 offset:8704
  v_mfma_f32_16x16x32_bf16 v[128:131], v[180:183], v[164:167], v[128:131]
  v_lshlrev_b32 v14, 16, v45
  v_and_b32 v15, 0xffff0000, v45
  ds_read_b64_tr_b16 v[214:215], v85 offset:8704
  s_waitcnt lgkmcnt(10)
  v_mfma_f32_16x16x32_bf16 v[140:143], v[184:187], v[160:163], v[140:143]
  v_lshlrev_b32 v16, 16, v46
  v_and_b32 v17, 0xffff0000, v46
  ds_read_b64_tr_b16 v[216:217], v85 offset:8960
  v_mfma_f32_16x16x32_bf16 v[144:147], v[184:187], v[164:167], v[144:147]
  v_lshlrev_b32 v18, 16, v47
  v_and_b32 v19, 0xffff0000, v47
  ds_read_b64_tr_b16 v[218:219], v84 offset:8960
  v_mfma_f32_16x16x32_bf16 v[132:135], v[180:183], v[172:175], v[132:135]
  v_lshlrev_b32 v20, 16, v48
  v_and_b32 v21, 0xffff0000, v48
  v_mfma_f32_16x16x32_bf16 v[136:139], v[180:183], v[176:179], v[136:139]
  v_lshlrev_b32 v22, 16, v49
  v_and_b32 v23, 0xffff0000, v49
  v_mfma_f32_16x16x32_bf16 v[148:151], v[184:187], v[172:175], v[148:151]
  v_lshlrev_b32 v24, 16, v50
  v_and_b32 v25, 0xffff0000, v50
  v_mfma_f32_16x16x32_bf16 v[152:155], v[184:187], v[176:179], v[152:155]
  v_lshlrev_b32 v26, 16, v51
  v_and_b32 v27, 0xffff0000, v51
  s_waitcnt lgkmcnt(9)
  v_mfma_f32_16x16x32_bf16 v[92:95], v[188:191], v[192:195], v[92:95]
  v_lshlrev_b32 v28, 16, v52
  v_and_b32 v29, 0xffff0000, v52
  s_waitcnt lgkmcnt(8)
  v_mfma_f32_16x16x32_bf16 v[96:99], v[188:191], v[196:199], v[96:99]
  v_lshlrev_b32 v30, 16, v53
  v_and_b32 v31, 0xffff0000, v53
  s_waitcnt lgkmcnt(0)
  s_barrier
  ds_read_b64_tr_b16 v[156:157], v80 offset:0
  v_mfma_f32_16x16x32_bf16 v[108:111], v[200:203], v[192:195], v[108:111]
  v_lshlrev_b32 v32, 16, v54
  v_and_b32 v33, 0xffff0000, v54
  ds_read_b64_tr_b16 v[158:159], v81 offset:0
  v_mfma_f32_16x16x32_bf16 v[112:115], v[200:203], v[196:199], v[112:115]
  v_lshlrev_b32 v34, 16, v55
  v_and_b32 v35, 0xffff0000, v55
  ds_read_b128 v[160:163], v86 offset:0
  v_mfma_f32_16x16x32_bf16 v[100:103], v[188:191], v[204:207], v[100:103]
  v_lshlrev_b32 v36, 16, v56
  v_and_b32 v37, 0xffff0000, v56
  ds_read_b128 v[164:167], v86 offset:2048
  v_mfma_f32_16x16x32_bf16 v[104:107], v[188:191], v[208:211], v[104:107]
  v_lshlrev_b32 v38, 16, v57
  v_and_b32 v39, 0xffff0000, v57
  ds_read_b64_tr_b16 v[168:169], v81 offset:256
  v_mfma_f32_16x16x32_bf16 v[116:119], v[200:203], v[204:207], v[116:119]
  v_lshlrev_b32 v40, 16, v58
  v_and_b32 v41, 0xffff0000, v58
  ds_read_b64_tr_b16 v[170:171], v80 offset:256
  v_mfma_f32_16x16x32_bf16 v[120:123], v[200:203], v[208:211], v[120:123]
  v_lshlrev_b32 v42, 16, v59
  v_and_b32 v43, 0xffff0000, v59
  ds_read_b128 v[172:175], v86 offset:4096
  v_mfma_f32_16x16x32_bf16 v[124:127], v[212:215], v[192:195], v[124:127]
  v_lshlrev_b32 v44, 16, v60
  v_and_b32 v45, 0xffff0000, v60
  ds_read_b128 v[176:179], v86 offset:6144
  v_mfma_f32_16x16x32_bf16 v[128:131], v[212:215], v[196:199], v[128:131]
  v_lshlrev_b32 v46, 16, v61
  v_and_b32 v47, 0xffff0000, v61
  ds_read_b64_tr_b16 v[180:181], v80 offset:512
  v_mfma_f32_16x16x32_bf16 v[140:143], v[216:219], v[192:195], v[140:143]
  v_lshlrev_b32 v48, 16, v62
  v_and_b32 v49, 0xffff0000, v62
  ds_read_b64_tr_b16 v[182:183], v81 offset:512
  v_mfma_f32_16x16x32_bf16 v[144:147], v[216:219], v[196:199], v[144:147]
  v_lshlrev_b32 v50, 16, v63
  v_and_b32 v51, 0xffff0000, v63
  ds_read_b64_tr_b16 v[184:185], v81 offset:768
  v_mfma_f32_16x16x32_bf16 v[132:135], v[212:215], v[204:207], v[132:135]
  v_lshlrev_b32 v52, 16, v64
  v_and_b32 v53, 0xffff0000, v64
  ds_read_b64_tr_b16 v[186:187], v80 offset:768
  v_mfma_f32_16x16x32_bf16 v[136:139], v[212:215], v[208:211], v[136:139]
  v_lshlrev_b32 v54, 16, v65
  v_and_b32 v55, 0xffff0000, v65
  v_mfma_f32_16x16x32_bf16 v[148:151], v[216:219], v[204:207], v[148:151]
  v_lshlrev_b32 v56, 16, v66
  v_and_b32 v57, 0xffff0000, v66
  v_mfma_f32_16x16x32_bf16 v[152:155], v[216:219], v[208:211], v[152:155]
  v_lshlrev_b32 v58, 16, v67
  v_and_b32 v59, 0xffff0000, v67
  s_waitcnt lgkmcnt(9)
  v_mfma_f32_16x16x32_bf16 v[92:95], v[156:159], v[160:163], v[92:95]
  v_lshlrev_b32 v60, 16, v68
  ds_read_b64_tr_b16 v[188:189], v80 offset:8192
  s_waitcnt lgkmcnt(9)
  v_mfma_f32_16x16x32_bf16 v[96:99], v[156:159], v[164:167], v[96:99]
  v_and_b32 v61, 0xffff0000, v68
  ds_read_b64_tr_b16 v[190:191], v81 offset:8192
  s_waitcnt lgkmcnt(8)
  v_mfma_f32_16x16x32_bf16 v[108:111], v[168:171], v[160:163], v[108:111]
  v_lshlrev_b32 v62, 16, v69
  ds_read_b128 v[192:195], v87 offset:0
  v_mfma_f32_16x16x32_bf16 v[112:115], v[168:171], v[164:167], v[112:115]
  v_and_b32 v63, 0xffff0000, v69
  ds_read_b128 v[196:199], v87 offset:2048
  s_waitcnt lgkmcnt(9)
  v_mfma_f32_16x16x32_bf16 v[100:103], v[156:159], v[172:175], v[100:103]
  v_lshlrev_b32 v64, 16, v70
  ds_read_b64_tr_b16 v[200:201], v81 offset:8448
  s_waitcnt lgkmcnt(9)
  v_mfma_f32_16x16x32_bf16 v[104:107], v[156:159], v[176:179], v[104:107]
  v_and_b32 v65, 0xffff0000, v70
  ds_read_b64_tr_b16 v[202:203], v80 offset:8448
  v_mfma_f32_16x16x32_bf16 v[116:119], v[168:171], v[172:175], v[116:119]
  v_lshlrev_b32 v66, 16, v71
  ds_read_b128 v[204:207], v87 offset:4096
  v_mfma_f32_16x16x32_bf16 v[120:123], v[168:171], v[176:179], v[120:123]
  v_and_b32 v67, 0xffff0000, v71
  ds_read_b128 v[208:211], v87 offset:6144
  s_waitcnt lgkmcnt(10)
  v_mfma_f32_16x16x32_bf16 v[124:127], v[180:183], v[160:163], v[124:127]
  v_lshlrev_b32 v68, 16, v72
  ds_read_b64_tr_b16 v[212:213], v80 offset:8704
  v_mfma_f32_16x16x32_bf16 v[128:131], v[180:183], v[164:167], v[128:131]
  v_and_b32 v69, 0xffff0000, v72
  ds_read_b64_tr_b16 v[214:215], v81 offset:8704
  s_waitcnt lgkmcnt(10)
  v_mfma_f32_16x16x32_bf16 v[140:143], v[184:187], v[160:163], v[140:143]
  v_lshlrev_b32 v70, 16, v73
  ds_read_b64_tr_b16 v[216:217], v81 offset:8960
  v_mfma_f32_16x16x32_bf16 v[144:147], v[184:187], v[164:167], v[144:147]
  v_and_b32 v71, 0xffff0000, v73
  ds_read_b64_tr_b16 v[218:219], v80 offset:8960
  v_mfma_f32_16x16x32_bf16 v[132:135], v[180:183], v[172:175], v[132:135]
  v_lshlrev_b32 v72, 16, v74
  v_mfma_f32_16x16x32_bf16 v[136:139], v[180:183], v[176:179], v[136:139]
  v_and_b32 v73, 0xffff0000, v74
  v_mfma_f32_16x16x32_bf16 v[148:151], v[184:187], v[172:175], v[148:151]
  v_lshlrev_b32 v74, 16, v75
  v_mfma_f32_16x16x32_bf16 v[152:155], v[184:187], v[176:179], v[152:155]
  v_and_b32 v75, 0xffff0000, v75
  s_waitcnt lgkmcnt(9)
  v_mfma_f32_16x16x32_bf16 v[92:95], v[188:191], v[192:195], v[92:95]
  s_waitcnt lgkmcnt(8)
  v_mfma_f32_16x16x32_bf16 v[96:99], v[188:191], v[196:199], v[96:99]
  s_waitcnt lgkmcnt(6)
  v_mfma_f32_16x16x32_bf16 v[108:111], v[200:203], v[192:195], v[108:111]
  v_mfma_f32_16x16x32_bf16 v[112:115], v[200:203], v[196:199], v[112:115]
  s_waitcnt lgkmcnt(5)
  v_mfma_f32_16x16x32_bf16 v[100:103], v[188:191], v[204:207], v[100:103]
  s_waitcnt lgkmcnt(4)
  v_mfma_f32_16x16x32_bf16 v[104:107], v[188:191], v[208:211], v[104:107]
  v_mfma_f32_16x16x32_bf16 v[116:119], v[200:203], v[204:207], v[116:119]
  v_mfma_f32_16x16x32_bf16 v[120:123], v[200:203], v[208:211], v[120:123]
  s_waitcnt lgkmcnt(2)
  v_mfma_f32_16x16x32_bf16 v[124:127], v[212:215], v[192:195], v[124:127]
  v_mfma_f32_16x16x32_bf16 v[128:131], v[212:215], v[196:199], v[128:131]
  s_waitcnt lgkmcnt(0)
  v_mfma_f32_16x16x32_bf16 v[140:143], v[216:219], v[192:195], v[140:143]
  v_mfma_f32_16x16x32_bf16 v[144:147], v[216:219], v[196:199], v[144:147]
  v_mfma_f32_16x16x32_bf16 v[132:135], v[212:215], v[204:207], v[132:135]
  v_mfma_f32_16x16x32_bf16 v[136:139], v[212:215], v[208:211], v[136:139]
  v_mfma_f32_16x16x32_bf16 v[148:151], v[216:219], v[204:207], v[148:151]
  v_mfma_f32_16x16x32_bf16 v[152:155], v[216:219], v[208:211], v[152:155]
  s_nop 4
  v_pk_mul_f32 v[92:93], v[92:93], v[12:13]
  v_pk_mul_f32 v[94:95], v[94:95], v[14:15]
  v_pk_mul_f32 v[96:97], v[96:97], v[16:17]
  v_pk_mul_f32 v[98:99], v[98:99], v[18:19]
  v_pk_mul_f32 v[100:101], v[100:101], v[20:21]
  v_pk_mul_f32 v[102:103], v[102:103], v[22:23]
  v_pk_mul_f32 v[104:105], v[104:105], v[24:25]
  v_pk_mul_f32 v[106:107], v[106:107], v[26:27]
  v_cvt_pk_bf16_f32 v220, v92, v93
  v_cvt_pk_bf16_f32 v221, v94, v95
  v_cvt_pk_bf16_f32 v222, v96, v97
  v_cvt_pk_bf16_f32 v223, v98, v99
  v_cvt_pk_bf16_f32 v224, v100, v101
  v_cvt_pk_bf16_f32 v225, v102, v103
  v_cvt_pk_bf16_f32 v226, v104, v105
  v_cvt_pk_bf16_f32 v227, v106, v107
  v_permlane16_swap_b32 v220, v222
  v_permlane16_swap_b32 v221, v223
  v_permlane16_swap_b32 v224, v226
  v_permlane16_swap_b32 v225, v227
  s_add_u32 s48, s45, 0
  buffer_store_dwordx4 v[220:223], v11, s[52:55], s48 offen offset:0 sc1
  buffer_store_dwordx4 v[224:227], v11, s[52:55], s48 offen offset:512 sc1
  s_nop 1
  v_pk_mul_f32 v[108:109], v[108:109], v[28:29]
  v_pk_mul_f32 v[110:111], v[110:111], v[30:31]
  v_pk_mul_f32 v[112:113], v[112:113], v[32:33]
  v_pk_mul_f32 v[114:115], v[114:115], v[34:35]
  v_pk_mul_f32 v[116:117], v[116:117], v[36:37]
  v_pk_mul_f32 v[118:119], v[118:119], v[38:39]
  v_pk_mul_f32 v[120:121], v[120:121], v[40:41]
  v_pk_mul_f32 v[122:123], v[122:123], v[42:43]
  v_cvt_pk_bf16_f32 v220, v108, v109
  v_cvt_pk_bf16_f32 v221, v110, v111
  v_cvt_pk_bf16_f32 v222, v112, v113
  v_cvt_pk_bf16_f32 v223, v114, v115
  v_cvt_pk_bf16_f32 v224, v116, v117
  v_cvt_pk_bf16_f32 v225, v118, v119
  v_cvt_pk_bf16_f32 v226, v120, v121
  v_cvt_pk_bf16_f32 v227, v122, v123
  v_permlane16_swap_b32 v220, v222
  v_permlane16_swap_b32 v221, v223
  v_permlane16_swap_b32 v224, v226
  v_permlane16_swap_b32 v225, v227
  s_add_u32 s48, s45, 69632
  buffer_store_dwordx4 v[220:223], v11, s[52:55], s48 offen offset:0 sc1
  buffer_store_dwordx4 v[224:227], v11, s[52:55], s48 offen offset:512 sc1
  s_nop 1
  v_pk_mul_f32 v[124:125], v[124:125], v[44:45]
  v_pk_mul_f32 v[126:127], v[126:127], v[46:47]
  v_pk_mul_f32 v[128:129], v[128:129], v[48:49]
  v_pk_mul_f32 v[130:131], v[130:131], v[50:51]
  v_pk_mul_f32 v[132:133], v[132:133], v[52:53]
  v_pk_mul_f32 v[134:135], v[134:135], v[54:55]
  v_pk_mul_f32 v[136:137], v[136:137], v[56:57]
  v_pk_mul_f32 v[138:139], v[138:139], v[58:59]
  v_cvt_pk_bf16_f32 v220, v124, v125
  v_cvt_pk_bf16_f32 v221, v126, v127
  v_cvt_pk_bf16_f32 v222, v128, v129
  v_cvt_pk_bf16_f32 v223, v130, v131
  v_cvt_pk_bf16_f32 v224, v132, v133
  v_cvt_pk_bf16_f32 v225, v134, v135
  v_cvt_pk_bf16_f32 v226, v136, v137
  v_cvt_pk_bf16_f32 v227, v138, v139
  v_permlane16_swap_b32 v220, v222
  v_permlane16_swap_b32 v221, v223
  v_permlane16_swap_b32 v224, v226
  v_permlane16_swap_b32 v225, v227
  s_add_u32 s48, s45, 139264
  buffer_store_dwordx4 v[220:223], v11, s[52:55], s48 offen offset:0 sc1
  buffer_store_dwordx4 v[224:227], v11, s[52:55], s48 offen offset:512 sc1
  s_nop 1
  v_pk_mul_f32 v[140:141], v[140:141], v[60:61]
  v_pk_mul_f32 v[142:143], v[142:143], v[62:63]
  v_pk_mul_f32 v[144:145], v[144:145], v[64:65]
  v_pk_mul_f32 v[146:147], v[146:147], v[66:67]
  v_pk_mul_f32 v[148:149], v[148:149], v[68:69]
  v_pk_mul_f32 v[150:151], v[150:151], v[70:71]
  v_pk_mul_f32 v[152:153], v[152:153], v[72:73]
  v_pk_mul_f32 v[154:155], v[154:155], v[74:75]
  v_cvt_pk_bf16_f32 v220, v140, v141
  v_cvt_pk_bf16_f32 v221, v142, v143
  v_cvt_pk_bf16_f32 v222, v144, v145
  v_cvt_pk_bf16_f32 v223, v146, v147
  v_cvt_pk_bf16_f32 v224, v148, v149
  v_cvt_pk_bf16_f32 v225, v150, v151
  v_cvt_pk_bf16_f32 v226, v152, v153
  v_cvt_pk_bf16_f32 v227, v154, v155
  v_permlane16_swap_b32 v220, v222
  v_permlane16_swap_b32 v221, v223
  v_permlane16_swap_b32 v224, v226
  v_permlane16_swap_b32 v225, v227
  s_add_u32 s48, s45, 208896
  buffer_store_dwordx4 v[220:223], v11, s[52:55], s48 offen offset:0 sc1
  buffer_store_dwordx4 v[224:227], v11, s[52:55], s48 offen offset:512 sc1
  s_nop 1
  s_add_u32 s64, s92, 33030144
  s_addc_u32 s65, s93, 0
  s_mov_b32 s66, 20480
  s_mov_b32 s67, 0x20000
  s_add_u32 s98, s94, 3
  v_mov_b32 v220, s98
  v_mov_b32 v221, 0x40000000
  v_cmp_gt_u32 vcc, 16, v0
  s_lshl_b32 s98, s2, 2
  v_mul_u32_u24 v222, 1280, v0
  v_cndmask_b32 v221, v221, v222, vcc
  v_readfirstlane_b32 s99, v0
  s_waitcnt vmcnt(0)
  s_barrier
  s_cmp_lg_u32 s99, 0
  s_cbranch_scc1 noflag_19
  buffer_store_dword v220, v221, s[64:67], s98 offen sc1
noflag_19:
  s_branch PH3
P2_g_ld:
  v_and_b32 v1, 63, v0
  v_bfe_u32 v2, v0, 6, 2
  s_nop 0
  v_readfirstlane_b32 s16, v2
  v_mul_u32_u24 v3, 256, v2
  v_add_u32 v3, v3, v1
  v_bfe_u32 v4, v3, 3, 4
  v_and_b32 v5, 7, v3
  v_lshrrev_b32 v3, 7, v3
  v_bfe_u32 v8, v4, 1, 1
  v_xor_b32 v8, v8, v3
  v_and_b32 v8, 1, v8
  v_lshlrev_b32 v8, 2, v8
  v_xor_b32 v5, v5, v8
  v_lshl_add_u32 v3, v3, 3, v5
  v_mul_u32_u24 v9, 34816, v4
  v_lshl_add_u32 v9, v3, 4, v9
  v_add_u32 v9, s20, v9
  v_mul_u32_u24 v3, 256, v2
  v_add_u32 v3, v3, v1
  v_add_u32 v3, 64, v3
  v_bfe_u32 v4, v3, 3, 4
  v_and_b32 v5, 7, v3
  v_lshrrev_b32 v3, 7, v3
  v_bfe_u32 v8, v4, 1, 1
  v_xor_b32 v8, v8, v3
  v_and_b32 v8, 1, v8
  v_lshlrev_b32 v8, 2, v8
  v_xor_b32 v5, v5, v8
  v_lshl_add_u32 v3, v3, 3, v5
  v_mul_u32_u24 v10, 34816, v4
  v_lshl_add_u32 v10, v3, 4, v10
  v_add_u32 v10, s20, v10
  v_mul_u32_u24 v3, 256, v2
  v_add_u32 v3, v3, v1
  v_add_u32 v3, 128, v3
  v_bfe_u32 v4, v3, 3, 4
  v_and_b32 v5, 7, v3
  v_lshrrev_b32 v3, 7, v3
  v_bfe_u32 v8, v4, 1, 1
  v_xor_b32 v8, v8, v3
  v_and_b32 v8, 1, v8
  v_lshlrev_b32 v8, 2, v8
  v_xor_b32 v5, v5, v8
  v_lshl_add_u32 v3, v3, 3, v5
  v_mul_u32_u24 v11, 34816, v4
  v_lshl_add_u32 v11, v3, 4, v11
  v_add_u32 v11, s20, v11
  v_mul_u32_u24 v3, 256, v2
  v_add_u32 v3, v3, v1
  v_add_u32 v3, 192, v3
  v_bfe_u32 v4, v3, 3, 4
  v_and_b32 v5, 7, v3
  v_lshrrev_b32 v3, 7, v3
  v_bfe_u32 v8, v4, 1, 1
  v_xor_b32 v8, v8, v3
  v_and_b32 v8, 1, v8
  v_lshlrev_b32 v8, 2, v8
  v_xor_b32 v5, v5, v8
  v_lshl_add_u32 v3, v3, 3, v5
  v_mul_u32_u24 v12, 34816, v4
  v_lshl_add_u32 v12, v3, 4, v12
  v_add_u32 v12, s20, v12
  s_lshl_b32 s21, s18, 19
  v_mul_u32_u24 v3, 32, v2
  v_lshrrev_b32 v4, 3, v1
  v_add3_u32 v3, v3, v4, 0
  v_bfe_u32 v4, v3, 1, 3
  v_and_b32 v8, 7, v1
  v_xor_b32 v4, v4, v8
  v_lshlrev_b32 v13, 12, v3
  v_lshl_add_u32 v13, v4, 4, v13
  v_add_u32 v13, s21, v13
  v_mul_u32_u24 v3, 32, v2
  v_lshrrev_b32 v4, 3, v1
  v_add3_u32 v3, v3, v4, 8
  v_bfe_u32 v4, v3, 1, 3
  v_and_b32 v8, 7, v1
  v_xor_b32 v4, v4, v8
  v_lshlrev_b32 v14, 12, v3
  v_lshl_add_u32 v14, v4, 4, v14
  v_add_u32 v14, s21, v14
  v_mul_u32_u24 v3, 32, v2
  v_lshrrev_b32 v4, 3, v1
  v_add3_u32 v3, v3, v4, 16
  v_bfe_u32 v4, v3, 1, 3
  v_and_b32 v8, 7, v1
  v_xor_b32 v4, v4, v8
  v_lshlrev_b32 v15, 12, v3
  v_lshl_add_u32 v15, v4, 4, v15
  v_add_u32 v15, s21, v15
  v_mul_u32_u24 v3, 32, v2
  v_lshrrev_b32 v4, 3, v1
  v_add3_u32 v3, v3, v4, 24
  v_bfe_u32 v4, v3, 1, 3
  v_and_b32 v8, 7, v1
  v_xor_b32 v4, v4, v8
  v_lshlrev_b32 v16, 12, v3
  v_lshl_add_u32 v16, v4, 4, v16
  v_add_u32 v16, s21, v16
  s_mul_i32 s34, s16, 4096
  s_mul_i32 s35, s16, 4096
  s_lshl_b32 s32, s17, 14
  s_lshl_b32 s33, s17, 11
  s_waitcnt lgkmcnt(0)
  s_add_u32 s24, s6, 12582912
  s_addc_u32 s25, s7, 0
  s_mov_b32 s26, 3760128
  s_mov_b32 s27, 0x20000
  s_mov_b32 s28, s4
  s_mov_b32 s29, s5
  s_mov_b32 s30, 8388608
  s_mov_b32 s31, 0x20000
  s_mov_b32 s97, 1
  s_cmp_lg_u32 s16, 0
  s_cbranch_scc1 pre_20
  s_add_u32 s64, s92, 33030144
  s_addc_u32 s65, s93, 0
  s_mov_b32 s66, 20480
  s_mov_b32 s67, 0x20000
  v_lshlrev_b32 v24, 4, v1
  s_and_b32 s98, s2, 15
  s_mul_i32 s98, s98, 1280
  v_add_u32 v24, s98, v24
  s_add_u32 s98, s94, 2
  s_mov_b32 s97, 0
pre_20:
  s_waitcnt vmcnt(0)
  s_barrier
  s_add_u32 m0, s35, 16384
  s_nop 0
  buffer_load_dwordx4 v13, s[28:31], s33 offen  lds
  s_add_u32 m0, s35, 17408
  s_nop 0
  buffer_load_dwordx4 v14, s[28:31], s33 offen  lds
  s_add_u32 m0, s35, 18432
  s_nop 0
  buffer_load_dwordx4 v15, s[28:31], s33 offen  lds
  s_add_u32 m0, s35, 19456
  s_nop 0
  buffer_load_dwordx4 v16, s[28:31], s33 offen  lds
  s_add_u32 s33, s33, 128
  s_add_u32 m0, s35, 49152
  s_nop 0
  buffer_load_dwordx4 v13, s[28:31], s33 offen  lds
  s_add_u32 m0, s35, 50176
  s_nop 0
  buffer_load_dwordx4 v14, s[28:31], s33 offen  lds
  s_add_u32 m0, s35, 51200
  s_nop 0
  buffer_load_dwordx4 v15, s[28:31], s33 offen  lds
  s_add_u32 m0, s35, 52224
  s_nop 0
  buffer_load_dwordx4 v16, s[28:31], s33 offen  lds
  s_add_u32 s33, s33, 128
  s_add_u32 m0, s35, 81920
  s_nop 0
  buffer_load_dwordx4 v13, s[28:31], s33 offen  lds
  s_add_u32 m0, s35, 82944
  s_nop 0
  buffer_load_dwordx4 v14, s[28:31], s33 offen  lds
  s_add_u32 m0, s35, 83968
  s_nop 0
  buffer_load_dwordx4 v15, s[28:31], s33 offen  lds
  s_add_u32 m0, s35, 84992
  s_nop 0
  buffer_load_dwordx4 v16, s[28:31], s33 offen  lds
  s_add_u32 s33, s33, 128
  s_add_u32 m0, s35, 114688
  s_nop 0
  buffer_load_dwordx4 v13, s[28:31], s33 offen  lds
  s_add_u32 m0, s35, 115712
  s_nop 0
  buffer_load_dwordx4 v14, s[28:31], s33 offen  lds
  s_add_u32 m0, s35, 116736
  s_nop 0
  buffer_load_dwordx4 v15, s[28:31], s33 offen  lds
  s_add_u32 m0, s35, 117760
  s_nop 0
  buffer_load_dwordx4 v16, s[28:31], s33 offen  lds
  s_add_u32 s33, s33, 128
  s_add_u32 m0, s35, 147456
  s_nop 0
  buffer_load_dwordx4 v13, s[28:31], s33 offen  lds
  s_add_u32 m0, s35, 148480
  s_nop 0
  buffer_load_dwordx4 v14, s[28:31], s33 offen  lds
  s_add_u32 m0, s35, 149504
  s_nop 0
  buffer_load_dwordx4 v15, s[28:31], s33 offen  lds
  s_add_u32 m0, s35, 150528
  s_nop 0
  buffer_load_dwordx4 v16, s[28:31], s33 offen  lds
  s_add_u32 s33, s33, 128
  s_cmp_eq_u32 s97, 1
  s_cbranch_scc1 pollskip_22
  s_mov_b32 s99, 0
poll_21:
  buffer_load_dwordx4 v[20:23], v24, s[64:67], 0 offen sc1
  s_waitcnt vmcnt(0)
  v_subrev_u32 v20, s98, v20
  v_subrev_u32 v21, s98, v21
  v_subrev_u32 v22, s98, v22
  v_subrev_u32 v23, s98, v23
  v_max_u32 v20, v20, v21
  v_max_u32 v22, v22, v23
  v_max_u32 v20, v20, v22
  v_cmp_ge_u32 vcc, 1, v20
  s_add_u32 s99, s99, 1
  s_cmp_eq_u64 vcc, exec
  s_cbranch_scc1 pollskip_22
  s_cmp_lt_u32 s99, 40000
  s_cbranch_scc1 poll_21
pollskip_22:
  s_barrier
  s_add_u32 m0, s34, 0
  s_nop 0
  buffer_load_dwordx4 v9, s[24:27], s32 offen sc1 lds
  s_add_u32 m0, s34, 1024
  s_nop 0
  buffer_load_dwordx4 v10, s[24:27], s32 offen sc1 lds
  s_add_u32 m0, s34, 2048
  s_nop 0
  buffer_load_dwordx4 v11, s[24:27], s32 offen sc1 lds
  s_add_u32 m0, s34, 3072
  s_nop 0
  buffer_load_dwordx4 v12, s[24:27], s32 offen sc1 lds
  s_add_u32 s32, s32, 1024
  s_add_u32 m0, s34, 32768
  s_nop 0
  buffer_load_dwordx4 v9, s[24:27], s32 offen sc1 lds
  s_add_u32 m0, s34, 33792
  s_nop 0
  buffer_load_dwordx4 v10, s[24:27], s32 offen sc1 lds
  s_add_u32 m0, s34, 34816
  s_nop 0
  buffer_load_dwordx4 v11, s[24:27], s32 offen sc1 lds
  s_add_u32 m0, s34, 35840
  s_nop 0
  buffer_load_dwordx4 v12, s[24:27], s32 offen sc1 lds
  s_add_u32 s32, s32, 1024
  s_waitcnt vmcnt(4)
  s_barrier
  s_add_u32 m0, s34, 65536
  s_nop 0
  buffer_load_dwordx4 v9, s[24:27], s32 offen sc1 lds
  s_add_u32 m0, s34, 66560
  s_nop 0
  buffer_load_dwordx4 v10, s[24:27], s32 offen sc1 lds
  s_add_u32 m0, s34, 67584
  s_nop 0
  buffer_load_dwordx4 v11, s[24:27], s32 offen sc1 lds
  s_add_u32 m0, s34, 68608
  s_nop 0
  buffer_load_dwordx4 v12, s[24:27], s32 offen sc1 lds
  s_add_u32 s32, s32, 1024
  s_add_u32 m0, s34, 98304
  s_nop 0
  buffer_load_dwordx4 v9, s[24:27], s32 offen sc1 lds
  s_add_u32 m0, s34, 99328
  s_nop 0
  buffer_load_dwordx4 v10, s[24:27], s32 offen sc1 lds
  s_add_u32 m0, s34, 100352
  s_nop 0
  buffer_load_dwordx4 v11, s[24:27], s32 offen sc1 lds
  s_add_u32 m0, s34, 101376
  s_nop 0
  buffer_load_dwordx4 v12, s[24:27], s32 offen sc1 lds
  s_add_u32 s32, s32, 1024
  s_add_u32 m0, s34, 131072
  s_nop 0
  buffer_load_dwordx4 v9, s[24:27], s32 offen sc1 lds
  s_add_u32 m0, s34, 132096
  s_nop 0
  buffer_load_dwordx4 v10, s[24:27], s32 offen sc1 lds
  s_add_u32 m0, s34, 133120
  s_nop 0
  buffer_load_dwordx4 v11, s[24:27], s32 offen sc1 lds
  s_add_u32 m0, s34, 134144
  s_nop 0
  buffer_load_dwordx4 v12, s[24:27], s32 offen sc1 lds
  s_add_u32 s32, s32, 1024
  s_waitcnt vmcnt(12)
  s_barrier
  s_add_u32 m0, s34, 0
  s_nop 0
  buffer_load_dwordx4 v9, s[24:27], s32 offen sc1 lds
  s_add_u32 m0, s34, 1024
  s_nop 0
  buffer_load_dwordx4 v10, s[24:27], s32 offen sc1 lds
  s_add_u32 m0, s34, 2048
  s_nop 0
  buffer_load_dwordx4 v11, s[24:27], s32 offen sc1 lds
  s_add_u32 m0, s34, 3072
  s_nop 0
  buffer_load_dwordx4 v12, s[24:27], s32 offen sc1 lds
  s_add_u32 s32, s32, 1024
  s_add_u32 m0, s35, 16384
  s_nop 0
  buffer_load_dwordx4 v13, s[28:31], s33 offen  lds
  s_add_u32 m0, s35, 17408
  s_nop 0
  buffer_load_dwordx4 v14, s[28:31], s33 offen  lds
  s_add_u32 m0, s35, 18432
  s_nop 0
  buffer_load_dwordx4 v15, s[28:31], s33 offen  lds
  s_add_u32 m0, s35, 19456
  s_nop 0
  buffer_load_dwordx4 v16, s[28:31], s33 offen  lds
  s_add_u32 s33, s33, 128
  s_waitcnt vmcnt(16)
  s_barrier
  s_add_u32 m0, s34, 32768
  s_nop 0
  buffer_load_dwordx4 v9, s[24:27], s32 offen sc1 lds
  s_add_u32 m0, s34, 33792
  s_nop 0
  buffer_load_dwordx4 v10, s[24:27], s32 offen sc1 lds
  s_add_u32 m0, s34, 34816
  s_nop 0
  buffer_load_dwordx4 v11, s[24:27], s32 offen sc1 lds
  s_add_u32 m0, s34, 35840
  s_nop 0
  buffer_load_dwordx4 v12, s[24:27], s32 offen sc1 lds
  s_add_u32 s32, s32, 1024
  s_add_u32 m0, s35, 49152
  s_nop 0
  buffer_load_dwordx4 v13, s[28:31], s33 offen  lds
  s_add_u32 m0, s35, 50176
  s_nop 0
  buffer_load_dwordx4 v14, s[28:31], s33 offen  lds
  s_add_u32 m0, s35, 51200
  s_nop 0
  buffer_load_dwordx4 v15, s[28:31], s33 offen  lds
  s_add_u32 m0, s35, 52224
  s_nop 0
  buffer_load_dwordx4 v16, s[28:31], s33 offen  lds
  s_add_u32 s33, s33, 128
  s_waitcnt vmcnt(20)
  s_barrier
  s_add_u32 m0, s34, 65536
  s_nop 0
  buffer_load_dwordx4 v9, s[24:27], s32 offen sc1 lds
  s_add_u32 m0, s34, 66560
  s_nop 0
  buffer_load_dwordx4 v10, s[24:27], s32 offen sc1 lds
  s_add_u32 m0, s34, 67584
  s_nop 0
  buffer_load_dwordx4 v11, s[24:27], s32 offen sc1 lds
  s_add_u32 m0, s34, 68608
  s_nop 0
  buffer_load_dwordx4 v12, s[24:27], s32 offen sc1 lds
  s_add_u32 s32, s32, 1024
  s_add_u32 m0, s35, 81920
  s_nop 0
  buffer_load_dwordx4 v13, s[28:31], s33 offen  lds
  s_add_u32 m0, s35, 82944
  s_nop 0
  buffer_load_dwordx4 v14, s[28:31], s33 offen  lds
  s_add_u32 m0, s35, 83968
  s_nop 0
  buffer_load_dwordx4 v15, s[28:31], s33 offen  lds
  s_add_u32 m0, s35, 84992
  s_nop 0
  buffer_load_dwordx4 v16, s[28:31], s33 offen  lds
  s_add_u32 s33, s33, 128
  s_waitcnt vmcnt(24)
  s_barrier
  s_add_u32 m0, s34, 98304
  s_nop 0
  buffer_load_dwordx4 v9, s[24:27], s32 offen sc1 lds
  s_add_u32 m0, s34, 99328
  s_nop 0
  buffer_load_dwordx4 v10, s[24:27], s32 offen sc1 lds
  s_add_u32 m0, s34, 100352
  s_nop 0
  buffer_load_dwordx4 v11, s[24:27], s32 offen sc1 lds
  s_add_u32 m0, s34, 101376
  s_nop 0
  buffer_load_dwordx4 v12, s[24:27], s32 offen sc1 lds
  s_add_u32 s32, s32, 1024
  s_add_u32 m0, s35, 114688
  s_nop 0
  buffer_load_dwordx4 v13, s[28:31], s33 offen  lds
  s_add_u32 m0, s35, 115712
  s_nop 0
  buffer_load_dwordx4 v14, s[28:31], s33 offen  lds
  s_add_u32 m0, s35, 116736
  s_nop 0
  buffer_load_dwordx4 v15, s[28:31], s33 offen  lds
  s_add_u32 m0, s35, 117760
  s_nop 0
  buffer_load_dwordx4 v16, s[28:31], s33 offen  lds
  s_add_u32 s33, s33, 128
  s_waitcnt vmcnt(24)
  s_barrier
  s_add_u32 m0, s34, 131072
  s_nop 0
  buffer_load_dwordx4 v9, s[24:27], s32 offen sc1 lds
  s_add_u32 m0, s34, 132096
  s_nop 0
  buffer_load_dwordx4 v10, s[24:27], s32 offen sc1 lds
  s_add_u32 m0, s34, 133120
  s_nop 0
  buffer_load_dwordx4 v11, s[24:27], s32 offen sc1 lds
  s_add_u32 m0, s34, 134144
  s_nop 0
  buffer_load_dwordx4 v12, s[24:27], s32 offen sc1 lds
  s_add_u32 s32, s32, 1024
  s_add_u32 m0, s35, 147456
  s_nop 0
  buffer_load_dwordx4 v13, s[28:31], s33 offen  lds
  s_add_u32 m0, s35, 148480
  s_nop 0
  buffer_load_dwordx4 v14, s[28:31], s33 offen  lds
  s_add_u32 m0, s35, 149504
  s_nop 0
  buffer_load_dwordx4 v15, s[28:31], s33 offen  lds
  s_add_u32 m0, s35, 150528
  s_nop 0
  buffer_load_dwordx4 v16, s[28:31], s33 offen  lds
  s_add_u32 s33, s33, 128
  s_waitcnt vmcnt(24)
  s_barrier
  s_add_u32 m0, s34, 0
  s_nop 0
  buffer_load_dwordx4 v9, s[24:27], s32 offen sc1 lds
  s_add_u32 m0, s34, 1024
  s_nop 0
  buffer_load_dwordx4 v10, s[24:27], s32 offen sc1 lds
  s_add_u32 m0, s34, 2048
  s_nop 0
  buffer_load_dwordx4 v11, s[24:27], s32 offen sc1 lds
  s_add_u32 m0, s34, 3072
  s_nop 0
  buffer_load_dwordx4 v12, s[24:27], s32 offen sc1 lds
  s_add_u32 s32, s32, 1024
  s_add_u32 m0, s35, 16384
  s_nop 0
  buffer_load_dwordx4 v13, s[28:31], s33 offen  lds
  s_add_u32 m0, s35, 17408
  s_nop 0
  buffer_load_dwordx4 v14, s[28:31], s33 offen  lds
  s_add_u32 m0, s35, 18432
  s_nop 0
  buffer_load_dwordx4 v15, s[28:31], s33 offen  lds
  s_add_u32 m0, s35, 19456
  s_nop 0
  buffer_load_dwordx4 v16, s[28:31], s33 offen  lds
  s_add_u32 s33, s33, 128
  s_waitcnt vmcnt(24)
  s_barrier
  s_add_u32 m0, s34, 32768
  s_nop 0
  buffer_load_dwordx4 v9, s[24:27], s32 offen sc1 lds
  s_add_u32 m0, s34, 33792
  s_nop 0
  buffer_load_dwordx4 v10, s[24:27], s32 offen sc1 lds
  s_add_u32 m0, s34, 34816
  s_nop 0
  buffer_load_dwordx4 v11, s[24:27], s32 offen sc1 lds
  s_add_u32 m0, s34, 35840
  s_nop 0
  buffer_load_dwordx4 v12, s[24:27], s32 offen sc1 lds
  s_add_u32 s32, s32, 1024
  s_add_u32 m0, s35, 49152
  s_nop 0
  buffer_load_dwordx4 v13, s[28:31], s33 offen  lds
  s_add_u32 m0, s35, 50176
  s_nop 0
  buffer_load_dwordx4 v14, s[28:31], s33 offen  lds
  s_add_u32 m0, s35, 51200
  s_nop 0
  buffer_load_dwordx4 v15, s[28:31], s33 offen  lds
  s_add_u32 m0, s35, 52224
  s_nop 0
  buffer_load_dwordx4 v16, s[28:31], s33 offen  lds
  s_add_u32 s33, s33, 128
  s_waitcnt vmcnt(24)
  s_barrier
  s_add_u32 m0, s34, 65536
  s_nop 0
  buffer_load_dwordx4 v9, s[24:27], s32 offen sc1 lds
  s_add_u32 m0, s34, 66560
  s_nop 0
  buffer_load_dwordx4 v10, s[24:27], s32 offen sc1 lds
  s_add_u32 m0, s34, 67584
  s_nop 0
  buffer_load_dwordx4 v11, s[24:27], s32 offen sc1 lds
  s_add_u32 m0, s34, 68608
  s_nop 0
  buffer_load_dwordx4 v12, s[24:27], s32 offen sc1 lds
  s_add_u32 s32, s32, 1024
  s_add_u32 m0, s35, 81920
  s_nop 0
  buffer_load_dwordx4 v13, s[28:31], s33 offen  lds
  s_add_u32 m0, s35, 82944
  s_nop 0
  buffer_load_dwordx4 v14, s[28:31], s33 offen  lds
  s_add_u32 m0, s35, 83968
  s_nop 0
  buffer_load_dwordx4 v15, s[28:31], s33 offen  lds
  s_add_u32 m0, s35, 84992
  s_nop 0
  buffer_load_dwordx4 v16, s[28:31], s33 offen  lds
  s_add_u32 s33, s33, 128
  s_waitcnt vmcnt(24)
  s_barrier
  s_add_u32 m0, s34, 98304
  s_nop 0
  buffer_load_dwordx4 v9, s[24:27], s32 offen sc1 lds
  s_add_u32 m0, s34, 99328
  s_nop 0
  buffer_load_dwordx4 v10, s[24:27], s32 offen sc1 lds
  s_add_u32 m0, s34, 100352
  s_nop 0
  buffer_load_dwordx4 v11, s[24:27], s32 offen sc1 lds
  s_add_u32 m0, s34, 101376
  s_nop 0
  buffer_load_dwordx4 v12, s[24:27], s32 offen sc1 lds
  s_add_u32 s32, s32, 1024
  s_add_u32 m0, s35, 114688
  s_nop 0
  buffer_load_dwordx4 v13, s[28:31], s33 offen  lds
  s_add_u32 m0, s35, 115712
  s_nop 0
  buffer_load_dwordx4 v14, s[28:31], s33 offen  lds
  s_add_u32 m0, s35, 116736
  s_nop 0
  buffer_load_dwordx4 v15, s[28:31], s33 offen  lds
  s_add_u32 m0, s35, 117760
  s_nop 0
  buffer_load_dwordx4 v16, s[28:31], s33 offen  lds
  s_add_u32 s33, s33, 128
  s_waitcnt vmcnt(24)
  s_barrier
  s_add_u32 m0, s34, 131072
  s_nop 0
  buffer_load_dwordx4 v9, s[24:27], s32 offen sc1 lds
  s_add_u32 m0, s34, 132096
  s_nop 0
  buffer_load_dwordx4 v10, s[24:27], s32 offen sc1 lds
  s_add_u32 m0, s34, 133120
  s_nop 0
  buffer_load_dwordx4 v11, s[24:27], s32 offen sc1 lds
  s_add_u32 m0, s34, 134144
  s_nop 0
  buffer_load_dwordx4 v12, s[24:27], s32 offen sc1 lds
  s_add_u32 s32, s32, 1024
  s_add_u32 m0, s35, 147456
  s_nop 0
  buffer_load_dwordx4 v13, s[28:31], s33 offen  lds
  s_add_u32 m0, s35, 148480
  s_nop 0
  buffer_load_dwordx4 v14, s[28:31], s33 offen  lds
  s_add_u32 m0, s35, 149504
  s_nop 0
  buffer_load_dwordx4 v15, s[28:31], s33 offen  lds
  s_add_u32 m0, s35, 150528
  s_nop 0
  buffer_load_dwordx4 v16, s[28:31], s33 offen  lds
  s_add_u32 s33, s33, 128
  s_waitcnt vmcnt(24)
  s_barrier
  s_add_u32 m0, s34, 0
  s_nop 0
  buffer_load_dwordx4 v9, s[24:27], s32 offen sc1 lds
  s_add_u32 m0, s34, 1024
  s_nop 0
  buffer_load_dwordx4 v10, s[24:27], s32 offen sc1 lds
  s_add_u32 m0, s34, 2048
  s_nop 0
  buffer_load_dwordx4 v11, s[24:27], s32 offen sc1 lds
  s_add_u32 m0, s34, 3072
  s_nop 0
  buffer_load_dwordx4 v12, s[24:27], s32 offen sc1 lds
  s_add_u32 s32, s32, 1024
  s_add_u32 m0, s35, 16384
  s_nop 0
  buffer_load_dwordx4 v13, s[28:31], s33 offen  lds
  s_add_u32 m0, s35, 17408
  s_nop 0
  buffer_load_dwordx4 v14, s[28:31], s33 offen  lds
  s_add_u32 m0, s35, 18432
  s_nop 0
  buffer_load_dwordx4 v15, s[28:31], s33 offen  lds
  s_add_u32 m0, s35, 19456
  s_nop 0
  buffer_load_dwordx4 v16, s[28:31], s33 offen  lds
  s_add_u32 s33, s33, 128
  s_waitcnt vmcnt(24)
  s_barrier
  s_waitcnt vmcnt(16)
  s_barrier
  s_waitcnt vmcnt(8)
  s_barrier
  s_waitcnt vmcnt(0)
  s_barrier
  s_branch PH3
P2_dft:
  s_sub_u32 s20, s15, 28
  s_lshr_b32 s18, s14, 2
  s_and_b32 s19, s14, 3
  s_lshl_b32 s17, s20, 3
  s_add_u32 s17, s17, s14
  v_readfirstlane_b32 s98, v0
  s_nop 3
  s_cmp_ge_u32 s98, 256
  s_cbranch_scc1 P2_d_ld
  v_and_b32 v1, 63, v0
  v_bfe_u32 v2, v0, 6, 2
  s_nop 0
  v_readfirstlane_b32 s16, v2
  v_mov_b32 v9, 0
  v_lshlrev_b32 v10, 5, v2
  v_and_b32 v3, 31, v1
  v_add_u32 v3, v3, v9
  v_lshrrev_b32 v4, 3, v3
  v_lshlrev_b32 v4, 10, v4
  v_and_b32 v5, 7, v3
  v_lshl_add_u32 v4, v5, 4, v4
  v_bfe_u32 v5, v3, 4, 1
  v_lshrrev_b32 v6, 5, v1
  v_xor_b32 v5, v5, v6
  v_lshl_add_u32 v4, v5, 7, v4
  v_add_u32 v11, 0, v4
  v_add_u32 v12, 57344, v11
  v_add_u32 v13, 114688, v11
  v_and_b32 v3, 31, v1
  v_bfe_u32 v4, v1, 1, 3
  v_lshrrev_b32 v5, 5, v1
  v_xor_b32 v4, v4, v5
  v_lshlrev_b32 v4, 4, v4
  v_add_u32 v3, v3, v10
  v_lshl_add_u32 v4, v3, 7, v4
  v_xor_b32 v14, 0, v4
  v_add_u32 v14, 12288, v14
  v_xor_b32 v15, 32, v4
  v_add_u32 v15, 12288, v15
  v_xor_b32 v16, 64, v4
  v_add_u32 v16, 12288, v16
  v_xor_b32 v17, 96, v4
  v_add_u32 v17, 12288, v17
  v_add_u32 v18, 57344, v14
  v_add_u32 v19, 57344, v15
  v_add_u32 v20, 57344, v16
  v_add_u32 v21, 57344, v17
  v_add_u32 v22, 114688, v14
  v_add_u32 v23, 114688, v15
  v_add_u32 v24, 114688, v16
  v_add_u32 v25, 114688, v17
  v_lshrrev_b32 v3, 5, v1
  v_lshlrev_b32 v36, 13, v3
  v_and_b32 v3, 31, v1
  v_add_u32 v3, v3, v10
  v_lshl_add_u32 v36, v3, 4, v36
  s_mul_i32 s44, s20, 81920
  s_lshl_b32 s45, s19, 11
  s_add_u32 s44, s44, s45
  s_mul_i32 s45, s18, 393216
  s_add_u32 s44, s44, s45
  s_waitcnt lgkmcnt(0)
  s_add_u32 s24, s6, 27262976
  s_addc_u32 s25, s7, 0
  s_mov_b32 s26, 1572864
  s_mov_b32 s27, 0x20000
  s_barrier
  s_barrier
  ds_read_b128 v[152:155], v11 offset:0
  ds_read_b128 v[156:159], v14 offset:0
  ds_read_b128 v[160:163], v11 offset:4096
  ds_read_b128 v[164:167], v11 offset:8192
  s_waitcnt lgkmcnt(2)
  v_mfma_f32_32x32x16_bf16 v[56:71], v[152:155], v[156:159], 0
  ds_read_b128 v[168:171], v11 offset:256
  ds_read_b128 v[172:175], v15 offset:0
  s_waitcnt lgkmcnt(3)
  v_mfma_f32_32x32x16_bf16 v[72:87], v[160:163], v[156:159], 0
  ds_read_b128 v[176:179], v11 offset:4352
  ds_read_b128 v[180:183], v11 offset:8448
  s_waitcnt lgkmcnt(4)
  v_mfma_f32_32x32x16_bf16 v[88:103], v[164:167], v[156:159], 0
  s_waitcnt lgkmcnt(2)
  v_mfma_f32_32x32x16_bf16 v[56:71], v[168:171], v[172:175], v[56:71]
  ds_read_b128 v[152:155], v11 offset:512
  ds_read_b128 v[156:159], v16 offset:0
  s_waitcnt lgkmcnt(3)
  v_mfma_f32_32x32x16_bf16 v[72:87], v[176:179], v[172:175], v[72:87]
  ds_read_b128 v[160:163], v11 offset:4608
  ds_read_b128 v[164:167], v11 offset:8704
  s_waitcnt lgkmcnt(4)
  v_mfma_f32_32x32x16_bf16 v[88:103], v[180:183], v[172:175], v[88:103]
  s_waitcnt lgkmcnt(2)
  v_mfma_f32_32x32x16_bf16 v[56:71], v[152:155], v[156:159], v[56:71]
  ds_read_b128 v[168:171], v11 offset:768
  ds_read_b128 v[172:175], v17 offset:0
  s_waitcnt lgkmcnt(3)
  v_mfma_f32_32x32x16_bf16 v[72:87], v[160:163], v[156:159], v[72:87]
  ds_read_b128 v[176:179], v11 offset:4864
  ds_read_b128 v[180:183], v11 offset:8960
  s_waitcnt lgkmcnt(4)
  v_mfma_f32_32x32x16_bf16 v[88:103], v[164:167], v[156:159], v[88:103]
  s_waitcnt lgkmcnt(2)
  v_mfma_f32_32x32x16_bf16 v[56:71], v[168:171], v[172:175], v[56:71]
  s_waitcnt lgkmcnt(0)
  s_barrier
  ds_read_b128 v[152:155], v11 offset:28672
  ds_read_b128 v[156:159], v14 offset:28672
  v_mfma_f32_32x32x16_bf16 v[72:87], v[176:179], v[172:175], v[72:87]
  ds_read_b128 v[160:163], v11 offset:32768
  ds_read_b128 v[164:167], v11 offset:36864
  v_mfma_f32_32x32x16_bf16 v[88:103], v[180:183], v[172:175], v[88:103]
  s_waitcnt lgkmcnt(2)
  v_mfma_f32_32x32x16_bf16 v[56:71], v[152:155], v[156:159], v[56:71]
  ds_read_b128 v[168:171], v11 offset:28928
  ds_read_b128 v[172:175], v15 offset:28672
  s_waitcnt lgkmcnt(3)
  v_mfma_f32_32x32x16_bf16 v[72:87], v[160:163], v[156:159], v[72:87]
  ds_read_b128 v[176:179], v11 offset:33024
  ds_read_b128 v[180:183], v11 offset:37120
  s_waitcnt lgkmcnt(4)
  v_mfma_f32_32x32x16_bf16 v[88:103], v[164:167], v[156:159], v[88:103]
  s_waitcnt lgkmcnt(2)
  v_mfma_f32_32x32x16_bf16 v[56:71], v[168:171], v[172:175], v[56:71]
  ds_read_b128 v[152:155], v11 offset:29184
  ds_read_b128 v[156:159], v16 offset:28672
  s_waitcnt lgkmcnt(3)
  v_mfma_f32_32x32x16_bf16 v[72:87], v[176:179], v[172:175], v[72:87]
  ds_read_b128 v[160:163], v11 offset:33280
  ds_read_b128 v[164:167], v11 offset:37376
  s_waitcnt lgkmcnt(4)
  v_mfma_f32_32x32x16_bf16 v[88:103], v[180:183], v[172:175], v[88:103]
  s_waitcnt lgkmcnt(2)
  v_mfma_f32_32x32x16_bf16 v[56:71], v[152:155], v[156:159], v[56:71]
  ds_read_b128 v[168:171], v11 offset:29440
  ds_read_b128 v[172:175], v17 offset:28672
  s_waitcnt lgkmcnt(3)
  v_mfma_f32_32x32x16_bf16 v[72:87], v[160:163], v[156:159], v[72:87]
  ds_read_b128 v[176:179], v11 offset:33536
  ds_read_b128 v[180:183], v11 offset:37632
  s_waitcnt lgkmcnt(4)
  v_mfma_f32_32x32x16_bf16 v[88:103], v[164:167], v[156:159], v[88:103]
  s_waitcnt lgkmcnt(2)
  v_mfma_f32_32x32x16_bf16 v[56:71], v[168:171], v[172:175], v[56:71]
  s_waitcnt lgkmcnt(0)
  s_barrier
  ds_read_b128 v[152:155], v12 offset:0
  ds_read_b128 v[156:159], v18 offset:0
  v_mfma_f32_32x32x16_bf16 v[72:87], v[176:179], v[172:175], v[72:87]
  ds_read_b128 v[160:163], v12 offset:4096
  ds_read_b128 v[164:167], v12 offset:8192
  v_mfma_f32_32x32x16_bf16 v[88:103], v[180:183], v[172:175], v[88:103]
  s_waitcnt lgkmcnt(2)
  v_mfma_f32_32x32x16_bf16 v[56:71], v[152:155], v[156:159], v[56:71]
  ds_read_b128 v[168:171], v12 offset:256
  ds_read_b128 v[172:175], v19 offset:0
  s_waitcnt lgkmcnt(3)
  v_mfma_f32_32x32x16_bf16 v[72:87], v[160:163], v[156:159], v[72:87]
  ds_read_b128 v[176:179], v12 offset:4352
  ds_read_b128 v[180:183], v12 offset:8448
  s_waitcnt lgkmcnt(4)
  v_mfma_f32_32x32x16_bf16 v[88:103], v[164:167], v[156:159], v[88:103]
  s_waitcnt lgkmcnt(2)
  v_mfma_f32_32x32x16_bf16 v[56:71], v[168:171], v[172:175], v[56:71]
  ds_read_b128 v[152:155], v12 offset:512
  ds_read_b128 v[156:159], v20 offset:0
  s_waitcnt lgkmcnt(3)
  v_mfma_f32_32x32x16_bf16 v[72:87], v[176:179], v[172:175], v[72:87]
  ds_read_b128 v[160:163], v12 offset:4608
  ds_read_b128 v[164:167], v12 offset:8704
  s_waitcnt lgkmcnt(4)
  v_mfma_f32_32x32x16_bf16 v[88:103], v[180:183], v[172:175], v[88:103]
  s_waitcnt lgkmcnt(2)
  v_mfma_f32_32x32x16_bf16 v[56:71], v[152:155], v[156:159], v[56:71]
  ds_read_b128 v[168:171], v12 offset:768
  ds_read_b128 v[172:175], v21 offset:0
  s_waitcnt lgkmcnt(3)
  v_mfma_f32_32x32x16_bf16 v[72:87], v[160:163], v[156:159], v[72:87]
  ds_read_b128 v[176:179], v12 offset:4864
  ds_read_b128 v[180:183], v12 offset:8960
  s_waitcnt lgkmcnt(4)
  v_mfma_f32_32x32x16_bf16 v[88:103], v[164:167], v[156:159], v[88:103]
  s_waitcnt lgkmcnt(2)
  v_mfma_f32_32x32x16_bf16 v[56:71], v[168:171], v[172:175], v[56:71]
  s_waitcnt lgkmcnt(0)
  s_barrier
  ds_read_b128 v[152:155], v12 offset:28672
  ds_read_b128 v[156:159], v18 offset:28672
  v_mfma_f32_32x32x16_bf16 v[72:87], v[176:179], v[172:175], v[72:87]
  ds_read_b128 v[160:163], v12 offset:32768
  ds_read_b128 v[164:167], v12 offset:36864
  v_mfma_f32_32x32x16_bf16 v[88:103], v[180:183], v[172:175], v[88:103]
  s_waitcnt lgkmcnt(2)
  v_mfma_f32_32x32x16_bf16 v[56:71], v[152:155], v[156:159], v[56:71]
  ds_read_b128 v[168:171], v12 offset:28928
  ds_read_b128 v[172:175], v19 offset:28672
  s_waitcnt lgkmcnt(3)
  v_mfma_f32_32x32x16_bf16 v[72:87], v[160:163], v[156:159], v[72:87]
  ds_read_b128 v[176:179], v12 offset:33024
  ds_read_b128 v[180:183], v12 offset:37120
  s_waitcnt lgkmcnt(4)
  v_mfma_f32_32x32x16_bf16 v[88:103], v[164:167], v[156:159], v[88:103]
  s_waitcnt lgkmcnt(2)
  v_mfma_f32_32x32x16_bf16 v[56:71], v[168:171], v[172:175], v[56:71]
  ds_read_b128 v[152:155], v12 offset:29184
  ds_read_b128 v[156:159], v20 offset:28672
  s_waitcnt lgkmcnt(3)
  v_mfma_f32_32x32x16_bf16 v[72:87], v[176:179], v[172:175], v[72:87]
  ds_read_b128 v[160:163], v12 offset:33280
  ds_read_b128 v[164:167], v12 offset:37376
  s_waitcnt lgkmcnt(4)
  v_mfma_f32_32x32x16_bf16 v[88:103], v[180:183], v[172:175], v[88:103]
  s_waitcnt lgkmcnt(2)
  v_mfma_f32_32x32x16_bf16 v[56:71], v[152:155], v[156:159], v[56:71]
  ds_read_b128 v[168:171], v12 offset:29440
  ds_read_b128 v[172:175], v21 offset:28672
  s_waitcnt lgkmcnt(3)
  v_mfma_f32_32x32x16_bf16 v[72:87], v[160:163], v[156:159], v[72:87]
  ds_read_b128 v[176:179], v12 offset:33536
  ds_read_b128 v[180:183], v12 offset:37632
  s_waitcnt lgkmcnt(4)
  v_mfma_f32_32x32x16_bf16 v[88:103], v[164:167], v[156:159], v[88:103]
  s_waitcnt lgkmcnt(2)
  v_mfma_f32_32x32x16_bf16 v[56:71], v[168:171], v[172:175], v[56:71]
  s_waitcnt lgkmcnt(0)
  s_barrier
  ds_read_b128 v[152:155], v13 offset:0
  ds_read_b128 v[156:159], v22 offset:0
  v_mfma_f32_32x32x16_bf16 v[72:87], v[176:179], v[172:175], v[72:87]
  ds_read_b128 v[160:163], v13 offset:4096
  ds_read_b128 v[164:167], v13 offset:8192
  v_mfma_f32_32x32x16_bf16 v[88:103], v[180:183], v[172:175], v[88:103]
  s_waitcnt lgkmcnt(2)
  v_mfma_f32_32x32x16_bf16 v[56:71], v[152:155], v[156:159], v[56:71]
  ds_read_b128 v[168:171], v13 offset:256
  ds_read_b128 v[172:175], v23 offset:0
  s_waitcnt lgkmcnt(3)
  v_mfma_f32_32x32x16_bf16 v[72:87], v[160:163], v[156:159], v[72:87]
  ds_read_b128 v[176:179], v13 offset:4352
  ds_read_b128 v[180:183], v13 offset:8448
  s_waitcnt lgkmcnt(4)
  v_mfma_f32_32x32x16_bf16 v[88:103], v[164:167], v[156:159], v[88:103]
  s_waitcnt lgkmcnt(2)
  v_mfma_f32_32x32x16_bf16 v[56:71], v[168:171], v[172:175], v[56:71]
  ds_read_b128 v[152:155], v13 offset:512
  ds_read_b128 v[156:159], v24 offset:0
  s_waitcnt lgkmcnt(3)
  v_mfma_f32_32x32x16_bf16 v[72:87], v[176:179], v[172:175], v[72:87]
  ds_read_b128 v[160:163], v13 offset:4608
  ds_read_b128 v[164:167], v13 offset:8704
  s_waitcnt lgkmcnt(4)
  v_mfma_f32_32x32x16_bf16 v[88:103], v[180:183], v[172:175], v[88:103]
  s_waitcnt lgkmcnt(2)
  v_mfma_f32_32x32x16_bf16 v[56:71], v[152:155], v[156:159], v[56:71]
  ds_read_b128 v[168:171], v13 offset:768
  ds_read_b128 v[172:175], v25 offset:0
  s_waitcnt lgkmcnt(3)
  v_mfma_f32_32x32x16_bf16 v[72:87], v[160:163], v[156:159], v[72:87]
  ds_read_b128 v[176:179], v13 offset:4864
  ds_read_b128 v[180:183], v13 offset:8960
  s_waitcnt lgkmcnt(4)
  v_mfma_f32_32x32x16_bf16 v[88:103], v[164:167], v[156:159], v[88:103]
  s_waitcnt lgkmcnt(2)
  v_mfma_f32_32x32x16_bf16 v[56:71], v[168:171], v[172:175], v[56:71]
  s_waitcnt lgkmcnt(0)
  s_barrier
  ds_read_b128 v[152:155], v11 offset:0
  ds_read_b128 v[156:159], v14 offset:0
  v_mfma_f32_32x32x16_bf16 v[72:87], v[176:179], v[172:175], v[72:87]
  ds_read_b128 v[160:163], v11 offset:4096
  ds_read_b128 v[164:167], v11 offset:8192
  v_mfma_f32_32x32x16_bf16 v[88:103], v[180:183], v[172:175], v[88:103]
  s_waitcnt lgkmcnt(2)
  v_mfma_f32_32x32x16_bf16 v[56:71], v[152:155], v[156:159], v[56:71]
  ds_read_b128 v[168:171], v11 offset:256
  ds_read_b128 v[172:175], v15 offset:0
  s_waitcnt lgkmcnt(3)
  v_mfma_f32_32x32x16_bf16 v[72:87], v[160:163], v[156:159], v[72:87]
  ds_read_b128 v[176:179], v11 offset:4352
  ds_read_b128 v[180:183], v11 offset:8448
  s_waitcnt lgkmcnt(4)
  v_mfma_f32_32x32x16_bf16 v[88:103], v[164:167], v[156:159], v[88:103]
  s_waitcnt lgkmcnt(2)
  v_mfma_f32_32x32x16_bf16 v[56:71], v[168:171], v[172:175], v[56:71]
  ds_read_b128 v[152:155], v11 offset:512
  ds_read_b128 v[156:159], v16 offset:0
  s_waitcnt lgkmcnt(3)
  v_mfma_f32_32x32x16_bf16 v[72:87], v[176:179], v[172:175], v[72:87]
  ds_read_b128 v[160:163], v11 offset:4608
  ds_read_b128 v[164:167], v11 offset:8704
  s_waitcnt lgkmcnt(4)
  v_mfma_f32_32x32x16_bf16 v[88:103], v[180:183], v[172:175], v[88:103]
  s_waitcnt lgkmcnt(2)
  v_mfma_f32_32x32x16_bf16 v[56:71], v[152:155], v[156:159], v[56:71]
  ds_read_b128 v[168:171], v11 offset:768
  ds_read_b128 v[172:175], v17 offset:0
  s_waitcnt lgkmcnt(3)
  v_mfma_f32_32x32x16_bf16 v[72:87], v[160:163], v[156:159], v[72:87]
  ds_read_b128 v[176:179], v11 offset:4864
  ds_read_b128 v[180:183], v11 offset:8960
  s_waitcnt lgkmcnt(4)
  v_mfma_f32_32x32x16_bf16 v[88:103], v[164:167], v[156:159], v[88:103]
  s_waitcnt lgkmcnt(2)
  v_mfma_f32_32x32x16_bf16 v[56:71], v[168:171], v[172:175], v[56:71]
  s_waitcnt lgkmcnt(0)
  s_barrier
  ds_read_b128 v[152:155], v11 offset:28672
  ds_read_b128 v[156:159], v14 offset:28672
  v_mfma_f32_32x32x16_bf16 v[72:87], v[176:179], v[172:175], v[72:87]
  ds_read_b128 v[160:163], v11 offset:32768
  ds_read_b128 v[164:167], v11 offset:36864
  v_mfma_f32_32x32x16_bf16 v[88:103], v[180:183], v[172:175], v[88:103]
  s_waitcnt lgkmcnt(2)
  v_mfma_f32_32x32x16_bf16 v[56:71], v[152:155], v[156:159], v[56:71]
  ds_read_b128 v[168:171], v11 offset:28928
  ds_read_b128 v[172:175], v15 offset:28672
  s_waitcnt lgkmcnt(3)
  v_mfma_f32_32x32x16_bf16 v[72:87], v[160:163], v[156:159], v[72:87]
  ds_read_b128 v[176:179], v11 offset:33024
  ds_read_b128 v[180:183], v11 offset:37120
  s_waitcnt lgkmcnt(4)
  v_mfma_f32_32x32x16_bf16 v[88:103], v[164:167], v[156:159], v[88:103]
  s_waitcnt lgkmcnt(2)
  v_mfma_f32_32x32x16_bf16 v[56:71], v[168:171], v[172:175], v[56:71]
  ds_read_b128 v[152:155], v11 offset:29184
  ds_read_b128 v[156:159], v16 offset:28672
  s_waitcnt lgkmcnt(3)
  v_mfma_f32_32x32x16_bf16 v[72:87], v[176:179], v[172:175], v[72:87]
  ds_read_b128 v[160:163], v11 offset:33280
  ds_read_b128 v[164:167], v11 offset:37376
  s_waitcnt lgkmcnt(4)
  v_mfma_f32_32x32x16_bf16 v[88:103], v[180:183], v[172:175], v[88:103]
  s_waitcnt lgkmcnt(2)
  v_mfma_f32_32x32x16_bf16 v[56:71], v[152:155], v[156:159], v[56:71]
  ds_read_b128 v[168:171], v11 offset:29440
  ds_read_b128 v[172:175], v17 offset:28672
  s_waitcnt lgkmcnt(3)
  v_mfma_f32_32x32x16_bf16 v[72:87], v[160:163], v[156:159], v[72:87]
  ds_read_b128 v[176:179], v11 offset:33536
  ds_read_b128 v[180:183], v11 offset:37632
  s_waitcnt lgkmcnt(4)
  v_mfma_f32_32x32x16_bf16 v[88:103], v[164:167], v[156:159], v[88:103]
  s_waitcnt lgkmcnt(2)
  v_mfma_f32_32x32x16_bf16 v[56:71], v[168:171], v[172:175], v[56:71]
  s_waitcnt lgkmcnt(0)
  s_barrier
  ds_read_b128 v[152:155], v12 offset:0
  ds_read_b128 v[156:159], v18 offset:0
  v_mfma_f32_32x32x16_bf16 v[72:87], v[176:179], v[172:175], v[72:87]
  ds_read_b128 v[160:163], v12 offset:4096
  ds_read_b128 v[164:167], v12 offset:8192
  v_mfma_f32_32x32x16_bf16 v[88:103], v[180:183], v[172:175], v[88:103]
  s_waitcnt lgkmcnt(2)
  v_mfma_f32_32x32x16_bf16 v[56:71], v[152:155], v[156:159], v[56:71]
  ds_read_b128 v[168:171], v12 offset:256
  ds_read_b128 v[172:175], v19 offset:0
  s_waitcnt lgkmcnt(3)
  v_mfma_f32_32x32x16_bf16 v[72:87], v[160:163], v[156:159], v[72:87]
  ds_read_b128 v[176:179], v12 offset:4352
  ds_read_b128 v[180:183], v12 offset:8448
  s_waitcnt lgkmcnt(4)
  v_mfma_f32_32x32x16_bf16 v[88:103], v[164:167], v[156:159], v[88:103]
  s_waitcnt lgkmcnt(2)
  v_mfma_f32_32x32x16_bf16 v[56:71], v[168:171], v[172:175], v[56:71]
  ds_read_b128 v[152:155], v12 offset:512
  ds_read_b128 v[156:159], v20 offset:0
  s_waitcnt lgkmcnt(3)
  v_mfma_f32_32x32x16_bf16 v[72:87], v[176:179], v[172:175], v[72:87]
  ds_read_b128 v[160:163], v12 offset:4608
  ds_read_b128 v[164:167], v12 offset:8704
  s_waitcnt lgkmcnt(4)
  v_mfma_f32_32x32x16_bf16 v[88:103], v[180:183], v[172:175], v[88:103]
  s_waitcnt lgkmcnt(2)
  v_mfma_f32_32x32x16_bf16 v[56:71], v[152:155], v[156:159], v[56:71]
  ds_read_b128 v[168:171], v12 offset:768
  ds_read_b128 v[172:175], v21 offset:0
  s_waitcnt lgkmcnt(3)
  v_mfma_f32_32x32x16_bf16 v[72:87], v[160:163], v[156:159], v[72:87]
  ds_read_b128 v[176:179], v12 offset:4864
  ds_read_b128 v[180:183], v12 offset:8960
  s_waitcnt lgkmcnt(4)
  v_mfma_f32_32x32x16_bf16 v[88:103], v[164:167], v[156:159], v[88:103]
  s_waitcnt lgkmcnt(2)
  v_mfma_f32_32x32x16_bf16 v[56:71], v[168:171], v[172:175], v[56:71]
  s_waitcnt lgkmcnt(0)
  s_barrier
  ds_read_b128 v[152:155], v12 offset:28672
  ds_read_b128 v[156:159], v18 offset:28672
  v_mfma_f32_32x32x16_bf16 v[72:87], v[176:179], v[172:175], v[72:87]
  ds_read_b128 v[160:163], v12 offset:32768
  ds_read_b128 v[164:167], v12 offset:36864
  v_mfma_f32_32x32x16_bf16 v[88:103], v[180:183], v[172:175], v[88:103]
  s_waitcnt lgkmcnt(2)
  v_mfma_f32_32x32x16_bf16 v[56:71], v[152:155], v[156:159], v[56:71]
  ds_read_b128 v[168:171], v12 offset:28928
  ds_read_b128 v[172:175], v19 offset:28672
  s_waitcnt lgkmcnt(3)
  v_mfma_f32_32x32x16_bf16 v[72:87], v[160:163], v[156:159], v[72:87]
  ds_read_b128 v[176:179], v12 offset:33024
  ds_read_b128 v[180:183], v12 offset:37120
  s_waitcnt lgkmcnt(4)
  v_mfma_f32_32x32x16_bf16 v[88:103], v[164:167], v[156:159], v[88:103]
  s_waitcnt lgkmcnt(2)
  v_mfma_f32_32x32x16_bf16 v[56:71], v[168:171], v[172:175], v[56:71]
  ds_read_b128 v[152:155], v12 offset:29184
  ds_read_b128 v[156:159], v20 offset:28672
  s_waitcnt lgkmcnt(3)
  v_mfma_f32_32x32x16_bf16 v[72:87], v[176:179], v[172:175], v[72:87]
  ds_read_b128 v[160:163], v12 offset:33280
  ds_read_b128 v[164:167], v12 offset:37376
  s_waitcnt lgkmcnt(4)
  v_mfma_f32_32x32x16_bf16 v[88:103], v[180:183], v[172:175], v[88:103]
  s_waitcnt lgkmcnt(2)
  v_mfma_f32_32x32x16_bf16 v[56:71], v[152:155], v[156:159], v[56:71]
  ds_read_b128 v[168:171], v12 offset:29440
  ds_read_b128 v[172:175], v21 offset:28672
  s_waitcnt lgkmcnt(3)
  v_mfma_f32_32x32x16_bf16 v[72:87], v[160:163], v[156:159], v[72:87]
  ds_read_b128 v[176:179], v12 offset:33536
  ds_read_b128 v[180:183], v12 offset:37632
  s_waitcnt lgkmcnt(4)
  v_mfma_f32_32x32x16_bf16 v[88:103], v[164:167], v[156:159], v[88:103]
  s_waitcnt lgkmcnt(2)
  v_mfma_f32_32x32x16_bf16 v[56:71], v[168:171], v[172:175], v[56:71]
  s_waitcnt lgkmcnt(0)
  s_barrier
  ds_read_b128 v[152:155], v13 offset:0
  ds_read_b128 v[156:159], v22 offset:0
  v_mfma_f32_32x32x16_bf16 v[72:87], v[176:179], v[172:175], v[72:87]
  ds_read_b128 v[160:163], v13 offset:4096
  ds_read_b128 v[164:167], v13 offset:8192
  v_mfma_f32_32x32x16_bf16 v[88:103], v[180:183], v[172:175], v[88:103]
  s_waitcnt lgkmcnt(2)
  v_mfma_f32_32x32x16_bf16 v[104:119], v[152:155], v[156:159], 0
  ds_read_b128 v[168:171], v13 offset:256
  ds_read_b128 v[172:175], v23 offset:0
  s_waitcnt lgkmcnt(3)
  v_mfma_f32_32x32x16_bf16 v[120:135], v[160:163], v[156:159], 0
  ds_read_b128 v[176:179], v13 offset:4352
  ds_read_b128 v[180:183], v13 offset:8448
  s_waitcnt lgkmcnt(4)
  v_mfma_f32_32x32x16_bf16 v[136:151], v[164:167], v[156:159], 0
  s_waitcnt lgkmcnt(2)
  v_mfma_f32_32x32x16_bf16 v[104:119], v[168:171], v[172:175], v[104:119]
  ds_read_b128 v[152:155], v13 offset:512
  ds_read_b128 v[156:159], v24 offset:0
  s_waitcnt lgkmcnt(3)
  v_mfma_f32_32x32x16_bf16 v[120:135], v[176:179], v[172:175], v[120:135]
  ds_read_b128 v[160:163], v13 offset:4608
  ds_read_b128 v[164:167], v13 offset:8704
  s_waitcnt lgkmcnt(4)
  v_mfma_f32_32x32x16_bf16 v[136:151], v[180:183], v[172:175], v[136:151]
  s_waitcnt lgkmcnt(2)
  v_mfma_f32_32x32x16_bf16 v[104:119], v[152:155], v[156:159], v[104:119]
  ds_read_b128 v[168:171], v13 offset:768
  ds_read_b128 v[172:175], v25 offset:0
  s_waitcnt lgkmcnt(3)
  v_mfma_f32_32x32x16_bf16 v[120:135], v[160:163], v[156:159], v[120:135]
  ds_read_b128 v[176:179], v13 offset:4864
  ds_read_b128 v[180:183], v13 offset:8960
  s_waitcnt lgkmcnt(4)
  v_mfma_f32_32x32x16_bf16 v[136:151], v[164:167], v[156:159], v[136:151]
  s_waitcnt lgkmcnt(2)
  v_mfma_f32_32x32x16_bf16 v[104:119], v[168:171], v[172:175], v[104:119]
  s_waitcnt lgkmcnt(0)
  s_barrier
  ds_read_b128 v[152:155], v11 offset:0
  ds_read_b128 v[156:159], v14 offset:0
  v_mfma_f32_32x32x16_bf16 v[120:135], v[176:179], v[172:175], v[120:135]
  ds_read_b128 v[160:163], v11 offset:4096
  ds_read_b128 v[164:167], v11 offset:8192
  v_mfma_f32_32x32x16_bf16 v[136:151], v[180:183], v[172:175], v[136:151]
  s_waitcnt lgkmcnt(2)
  v_mfma_f32_32x32x16_bf16 v[104:119], v[152:155], v[156:159], v[104:119]
  ds_read_b128 v[168:171], v11 offset:256
  ds_read_b128 v[172:175], v15 offset:0
  s_waitcnt lgkmcnt(3)
  v_mfma_f32_32x32x16_bf16 v[120:135], v[160:163], v[156:159], v[120:135]
  ds_read_b128 v[176:179], v11 offset:4352
  ds_read_b128 v[180:183], v11 offset:8448
  s_waitcnt lgkmcnt(4)
  v_mfma_f32_32x32x16_bf16 v[136:151], v[164:167], v[156:159], v[136:151]
  s_waitcnt lgkmcnt(2)
  v_mfma_f32_32x32x16_bf16 v[104:119], v[168:171], v[172:175], v[104:119]
  ds_read_b128 v[152:155], v11 offset:512
  ds_read_b128 v[156:159], v16 offset:0
  s_waitcnt lgkmcnt(3)
  v_mfma_f32_32x32x16_bf16 v[120:135], v[176:179], v[172:175], v[120:135]
  ds_read_b128 v[160:163], v11 offset:4608
  ds_read_b128 v[164:167], v11 offset:8704
  s_waitcnt lgkmcnt(4)
  v_mfma_f32_32x32x16_bf16 v[136:151], v[180:183], v[172:175], v[136:151]
  s_waitcnt lgkmcnt(2)
  v_mfma_f32_32x32x16_bf16 v[104:119], v[152:155], v[156:159], v[104:119]
  ds_read_b128 v[168:171], v11 offset:768
  ds_read_b128 v[172:175], v17 offset:0
  s_waitcnt lgkmcnt(3)
  v_mfma_f32_32x32x16_bf16 v[120:135], v[160:163], v[156:159], v[120:135]
  ds_read_b128 v[176:179], v11 offset:4864
  ds_read_b128 v[180:183], v11 offset:8960
  s_waitcnt lgkmcnt(4)
  v_mfma_f32_32x32x16_bf16 v[136:151], v[164:167], v[156:159], v[136:151]
  s_waitcnt lgkmcnt(2)
  v_mfma_f32_32x32x16_bf16 v[104:119], v[168:171], v[172:175], v[104:119]
  s_waitcnt lgkmcnt(0)
  s_barrier
  ds_read_b128 v[152:155], v11 offset:28672
  ds_read_b128 v[156:159], v14 offset:28672
  v_mfma_f32_32x32x16_bf16 v[120:135], v[176:179], v[172:175], v[120:135]
  ds_read_b128 v[160:163], v11 offset:32768
  ds_read_b128 v[164:167], v11 offset:36864
  v_mfma_f32_32x32x16_bf16 v[136:151], v[180:183], v[172:175], v[136:151]
  s_waitcnt lgkmcnt(2)
  v_mfma_f32_32x32x16_bf16 v[104:119], v[152:155], v[156:159], v[104:119]
  ds_read_b128 v[168:171], v11 offset:28928
  ds_read_b128 v[172:175], v15 offset:28672
  s_waitcnt lgkmcnt(3)
  v_mfma_f32_32x32x16_bf16 v[120:135], v[160:163], v[156:159], v[120:135]
  ds_read_b128 v[176:179], v11 offset:33024
  ds_read_b128 v[180:183], v11 offset:37120
  s_waitcnt lgkmcnt(4)
  v_mfma_f32_32x32x16_bf16 v[136:151], v[164:167], v[156:159], v[136:151]
  s_waitcnt lgkmcnt(2)
  v_mfma_f32_32x32x16_bf16 v[104:119], v[168:171], v[172:175], v[104:119]
  ds_read_b128 v[152:155], v11 offset:29184
  ds_read_b128 v[156:159], v16 offset:28672
  s_waitcnt lgkmcnt(3)
  v_mfma_f32_32x32x16_bf16 v[120:135], v[176:179], v[172:175], v[120:135]
  ds_read_b128 v[160:163], v11 offset:33280
  ds_read_b128 v[164:167], v11 offset:37376
  s_waitcnt lgkmcnt(4)
  v_mfma_f32_32x32x16_bf16 v[136:151], v[180:183], v[172:175], v[136:151]
  s_waitcnt lgkmcnt(2)
  v_mfma_f32_32x32x16_bf16 v[104:119], v[152:155], v[156:159], v[104:119]
  ds_read_b128 v[168:171], v11 offset:29440
  ds_read_b128 v[172:175], v17 offset:28672
  s_waitcnt lgkmcnt(3)
  v_mfma_f32_32x32x16_bf16 v[120:135], v[160:163], v[156:159], v[120:135]
  ds_read_b128 v[176:179], v11 offset:33536
  ds_read_b128 v[180:183], v11 offset:37632
  s_waitcnt lgkmcnt(4)
  v_mfma_f32_32x32x16_bf16 v[136:151], v[164:167], v[156:159], v[136:151]
  s_waitcnt lgkmcnt(2)
  v_mfma_f32_32x32x16_bf16 v[104:119], v[168:171], v[172:175], v[104:119]
  s_waitcnt lgkmcnt(0)
  s_barrier
  ds_read_b128 v[152:155], v12 offset:0
  ds_read_b128 v[156:159], v18 offset:0
  v_mfma_f32_32x32x16_bf16 v[120:135], v[176:179], v[172:175], v[120:135]
  ds_read_b128 v[160:163], v12 offset:4096
  ds_read_b128 v[164:167], v12 offset:8192
  v_mfma_f32_32x32x16_bf16 v[136:151], v[180:183], v[172:175], v[136:151]
  s_waitcnt lgkmcnt(2)
  v_mfma_f32_32x32x16_bf16 v[104:119], v[152:155], v[156:159], v[104:119]
  ds_read_b128 v[168:171], v12 offset:256
  ds_read_b128 v[172:175], v19 offset:0
  s_waitcnt lgkmcnt(3)
  v_mfma_f32_32x32x16_bf16 v[120:135], v[160:163], v[156:159], v[120:135]
  ds_read_b128 v[176:179], v12 offset:4352
  ds_read_b128 v[180:183], v12 offset:8448
  s_waitcnt lgkmcnt(4)
  v_mfma_f32_32x32x16_bf16 v[136:151], v[164:167], v[156:159], v[136:151]
  s_waitcnt lgkmcnt(2)
  v_mfma_f32_32x32x16_bf16 v[104:119], v[168:171], v[172:175], v[104:119]
  ds_read_b128 v[152:155], v12 offset:512
  ds_read_b128 v[156:159], v20 offset:0
  s_waitcnt lgkmcnt(3)
  v_mfma_f32_32x32x16_bf16 v[120:135], v[176:179], v[172:175], v[120:135]
  ds_read_b128 v[160:163], v12 offset:4608
  ds_read_b128 v[164:167], v12 offset:8704
  s_waitcnt lgkmcnt(4)
  v_mfma_f32_32x32x16_bf16 v[136:151], v[180:183], v[172:175], v[136:151]
  s_waitcnt lgkmcnt(2)
  v_mfma_f32_32x32x16_bf16 v[104:119], v[152:155], v[156:159], v[104:119]
  ds_read_b128 v[168:171], v12 offset:768
  ds_read_b128 v[172:175], v21 offset:0
  s_waitcnt lgkmcnt(3)
  v_mfma_f32_32x32x16_bf16 v[120:135], v[160:163], v[156:159], v[120:135]
  ds_read_b128 v[176:179], v12 offset:4864
  ds_read_b128 v[180:183], v12 offset:8960
  s_waitcnt lgkmcnt(4)
  v_mfma_f32_32x32x16_bf16 v[136:151], v[164:167], v[156:159], v[136:151]
  s_waitcnt lgkmcnt(2)
  v_mfma_f32_32x32x16_bf16 v[104:119], v[168:171], v[172:175], v[104:119]
  s_waitcnt lgkmcnt(0)
  s_barrier
  ds_read_b128 v[152:155], v12 offset:28672
  ds_read_b128 v[156:159], v18 offset:28672
  v_mfma_f32_32x32x16_bf16 v[120:135], v[176:179], v[172:175], v[120:135]
  ds_read_b128 v[160:163], v12 offset:32768
  ds_read_b128 v[164:167], v12 offset:36864
  v_mfma_f32_32x32x16_bf16 v[136:151], v[180:183], v[172:175], v[136:151]
  s_waitcnt lgkmcnt(2)
  v_mfma_f32_32x32x16_bf16 v[104:119], v[152:155], v[156:159], v[104:119]
  ds_read_b128 v[168:171], v12 offset:28928
  ds_read_b128 v[172:175], v19 offset:28672
  s_waitcnt lgkmcnt(3)
  v_mfma_f32_32x32x16_bf16 v[120:135], v[160:163], v[156:159], v[120:135]
  ds_read_b128 v[176:179], v12 offset:33024
  ds_read_b128 v[180:183], v12 offset:37120
  s_waitcnt lgkmcnt(4)
  v_mfma_f32_32x32x16_bf16 v[136:151], v[164:167], v[156:159], v[136:151]
  s_waitcnt lgkmcnt(2)
  v_mfma_f32_32x32x16_bf16 v[104:119], v[168:171], v[172:175], v[104:119]
  ds_read_b128 v[152:155], v12 offset:29184
  ds_read_b128 v[156:159], v20 offset:28672
  s_waitcnt lgkmcnt(3)
  v_mfma_f32_32x32x16_bf16 v[120:135], v[176:179], v[172:175], v[120:135]
  ds_read_b128 v[160:163], v12 offset:33280
  ds_read_b128 v[164:167], v12 offset:37376
  s_waitcnt lgkmcnt(4)
  v_mfma_f32_32x32x16_bf16 v[136:151], v[180:183], v[172:175], v[136:151]
  s_waitcnt lgkmcnt(2)
  v_mfma_f32_32x32x16_bf16 v[104:119], v[152:155], v[156:159], v[104:119]
  ds_read_b128 v[168:171], v12 offset:29440
  ds_read_b128 v[172:175], v21 offset:28672
  s_waitcnt lgkmcnt(3)
  v_mfma_f32_32x32x16_bf16 v[120:135], v[160:163], v[156:159], v[120:135]
  ds_read_b128 v[176:179], v12 offset:33536
  ds_read_b128 v[180:183], v12 offset:37632
  s_waitcnt lgkmcnt(4)
  v_mfma_f32_32x32x16_bf16 v[136:151], v[164:167], v[156:159], v[136:151]
  s_waitcnt lgkmcnt(2)
  v_mfma_f32_32x32x16_bf16 v[104:119], v[168:171], v[172:175], v[104:119]
  s_waitcnt lgkmcnt(0)
  s_barrier
  ds_read_b128 v[152:155], v13 offset:0
  ds_read_b128 v[156:159], v22 offset:0
  v_mfma_f32_32x32x16_bf16 v[120:135], v[176:179], v[172:175], v[120:135]
  ds_read_b128 v[160:163], v13 offset:4096
  ds_read_b128 v[164:167], v13 offset:8192
  v_mfma_f32_32x32x16_bf16 v[136:151], v[180:183], v[172:175], v[136:151]
  s_waitcnt lgkmcnt(2)
  v_mfma_f32_32x32x16_bf16 v[104:119], v[152:155], v[156:159], v[104:119]
  ds_read_b128 v[168:171], v13 offset:256
  ds_read_b128 v[172:175], v23 offset:0
  s_waitcnt lgkmcnt(3)
  v_mfma_f32_32x32x16_bf16 v[120:135], v[160:163], v[156:159], v[120:135]
  ds_read_b128 v[176:179], v13 offset:4352
  ds_read_b128 v[180:183], v13 offset:8448
  s_waitcnt lgkmcnt(4)
  v_mfma_f32_32x32x16_bf16 v[136:151], v[164:167], v[156:159], v[136:151]
  s_waitcnt lgkmcnt(2)
  v_mfma_f32_32x32x16_bf16 v[104:119], v[168:171], v[172:175], v[104:119]
  ds_read_b128 v[152:155], v13 offset:512
  ds_read_b128 v[156:159], v24 offset:0
  s_waitcnt lgkmcnt(3)
  v_mfma_f32_32x32x16_bf16 v[120:135], v[176:179], v[172:175], v[120:135]
  ds_read_b128 v[160:163], v13 offset:4608
  ds_read_b128 v[164:167], v13 offset:8704
  s_waitcnt lgkmcnt(4)
  v_mfma_f32_32x32x16_bf16 v[136:151], v[180:183], v[172:175], v[136:151]
  s_waitcnt lgkmcnt(2)
  v_mfma_f32_32x32x16_bf16 v[104:119], v[152:155], v[156:159], v[104:119]
  ds_read_b128 v[168:171], v13 offset:768
  ds_read_b128 v[172:175], v25 offset:0
  s_waitcnt lgkmcnt(3)
  v_mfma_f32_32x32x16_bf16 v[120:135], v[160:163], v[156:159], v[120:135]
  ds_read_b128 v[176:179], v13 offset:4864
  ds_read_b128 v[180:183], v13 offset:8960
  s_waitcnt lgkmcnt(4)
  v_mfma_f32_32x32x16_bf16 v[136:151], v[164:167], v[156:159], v[136:151]
  s_waitcnt lgkmcnt(2)
  v_mfma_f32_32x32x16_bf16 v[104:119], v[168:171], v[172:175], v[104:119]
  s_waitcnt lgkmcnt(0)
  s_barrier
  ds_read_b128 v[152:155], v11 offset:0
  ds_read_b128 v[156:159], v14 offset:0
  v_mfma_f32_32x32x16_bf16 v[120:135], v[176:179], v[172:175], v[120:135]
  ds_read_b128 v[160:163], v11 offset:4096
  ds_read_b128 v[164:167], v11 offset:8192
  v_mfma_f32_32x32x16_bf16 v[136:151], v[180:183], v[172:175], v[136:151]
  s_waitcnt lgkmcnt(2)
  v_mfma_f32_32x32x16_bf16 v[104:119], v[152:155], v[156:159], v[104:119]
  ds_read_b128 v[168:171], v11 offset:256
  ds_read_b128 v[172:175], v15 offset:0
  s_waitcnt lgkmcnt(3)
  v_mfma_f32_32x32x16_bf16 v[120:135], v[160:163], v[156:159], v[120:135]
  ds_read_b128 v[176:179], v11 offset:4352
  ds_read_b128 v[180:183], v11 offset:8448
  s_waitcnt lgkmcnt(4)
  v_mfma_f32_32x32x16_bf16 v[136:151], v[164:167], v[156:159], v[136:151]
  s_waitcnt lgkmcnt(2)
  v_mfma_f32_32x32x16_bf16 v[104:119], v[168:171], v[172:175], v[104:119]
  ds_read_b128 v[152:155], v11 offset:512
  ds_read_b128 v[156:159], v16 offset:0
  s_waitcnt lgkmcnt(3)
  v_mfma_f32_32x32x16_bf16 v[120:135], v[176:179], v[172:175], v[120:135]
  ds_read_b128 v[160:163], v11 offset:4608
  ds_read_b128 v[164:167], v11 offset:8704
  s_waitcnt lgkmcnt(4)
  v_mfma_f32_32x32x16_bf16 v[136:151], v[180:183], v[172:175], v[136:151]
  s_waitcnt lgkmcnt(2)
  v_mfma_f32_32x32x16_bf16 v[104:119], v[152:155], v[156:159], v[104:119]
  ds_read_b128 v[168:171], v11 offset:768
  ds_read_b128 v[172:175], v17 offset:0
  s_waitcnt lgkmcnt(3)
  v_mfma_f32_32x32x16_bf16 v[120:135], v[160:163], v[156:159], v[120:135]
  ds_read_b128 v[176:179], v11 offset:4864
  ds_read_b128 v[180:183], v11 offset:8960
  s_waitcnt lgkmcnt(4)
  v_mfma_f32_32x32x16_bf16 v[136:151], v[164:167], v[156:159], v[136:151]
  s_waitcnt lgkmcnt(2)
  v_mfma_f32_32x32x16_bf16 v[104:119], v[168:171], v[172:175], v[104:119]
  s_waitcnt lgkmcnt(0)
  s_barrier
  ds_read_b128 v[152:155], v11 offset:28672
  ds_read_b128 v[156:159], v14 offset:28672
  v_mfma_f32_32x32x16_bf16 v[120:135], v[176:179], v[172:175], v[120:135]
  ds_read_b128 v[160:163], v11 offset:32768
  ds_read_b128 v[164:167], v11 offset:36864
  v_mfma_f32_32x32x16_bf16 v[136:151], v[180:183], v[172:175], v[136:151]
  s_waitcnt lgkmcnt(2)
  v_mfma_f32_32x32x16_bf16 v[104:119], v[152:155], v[156:159], v[104:119]
  ds_read_b128 v[168:171], v11 offset:28928
  ds_read_b128 v[172:175], v15 offset:28672
  s_waitcnt lgkmcnt(3)
  v_mfma_f32_32x32x16_bf16 v[120:135], v[160:163], v[156:159], v[120:135]
  ds_read_b128 v[176:179], v11 offset:33024
  ds_read_b128 v[180:183], v11 offset:37120
  s_waitcnt lgkmcnt(4)
  v_mfma_f32_32x32x16_bf16 v[136:151], v[164:167], v[156:159], v[136:151]
  s_waitcnt lgkmcnt(2)
  v_mfma_f32_32x32x16_bf16 v[104:119], v[168:171], v[172:175], v[104:119]
  ds_read_b128 v[152:155], v11 offset:29184
  ds_read_b128 v[156:159], v16 offset:28672
  s_waitcnt lgkmcnt(3)
  v_mfma_f32_32x32x16_bf16 v[120:135], v[176:179], v[172:175], v[120:135]
  ds_read_b128 v[160:163], v11 offset:33280
  ds_read_b128 v[164:167], v11 offset:37376
  s_waitcnt lgkmcnt(4)
  v_mfma_f32_32x32x16_bf16 v[136:151], v[180:183], v[172:175], v[136:151]
  s_waitcnt lgkmcnt(2)
  v_mfma_f32_32x32x16_bf16 v[104:119], v[152:155], v[156:159], v[104:119]
  ds_read_b128 v[168:171], v11 offset:29440
  ds_read_b128 v[172:175], v17 offset:28672
  s_waitcnt lgkmcnt(3)
  v_mfma_f32_32x32x16_bf16 v[120:135], v[160:163], v[156:159], v[120:135]
  ds_read_b128 v[176:179], v11 offset:33536
  ds_read_b128 v[180:183], v11 offset:37632
  s_waitcnt lgkmcnt(4)
  v_mfma_f32_32x32x16_bf16 v[136:151], v[164:167], v[156:159], v[136:151]
  s_waitcnt lgkmcnt(2)
  v_mfma_f32_32x32x16_bf16 v[104:119], v[168:171], v[172:175], v[104:119]
  s_waitcnt lgkmcnt(0)
  s_barrier
  ds_read_b128 v[152:155], v12 offset:0
  ds_read_b128 v[156:159], v18 offset:0
  v_mfma_f32_32x32x16_bf16 v[120:135], v[176:179], v[172:175], v[120:135]
  ds_read_b128 v[160:163], v12 offset:4096
  ds_read_b128 v[164:167], v12 offset:8192
  v_mfma_f32_32x32x16_bf16 v[136:151], v[180:183], v[172:175], v[136:151]
  s_waitcnt lgkmcnt(2)
  v_mfma_f32_32x32x16_bf16 v[104:119], v[152:155], v[156:159], v[104:119]
  ds_read_b128 v[168:171], v12 offset:256
  ds_read_b128 v[172:175], v19 offset:0
  s_waitcnt lgkmcnt(3)
  v_mfma_f32_32x32x16_bf16 v[120:135], v[160:163], v[156:159], v[120:135]
  ds_read_b128 v[176:179], v12 offset:4352
  ds_read_b128 v[180:183], v12 offset:8448
  s_waitcnt lgkmcnt(4)
  v_mfma_f32_32x32x16_bf16 v[136:151], v[164:167], v[156:159], v[136:151]
  s_waitcnt lgkmcnt(2)
  v_mfma_f32_32x32x16_bf16 v[104:119], v[168:171], v[172:175], v[104:119]
  ds_read_b128 v[152:155], v12 offset:512
  ds_read_b128 v[156:159], v20 offset:0
  s_waitcnt lgkmcnt(3)
  v_mfma_f32_32x32x16_bf16 v[120:135], v[176:179], v[172:175], v[120:135]
  ds_read_b128 v[160:163], v12 offset:4608
  ds_read_b128 v[164:167], v12 offset:8704
  s_waitcnt lgkmcnt(4)
  v_mfma_f32_32x32x16_bf16 v[136:151], v[180:183], v[172:175], v[136:151]
  s_waitcnt lgkmcnt(2)
  v_mfma_f32_32x32x16_bf16 v[104:119], v[152:155], v[156:159], v[104:119]
  ds_read_b128 v[168:171], v12 offset:768
  ds_read_b128 v[172:175], v21 offset:0
  s_waitcnt lgkmcnt(3)
  v_mfma_f32_32x32x16_bf16 v[120:135], v[160:163], v[156:159], v[120:135]
  ds_read_b128 v[176:179], v12 offset:4864
  ds_read_b128 v[180:183], v12 offset:8960
  s_waitcnt lgkmcnt(4)
  v_mfma_f32_32x32x16_bf16 v[136:151], v[164:167], v[156:159], v[136:151]
  s_waitcnt lgkmcnt(2)
  v_mfma_f32_32x32x16_bf16 v[104:119], v[168:171], v[172:175], v[104:119]
  s_waitcnt lgkmcnt(1)
  v_mfma_f32_32x32x16_bf16 v[120:135], v[176:179], v[172:175], v[120:135]
  s_waitcnt lgkmcnt(0)
  v_mfma_f32_32x32x16_bf16 v[136:151], v[180:183], v[172:175], v[136:151]
  s_nop 7
  v_pk_add_f32 v[40:41], v[56:57], v[104:105] neg_lo:[0,1] neg_hi:[0,1]
  v_pk_add_f32 v[42:43], v[58:59], v[106:107] neg_lo:[0,1] neg_hi:[0,1]
  v_pk_add_f32 v[44:45], v[60:61], v[108:109] neg_lo:[0,1] neg_hi:[0,1]
  v_pk_add_f32 v[46:47], v[62:63], v[110:111] neg_lo:[0,1] neg_hi:[0,1]
  v_pk_add_f32 v[48:49], v[64:65], v[112:113] neg_lo:[0,1] neg_hi:[0,1]
  v_pk_add_f32 v[50:51], v[66:67], v[114:115] neg_lo:[0,1] neg_hi:[0,1]
  v_pk_add_f32 v[52:53], v[68:69], v[116:117] neg_lo:[0,1] neg_hi:[0,1]
  v_pk_add_f32 v[54:55], v[70:71], v[118:119] neg_lo:[0,1] neg_hi:[0,1]
  v_cvt_pk_bf16_f32 v28, v40, v41
  v_cvt_pk_bf16_f32 v29, v42, v43
  v_cvt_pk_bf16_f32 v30, v44, v45
  v_cvt_pk_bf16_f32 v31, v46, v47
  v_cvt_pk_bf16_f32 v32, v48, v49
  v_cvt_pk_bf16_f32 v33, v50, v51
  v_cvt_pk_bf16_f32 v34, v52, v53
  v_cvt_pk_bf16_f32 v35, v54, v55
  s_nop 1
  v_permlane32_swap_b32 v28, v30
  v_permlane32_swap_b32 v29, v31
  v_permlane32_swap_b32 v32, v34
  v_permlane32_swap_b32 v33, v35
  s_add_u32 s48, s44, 0
  buffer_store_dwordx4 v[28:31], v36, s[24:27], s48 offen sc1
  s_add_u32 s48, s44, 16384
  buffer_store_dwordx4 v[32:35], v36, s[24:27], s48 offen sc1
  s_nop 1
  v_pk_add_f32 v[40:41], v[56:57], v[104:105]
  v_pk_add_f32 v[42:43], v[58:59], v[106:107]
  v_pk_add_f32 v[44:45], v[60:61], v[108:109]
  v_pk_add_f32 v[46:47], v[62:63], v[110:111]
  v_pk_add_f32 v[48:49], v[64:65], v[112:113]
  v_pk_add_f32 v[50:51], v[66:67], v[114:115]
  v_pk_add_f32 v[52:53], v[68:69], v[116:117]
  v_pk_add_f32 v[54:55], v[70:71], v[118:119]
  v_cvt_pk_bf16_f32 v28, v40, v41
  v_cvt_pk_bf16_f32 v29, v42, v43
  v_cvt_pk_bf16_f32 v30, v44, v45
  v_cvt_pk_bf16_f32 v31, v46, v47
  v_cvt_pk_bf16_f32 v32, v48, v49
  v_cvt_pk_bf16_f32 v33, v50, v51
  v_cvt_pk_bf16_f32 v34, v52, v53
  v_cvt_pk_bf16_f32 v35, v54, v55
  s_nop 1
  v_permlane32_swap_b32 v28, v30
  v_permlane32_swap_b32 v29, v31
  v_permlane32_swap_b32 v32, v34
  v_permlane32_swap_b32 v33, v35
  s_add_u32 s48, s44, 786432
  buffer_store_dwordx4 v[28:31], v36, s[24:27], s48 offen sc1
  s_add_u32 s48, s44, 802816
  buffer_store_dwordx4 v[32:35], v36, s[24:27], s48 offen sc1
  s_nop 1
  v_pk_add_f32 v[40:41], v[72:73], v[120:121] neg_lo:[0,1] neg_hi:[0,1]
  v_pk_add_f32 v[42:43], v[74:75], v[122:123] neg_lo:[0,1] neg_hi:[0,1]
  v_pk_add_f32 v[44:45], v[76:77], v[124:125] neg_lo:[0,1] neg_hi:[0,1]
  v_pk_add_f32 v[46:47], v[78:79], v[126:127] neg_lo:[0,1] neg_hi:[0,1]
  v_pk_add_f32 v[48:49], v[80:81], v[128:129] neg_lo:[0,1] neg_hi:[0,1]
  v_pk_add_f32 v[50:51], v[82:83], v[130:131] neg_lo:[0,1] neg_hi:[0,1]
  v_pk_add_f32 v[52:53], v[84:85], v[132:133] neg_lo:[0,1] neg_hi:[0,1]
  v_pk_add_f32 v[54:55], v[86:87], v[134:135] neg_lo:[0,1] neg_hi:[0,1]
  v_cvt_pk_bf16_f32 v28, v40, v41
  v_cvt_pk_bf16_f32 v29, v42, v43
  v_cvt_pk_bf16_f32 v30, v44, v45
  v_cvt_pk_bf16_f32 v31, v46, v47
  v_cvt_pk_bf16_f32 v32, v48, v49
  v_cvt_pk_bf16_f32 v33, v50, v51
  v_cvt_pk_bf16_f32 v34, v52, v53
  v_cvt_pk_bf16_f32 v35, v54, v55
  s_nop 1
  v_permlane32_swap_b32 v28, v30
  v_permlane32_swap_b32 v29, v31
  v_permlane32_swap_b32 v32, v34
  v_permlane32_swap_b32 v33, v35
  s_add_u32 s48, s44, 32768
  buffer_store_dwordx4 v[28:31], v36, s[24:27], s48 offen sc1
  s_add_u32 s48, s44, 49152
  buffer_store_dwordx4 v[32:35], v36, s[24:27], s48 offen sc1
  s_nop 1
  v_pk_add_f32 v[40:41], v[72:73], v[120:121]
  v_pk_add_f32 v[42:43], v[74:75], v[122:123]
  v_pk_add_f32 v[44:45], v[76:77], v[124:125]
  v_pk_add_f32 v[46:47], v[78:79], v[126:127]
  v_pk_add_f32 v[48:49], v[80:81], v[128:129]
  v_pk_add_f32 v[50:51], v[82:83], v[130:131]
  v_pk_add_f32 v[52:53], v[84:85], v[132:133]
  v_pk_add_f32 v[54:55], v[86:87], v[134:135]
  v_cvt_pk_bf16_f32 v28, v40, v41
  v_cvt_pk_bf16_f32 v29, v42, v43
  v_cvt_pk_bf16_f32 v30, v44, v45
  v_cvt_pk_bf16_f32 v31, v46, v47
  v_cvt_pk_bf16_f32 v32, v48, v49
  v_cvt_pk_bf16_f32 v33, v50, v51
  v_cvt_pk_bf16_f32 v34, v52, v53
  v_cvt_pk_bf16_f32 v35, v54, v55
  s_nop 1
  v_permlane32_swap_b32 v28, v30
  v_permlane32_swap_b32 v29, v31
  v_permlane32_swap_b32 v32, v34
  v_permlane32_swap_b32 v33, v35
  s_add_u32 s48, s44, 819200
  buffer_store_dwordx4 v[28:31], v36, s[24:27], s48 offen sc1
  s_add_u32 s48, s44, 835584
  buffer_store_dwordx4 v[32:35], v36, s[24:27], s48 offen sc1
  s_nop 1
  v_pk_add_f32 v[40:41], v[88:89], v[136:137] neg_lo:[0,1] neg_hi:[0,1]
  v_pk_add_f32 v[42:43], v[90:91], v[138:139] neg_lo:[0,1] neg_hi:[0,1]
  v_pk_add_f32 v[44:45], v[92:93], v[140:141] neg_lo:[0,1] neg_hi:[0,1]
  v_pk_add_f32 v[46:47], v[94:95], v[142:143] neg_lo:[0,1] neg_hi:[0,1]
  v_pk_add_f32 v[48:49], v[96:97], v[144:145] neg_lo:[0,1] neg_hi:[0,1]
  v_pk_add_f32 v[50:51], v[98:99], v[146:147] neg_lo:[0,1] neg_hi:[0,1]
  v_pk_add_f32 v[52:53], v[100:101], v[148:149] neg_lo:[0,1] neg_hi:[0,1]
  v_pk_add_f32 v[54:55], v[102:103], v[150:151] neg_lo:[0,1] neg_hi:[0,1]
  v_cvt_pk_bf16_f32 v28, v40, v41
  v_cvt_pk_bf16_f32 v29, v42, v43
  v_cvt_pk_bf16_f32 v30, v44, v45
  v_cvt_pk_bf16_f32 v31, v46, v47
  v_cvt_pk_bf16_f32 v32, v48, v49
  v_cvt_pk_bf16_f32 v33, v50, v51
  v_cvt_pk_bf16_f32 v34, v52, v53
  v_cvt_pk_bf16_f32 v35, v54, v55
  s_nop 1
  v_permlane32_swap_b32 v28, v30
  v_permlane32_swap_b32 v29, v31
  v_permlane32_swap_b32 v32, v34
  v_permlane32_swap_b32 v33, v35
  s_add_u32 s48, s44, 65536
  buffer_store_dwordx4 v[28:31], v36, s[24:27], s48 offen sc1
  s_add_u32 s48, s44, 81920
  buffer_store_dwordx4 v[32:35], v36, s[24:27], s48 offen sc1
  s_nop 1
  v_pk_add_f32 v[40:41], v[88:89], v[136:137]
  v_pk_add_f32 v[42:43], v[90:91], v[138:139]
  v_pk_add_f32 v[44:45], v[92:93], v[140:141]
  v_pk_add_f32 v[46:47], v[94:95], v[142:143]
  v_pk_add_f32 v[48:49], v[96:97], v[144:145]
  v_pk_add_f32 v[50:51], v[98:99], v[146:147]
  v_pk_add_f32 v[52:53], v[100:101], v[148:149]
  v_pk_add_f32 v[54:55], v[102:103], v[150:151]
  v_cvt_pk_bf16_f32 v28, v40, v41
  v_cvt_pk_bf16_f32 v29, v42, v43
  v_cvt_pk_bf16_f32 v30, v44, v45
  v_cvt_pk_bf16_f32 v31, v46, v47
  v_cvt_pk_bf16_f32 v32, v48, v49
  v_cvt_pk_bf16_f32 v33, v50, v51
  v_cvt_pk_bf16_f32 v34, v52, v53
  v_cvt_pk_bf16_f32 v35, v54, v55
  s_nop 1
  v_permlane32_swap_b32 v28, v30
  v_permlane32_swap_b32 v29, v31
  v_permlane32_swap_b32 v32, v34
  v_permlane32_swap_b32 v33, v35
  s_add_u32 s48, s44, 851968
  buffer_store_dwordx4 v[28:31], v36, s[24:27], s48 offen sc1
  s_add_u32 s48, s44, 868352
  buffer_store_dwordx4 v[32:35], v36, s[24:27], s48 offen sc1
  s_nop 1
  s_add_u32 s64, s92, 33030144
  s_addc_u32 s65, s93, 0
  s_mov_b32 s66, 20480
  s_mov_b32 s67, 0x20000
  s_add_u32 s98, s94, 3
  v_mov_b32 v28, s98
  v_mov_b32 v29, 0x40000000
  v_cmp_gt_u32 vcc, 16, v0
  s_lshl_b32 s98, s2, 2
  v_mul_u32_u24 v30, 1280, v0
  v_cndmask_b32 v29, v29, v30, vcc
  v_readfirstlane_b32 s99, v0
  s_waitcnt vmcnt(0)
  s_barrier
  s_cmp_lg_u32 s99, 0
  s_cbranch_scc1 noflag_23
  buffer_store_dword v28, v29, s[64:67], s98 offen sc1
noflag_23:
  s_branch PH3
P2_d_ld:
  v_and_b32 v1, 63, v0
  v_bfe_u32 v2, v0, 6, 2
  s_nop 0
  v_readfirstlane_b32 s16, v2
  s_mul_i32 s21, s20, 1280
  v_mul_u32_u24 v3, 3, v2
  v_bfe_u32 v5, v3, 1, 1
  v_lshrrev_b32 v4, 3, v1
  v_xor_b32 v4, v4, v5
  v_and_b32 v5, 7, v1
  v_lshl_add_u32 v3, v3, 3, v5
  v_mul_u32_u24 v9, 5632, v4
  v_lshl_add_u32 v9, v3, 4, v9
  v_add_u32 v9, s21, v9
  v_mul_u32_u24 v3, 3, v2
  v_add_u32 v3, 1, v3
  v_bfe_u32 v5, v3, 1, 1
  v_lshrrev_b32 v4, 3, v1
  v_xor_b32 v4, v4, v5
  v_and_b32 v5, 7, v1
  v_lshl_add_u32 v3, v3, 3, v5
  v_mul_u32_u24 v10, 5632, v4
  v_lshl_add_u32 v10, v3, 4, v10
  v_add_u32 v10, s21, v10
  v_mul_u32_u24 v3, 3, v2
  v_add_u32 v3, 2, v3
  v_bfe_u32 v5, v3, 1, 1
  v_lshrrev_b32 v4, 3, v1
  v_xor_b32 v4, v4, v5
  v_and_b32 v5, 7, v1
  v_lshl_add_u32 v3, v3, 3, v5
  v_mul_u32_u24 v11, 5632, v4
  v_lshl_add_u32 v11, v3, 4, v11
  v_add_u32 v11, s21, v11
  s_lshl_b32 s22, s19, 8
  s_add_u32 s22, s22, s18
  s_lshl_b32 s22, s22, 12
  v_mul_u32_u24 v3, 32, v2
  v_lshrrev_b32 v4, 3, v1
  v_add3_u32 v3, v3, v4, 0
  v_bfe_u32 v4, v3, 1, 3
  v_and_b32 v8, 7, v1
  v_xor_b32 v4, v4, v8
  v_lshlrev_b32 v12, 13, v3
  v_lshl_add_u32 v12, v4, 4, v12
  v_add_u32 v12, s22, v12
  v_mul_u32_u24 v3, 32, v2
  v_lshrrev_b32 v4, 3, v1
  v_add3_u32 v3, v3, v4, 8
  v_bfe_u32 v4, v3, 1, 3
  v_and_b32 v8, 7, v1
  v_xor_b32 v4, v4, v8
  v_lshlrev_b32 v13, 13, v3
  v_lshl_add_u32 v13, v4, 4, v13
  v_add_u32 v13, s22, v13
  v_mul_u32_u24 v3, 32, v2
  v_lshrrev_b32 v4, 3, v1
  v_add3_u32 v3, v3, v4, 16
  v_bfe_u32 v4, v3, 1, 3
  v_and_b32 v8, 7, v1
  v_xor_b32 v4, v4, v8
  v_lshlrev_b32 v14, 13, v3
  v_lshl_add_u32 v14, v4, 4, v14
  v_add_u32 v14, s22, v14
  v_mul_u32_u24 v3, 32, v2
  v_lshrrev_b32 v4, 3, v1
  v_add3_u32 v3, v3, v4, 24
  v_bfe_u32 v4, v3, 1, 3
  v_and_b32 v8, 7, v1
  v_xor_b32 v4, v4, v8
  v_lshlrev_b32 v15, 13, v3
  v_lshl_add_u32 v15, v4, 4, v15
  v_add_u32 v15, s22, v15
  s_mul_i32 s34, s16, 3072
  s_mul_i32 s35, s16, 4096
  s_mov_b32 s56, 0
  s_mov_b32 s32, 0
  s_mov_b32 s33, 0
  s_waitcnt lgkmcnt(0)
  s_mul_i32 s48, s18, 524288
  s_add_u32 s48, s48, 5242880
  s_add_u32 s24, s6, s48
  s_addc_u32 s25, s7, 0
  s_mov_b32 s26, 382976
  s_mov_b32 s27, 0x20000
  s_add_u32 s48, s48, 1048576
  s_add_u32 s36, s6, s48
  s_addc_u32 s37, s7, 0
  s_mov_b32 s38, 382976
  s_mov_b32 s39, 0x20000
  s_mov_b32 s28, s8
  s_mov_b32 s29, s9
  s_mov_b32 s30, 8388608
  s_mov_b32 s31, 0x20000
  s_mov_b32 s40, s10
  s_mov_b32 s41, s11
  s_mov_b32 s42, 8388608
  s_mov_b32 s43, 0x20000
  v_and_b32 v16, 255, v0
  s_mov_b32 s97, 1
  s_cmp_lg_u32 s16, 0
  s_cbranch_scc1 pre_24
  s_add_u32 s64, s92, 33030144
  s_addc_u32 s65, s93, 0
  s_mov_b32 s66, 20480
  s_mov_b32 s67, 0x20000
  v_lshlrev_b32 v32, 4, v1
  s_and_b32 s98, s2, 15
  s_mul_i32 s98, s98, 1280
  v_add_u32 v32, s98, v32
  s_add_u32 s98, s94, 2
  s_mov_b32 s97, 0
pre_24:
  s_waitcnt vmcnt(0)
  s_barrier
  s_add_u32 m0, s35, 12288
  s_nop 0
  buffer_load_dwordx4 v12, s[28:31], s33 offen  lds
  s_add_u32 m0, s35, 13312
  s_nop 0
  buffer_load_dwordx4 v13, s[28:31], s33 offen  lds
  s_add_u32 m0, s35, 14336
  s_nop 0
  buffer_load_dwordx4 v14, s[28:31], s33 offen  lds
  s_add_u32 m0, s35, 15360
  s_nop 0
  buffer_load_dwordx4 v15, s[28:31], s33 offen  lds
  s_add_u32 s33, s33, 128
  s_add_u32 m0, s35, 40960
  s_nop 0
  buffer_load_dwordx4 v12, s[28:31], s33 offen  lds
  s_add_u32 m0, s35, 41984
  s_nop 0
  buffer_load_dwordx4 v13, s[28:31], s33 offen  lds
  s_add_u32 m0, s35, 43008
  s_nop 0
  buffer_load_dwordx4 v14, s[28:31], s33 offen  lds
  s_add_u32 m0, s35, 44032
  s_nop 0
  buffer_load_dwordx4 v15, s[28:31], s33 offen  lds
  s_add_u32 s33, s33, 128
  s_add_u32 m0, s35, 69632
  s_nop 0
  buffer_load_dwordx4 v12, s[28:31], s33 offen  lds
  s_add_u32 m0, s35, 70656
  s_nop 0
  buffer_load_dwordx4 v13, s[28:31], s33 offen  lds
  s_add_u32 m0, s35, 71680
  s_nop 0
  buffer_load_dwordx4 v14, s[28:31], s33 offen  lds
  s_add_u32 m0, s35, 72704
  s_nop 0
  buffer_load_dwordx4 v15, s[28:31], s33 offen  lds
  s_add_u32 s33, s33, 128
  s_add_u32 m0, s35, 98304
  s_nop 0
  buffer_load_dwordx4 v12, s[28:31], s33 offen  lds
  s_add_u32 m0, s35, 99328
  s_nop 0
  buffer_load_dwordx4 v13, s[28:31], s33 offen  lds
  s_add_u32 m0, s35, 100352
  s_nop 0
  buffer_load_dwordx4 v14, s[28:31], s33 offen  lds
  s_add_u32 m0, s35, 101376
  s_nop 0
  buffer_load_dwordx4 v15, s[28:31], s33 offen  lds
  s_add_u32 s33, s33, 128
  s_add_u32 m0, s35, 126976
  s_nop 0
  buffer_load_dwordx4 v12, s[28:31], s33 offen  lds
  s_add_u32 m0, s35, 128000
  s_nop 0
  buffer_load_dwordx4 v13, s[28:31], s33 offen  lds
  s_add_u32 m0, s35, 129024
  s_nop 0
  buffer_load_dwordx4 v14, s[28:31], s33 offen  lds
  s_add_u32 m0, s35, 130048
  s_nop 0
  buffer_load_dwordx4 v15, s[28:31], s33 offen  lds
  s_add_u32 s33, s33, 128
  s_cmp_eq_u32 s97, 1
  s_cbranch_scc1 pollskip_26
  s_mov_b32 s99, 0
poll_25:
  buffer_load_dwordx4 v[28:31], v32, s[64:67], 0 offen sc1
  s_waitcnt vmcnt(0)
  v_subrev_u32 v28, s98, v28
  v_subrev_u32 v29, s98, v29
  v_subrev_u32 v30, s98, v30
  v_subrev_u32 v31, s98, v31
  v_max_u32 v28, v28, v29
  v_max_u32 v30, v30, v31
  v_max_u32 v28, v28, v30
  v_cmp_ge_u32 vcc, 1, v28
  s_add_u32 s99, s99, 1
  s_cmp_eq_u64 vcc, exec
  s_cbranch_scc1 pollskip_26
  s_cmp_lt_u32 s99, 40000
  s_cbranch_scc1 poll_25
pollskip_26:
  s_barrier
  s_add_u32 m0, s34, 0
  s_nop 0
  buffer_load_dwordx4 v9, s[24:27], s32 offen sc1 lds
  s_add_u32 m0, s34, 1024
  s_nop 0
  buffer_load_dwordx4 v10, s[24:27], s32 offen sc1 lds
  s_add_u32 m0, s34, 2048
  s_nop 0
  buffer_load_dwordx4 v11, s[24:27], s32 offen sc1 lds
  s_add_u32 s32, s32, 45056
  s_add_u32 m0, s34, 28672
  s_nop 0
  buffer_load_dwordx4 v9, s[24:27], s32 offen sc1 lds
  s_add_u32 m0, s34, 29696
  s_nop 0
  buffer_load_dwordx4 v10, s[24:27], s32 offen sc1 lds
  s_add_u32 m0, s34, 30720
  s_nop 0
  buffer_load_dwordx4 v11, s[24:27], s32 offen sc1 lds
  s_add_u32 s32, s32, 45056
  s_waitcnt vmcnt(3)
  s_barrier
  s_add_u32 m0, s34, 57344
  s_nop 0
  buffer_load_dwordx4 v9, s[24:27], s32 offen sc1 lds
  s_add_u32 m0, s34, 58368
  s_nop 0
  buffer_load_dwordx4 v10, s[24:27], s32 offen sc1 lds
  s_add_u32 m0, s34, 59392
  s_nop 0
  buffer_load_dwordx4 v11, s[24:27], s32 offen sc1 lds
  s_add_u32 s32, s32, 45056
  s_add_u32 m0, s34, 86016
  s_nop 0
  buffer_load_dwordx4 v9, s[24:27], s32 offen sc1 lds
  s_add_u32 m0, s34, 87040
  s_nop 0
  buffer_load_dwordx4 v10, s[24:27], s32 offen sc1 lds
  s_add_u32 m0, s34, 88064
  s_nop 0
  buffer_load_dwordx4 v11, s[24:27], s32 offen sc1 lds
  s_add_u32 s32, s32, 45056
  s_add_u32 m0, s34, 114688
  s_nop 0
  buffer_load_dwordx4 v9, s[24:27], s32 offen sc1 lds
  s_add_u32 m0, s34, 115712
  s_nop 0
  buffer_load_dwordx4 v10, s[24:27], s32 offen sc1 lds
  s_add_u32 m0, s34, 116736
  s_nop 0
  buffer_load_dwordx4 v11, s[24:27], s32 offen sc1 lds
  s_add_u32 s32, s32, 45056
  s_waitcnt vmcnt(9)
  s_barrier
  s_add_u32 m0, s34, 0
  s_nop 0
  buffer_load_dwordx4 v9, s[24:27], s32 offen sc1 lds
  s_add_u32 m0, s34, 1024
  s_nop 0
  buffer_load_dwordx4 v10, s[24:27], s32 offen sc1 lds
  s_add_u32 m0, s34, 2048
  s_nop 0
  buffer_load_dwordx4 v11, s[24:27], s32 offen sc1 lds
  s_add_u32 s32, s32, 45056
  s_add_u32 m0, s35, 12288
  s_nop 0
  buffer_load_dwordx4 v12, s[28:31], s33 offen  lds
  s_add_u32 m0, s35, 13312
  s_nop 0
  buffer_load_dwordx4 v13, s[28:31], s33 offen  lds
  s_add_u32 m0, s35, 14336
  s_nop 0
  buffer_load_dwordx4 v14, s[28:31], s33 offen  lds
  s_add_u32 m0, s35, 15360
  s_nop 0
  buffer_load_dwordx4 v15, s[28:31], s33 offen  lds
  s_add_u32 s33, s33, 128
  s_waitcnt vmcnt(13)
  s_barrier
  s_add_u32 m0, s34, 28672
  s_nop 0
  buffer_load_dwordx4 v9, s[24:27], s32 offen sc1 lds
  s_add_u32 m0, s34, 29696
  s_nop 0
  buffer_load_dwordx4 v10, s[24:27], s32 offen sc1 lds
  s_add_u32 m0, s34, 30720
  s_nop 0
  buffer_load_dwordx4 v11, s[24:27], s32 offen sc1 lds
  s_add_u32 s32, s32, 45056
  s_add_u32 m0, s35, 40960
  s_nop 0
  buffer_load_dwordx4 v12, s[28:31], s33 offen  lds
  s_add_u32 m0, s35, 41984
  s_nop 0
  buffer_load_dwordx4 v13, s[28:31], s33 offen  lds
  s_add_u32 m0, s35, 43008
  s_nop 0
  buffer_load_dwordx4 v14, s[28:31], s33 offen  lds
  s_add_u32 m0, s35, 44032
  s_nop 0
  buffer_load_dwordx4 v15, s[28:31], s33 offen  lds
  s_add_u32 s33, s33, 128
  s_waitcnt vmcnt(17)
  s_barrier
  s_add_u32 m0, s34, 57344
  s_nop 0
  buffer_load_dwordx4 v9, s[24:27], s32 offen sc1 lds
  s_add_u32 m0, s34, 58368
  s_nop 0
  buffer_load_dwordx4 v10, s[24:27], s32 offen sc1 lds
  s_add_u32 m0, s34, 59392
  s_nop 0
  buffer_load_dwordx4 v11, s[24:27], s32 offen sc1 lds
  s_add_u32 s32, s32, 45056
  s_add_u32 m0, s35, 69632
  s_nop 0
  buffer_load_dwordx4 v12, s[28:31], s33 offen  lds
  s_add_u32 m0, s35, 70656
  s_nop 0
  buffer_load_dwordx4 v13, s[28:31], s33 offen  lds
  s_add_u32 m0, s35, 71680
  s_nop 0
  buffer_load_dwordx4 v14, s[28:31], s33 offen  lds
  s_add_u32 m0, s35, 72704
  s_nop 0
  buffer_load_dwordx4 v15, s[28:31], s33 offen  lds
  s_add_u32 s33, s33, 128
  s_waitcnt vmcnt(21)
  s_barrier
  s_add_u32 m0, s34, 86016
  s_nop 0
  buffer_load_dwordx4 v9, s[24:27], s32 offen sc1 lds
  s_add_u32 m0, s34, 87040
  s_nop 0
  buffer_load_dwordx4 v10, s[24:27], s32 offen sc1 lds
  s_add_u32 m0, s34, 88064
  s_nop 0
  buffer_load_dwordx4 v11, s[24:27], s32 offen sc1 lds
  s_sub_u32 s32, s32, 360448
  s_add_u32 m0, s35, 98304
  s_nop 0
  buffer_load_dwordx4 v12, s[28:31], s33 offen  lds
  s_add_u32 m0, s35, 99328
  s_nop 0
  buffer_load_dwordx4 v13, s[28:31], s33 offen  lds
  s_add_u32 m0, s35, 100352
  s_nop 0
  buffer_load_dwordx4 v14, s[28:31], s33 offen  lds
  s_add_u32 m0, s35, 101376
  s_nop 0
  buffer_load_dwordx4 v15, s[28:31], s33 offen  lds
  s_sub_u32 s33, s33, 1024
  s_waitcnt vmcnt(21)
  s_barrier
  s_add_u32 m0, s34, 114688
  s_nop 0
  buffer_load_dwordx4 v9, s[36:39], s32 offen sc1 lds
  s_add_u32 m0, s34, 115712
  s_nop 0
  buffer_load_dwordx4 v10, s[36:39], s32 offen sc1 lds
  s_add_u32 m0, s34, 116736
  s_nop 0
  buffer_load_dwordx4 v11, s[36:39], s32 offen sc1 lds
  s_add_u32 s32, s32, 45056
  s_add_u32 m0, s35, 126976
  s_nop 0
  buffer_load_dwordx4 v12, s[40:43], s33 offen  lds
  s_add_u32 m0, s35, 128000
  s_nop 0
  buffer_load_dwordx4 v13, s[40:43], s33 offen  lds
  s_add_u32 m0, s35, 129024
  s_nop 0
  buffer_load_dwordx4 v14, s[40:43], s33 offen  lds
  s_add_u32 m0, s35, 130048
  s_nop 0
  buffer_load_dwordx4 v15, s[40:43], s33 offen  lds
  s_add_u32 s33, s33, 128
  s_waitcnt vmcnt(21)
  s_barrier
  s_add_u32 m0, s34, 0
  s_nop 0
  buffer_load_dwordx4 v9, s[36:39], s32 offen sc1 lds
  s_add_u32 m0, s34, 1024
  s_nop 0
  buffer_load_dwordx4 v10, s[36:39], s32 offen sc1 lds
  s_add_u32 m0, s34, 2048
  s_nop 0
  buffer_load_dwordx4 v11, s[36:39], s32 offen sc1 lds
  s_add_u32 s32, s32, 45056
  s_add_u32 m0, s35, 12288
  s_nop 0
  buffer_load_dwordx4 v12, s[40:43], s33 offen  lds
  s_add_u32 m0, s35, 13312
  s_nop 0
  buffer_load_dwordx4 v13, s[40:43], s33 offen  lds
  s_add_u32 m0, s35, 14336
  s_nop 0
  buffer_load_dwordx4 v14, s[40:43], s33 offen  lds
  s_add_u32 m0, s35, 15360
  s_nop 0
  buffer_load_dwordx4 v15, s[40:43], s33 offen  lds
  s_add_u32 s33, s33, 128
  s_waitcnt vmcnt(21)
  s_barrier
  s_add_u32 m0, s34, 28672
  s_nop 0
  buffer_load_dwordx4 v9, s[36:39], s32 offen sc1 lds
  s_add_u32 m0, s34, 29696
  s_nop 0
  buffer_load_dwordx4 v10, s[36:39], s32 offen sc1 lds
  s_add_u32 m0, s34, 30720
  s_nop 0
  buffer_load_dwordx4 v11, s[36:39], s32 offen sc1 lds
  s_add_u32 s32, s32, 45056
  s_add_u32 m0, s35, 40960
  s_nop 0
  buffer_load_dwordx4 v12, s[40:43], s33 offen  lds
  s_add_u32 m0, s35, 41984
  s_nop 0
  buffer_load_dwordx4 v13, s[40:43], s33 offen  lds
  s_add_u32 m0, s35, 43008
  s_nop 0
  buffer_load_dwordx4 v14, s[40:43], s33 offen  lds
  s_add_u32 m0, s35, 44032
  s_nop 0
  buffer_load_dwordx4 v15, s[40:43], s33 offen  lds
  s_add_u32 s33, s33, 128
  s_waitcnt vmcnt(21)
  s_barrier
  s_add_u32 m0, s34, 57344
  s_nop 0
  buffer_load_dwordx4 v9, s[36:39], s32 offen sc1 lds
  s_add_u32 m0, s34, 58368
  s_nop 0
  buffer_load_dwordx4 v10, s[36:39], s32 offen sc1 lds
  s_add_u32 m0, s34, 59392
  s_nop 0
  buffer_load_dwordx4 v11, s[36:39], s32 offen sc1 lds
  s_add_u32 s32, s32, 45056
  s_add_u32 m0, s35, 69632
  s_nop 0
  buffer_load_dwordx4 v12, s[40:43], s33 offen  lds
  s_add_u32 m0, s35, 70656
  s_nop 0
  buffer_load_dwordx4 v13, s[40:43], s33 offen  lds
  s_add_u32 m0, s35, 71680
  s_nop 0
  buffer_load_dwordx4 v14, s[40:43], s33 offen  lds
  s_add_u32 m0, s35, 72704
  s_nop 0
  buffer_load_dwordx4 v15, s[40:43], s33 offen  lds
  s_add_u32 s33, s33, 128
  s_waitcnt vmcnt(21)
  s_barrier
  s_add_u32 m0, s34, 86016
  s_nop 0
  buffer_load_dwordx4 v9, s[36:39], s32 offen sc1 lds
  s_add_u32 m0, s34, 87040
  s_nop 0
  buffer_load_dwordx4 v10, s[36:39], s32 offen sc1 lds
  s_add_u32 m0, s34, 88064
  s_nop 0
  buffer_load_dwordx4 v11, s[36:39], s32 offen sc1 lds
  s_add_u32 s32, s32, 45056
  s_add_u32 m0, s35, 98304
  s_nop 0
  buffer_load_dwordx4 v12, s[40:43], s33 offen  lds
  s_add_u32 m0, s35, 99328
  s_nop 0
  buffer_load_dwordx4 v13, s[40:43], s33 offen  lds
  s_add_u32 m0, s35, 100352
  s_nop 0
  buffer_load_dwordx4 v14, s[40:43], s33 offen  lds
  s_add_u32 m0, s35, 101376
  s_nop 0
  buffer_load_dwordx4 v15, s[40:43], s33 offen  lds
  s_add_u32 s33, s33, 128
  s_waitcnt vmcnt(21)
  s_barrier
  s_add_u32 m0, s34, 114688
  s_nop 0
  buffer_load_dwordx4 v9, s[36:39], s32 offen sc1 lds
  s_add_u32 m0, s34, 115712
  s_nop 0
  buffer_load_dwordx4 v10, s[36:39], s32 offen sc1 lds
  s_add_u32 m0, s34, 116736
  s_nop 0
  buffer_load_dwordx4 v11, s[36:39], s32 offen sc1 lds
  s_add_u32 s32, s32, 45056
  s_add_u32 m0, s35, 126976
  s_nop 0
  buffer_load_dwordx4 v12, s[40:43], s33 offen  lds
  s_add_u32 m0, s35, 128000
  s_nop 0
  buffer_load_dwordx4 v13, s[40:43], s33 offen  lds
  s_add_u32 m0, s35, 129024
  s_nop 0
  buffer_load_dwordx4 v14, s[40:43], s33 offen  lds
  s_add_u32 m0, s35, 130048
  s_nop 0
  buffer_load_dwordx4 v15, s[40:43], s33 offen  lds
  s_add_u32 s33, s33, 128
  s_waitcnt vmcnt(21)
  s_barrier
  s_add_u32 m0, s34, 0
  s_nop 0
  buffer_load_dwordx4 v9, s[36:39], s32 offen sc1 lds
  s_add_u32 m0, s34, 1024
  s_nop 0
  buffer_load_dwordx4 v10, s[36:39], s32 offen sc1 lds
  s_add_u32 m0, s34, 2048
  s_nop 0
  buffer_load_dwordx4 v11, s[36:39], s32 offen sc1 lds
  s_add_u32 s32, s32, 45056
  s_add_u32 m0, s35, 12288
  s_nop 0
  buffer_load_dwordx4 v12, s[40:43], s33 offen  lds
  s_add_u32 m0, s35, 13312
  s_nop 0
  buffer_load_dwordx4 v13, s[40:43], s33 offen  lds
  s_add_u32 m0, s35, 14336
  s_nop 0
  buffer_load_dwordx4 v14, s[40:43], s33 offen  lds
  s_add_u32 m0, s35, 15360
  s_nop 0
  buffer_load_dwordx4 v15, s[40:43], s33 offen  lds
  s_add_u32 s33, s33, 128
  s_waitcnt vmcnt(21)
  s_barrier
  s_add_u32 m0, s34, 28672
  s_nop 0
  buffer_load_dwordx4 v9, s[36:39], s32 offen sc1 lds
  s_add_u32 m0, s34, 29696
  s_nop 0
  buffer_load_dwordx4 v10, s[36:39], s32 offen sc1 lds
  s_add_u32 m0, s34, 30720
  s_nop 0
  buffer_load_dwordx4 v11, s[36:39], s32 offen sc1 lds
  s_add_u32 s32, s32, 45056
  s_add_u32 m0, s35, 40960
  s_nop 0
  buffer_load_dwordx4 v12, s[40:43], s33 offen  lds
  s_add_u32 m0, s35, 41984
  s_nop 0
  buffer_load_dwordx4 v13, s[40:43], s33 offen  lds
  s_add_u32 m0, s35, 43008
  s_nop 0
  buffer_load_dwordx4 v14, s[40:43], s33 offen  lds
  s_add_u32 m0, s35, 44032
  s_nop 0
  buffer_load_dwordx4 v15, s[40:43], s33 offen  lds
  s_add_u32 s33, s33, 128
  s_waitcnt vmcnt(21)
  s_barrier
  s_add_u32 m0, s34, 57344
  s_nop 0
  buffer_load_dwordx4 v9, s[36:39], s32 offen sc1 lds
  s_add_u32 m0, s34, 58368
  s_nop 0
  buffer_load_dwordx4 v10, s[36:39], s32 offen sc1 lds
  s_add_u32 m0, s34, 59392
  s_nop 0
  buffer_load_dwordx4 v11, s[36:39], s32 offen sc1 lds
  s_add_u32 s32, s32, 45056
  s_add_u32 m0, s35, 69632
  s_nop 0
  buffer_load_dwordx4 v12, s[40:43], s33 offen  lds
  s_add_u32 m0, s35, 70656
  s_nop 0
  buffer_load_dwordx4 v13, s[40:43], s33 offen  lds
  s_add_u32 m0, s35, 71680
  s_nop 0
  buffer_load_dwordx4 v14, s[40:43], s33 offen  lds
  s_add_u32 m0, s35, 72704
  s_nop 0
  buffer_load_dwordx4 v15, s[40:43], s33 offen  lds
  s_add_u32 s33, s33, 128
  s_waitcnt vmcnt(21)
  s_barrier
  s_waitcnt vmcnt(14)
  s_barrier
  s_waitcnt vmcnt(7)
  s_barrier
  s_waitcnt vmcnt(0)
  s_barrier
  s_cmp_lg_u32 s17, 0
  s_cbranch_scc1 P2_fin
  s_add_u32 s28, s6, 31457280
  s_addc_u32 s29, s7, 0
  s_mov_b32 s30, 15488
  s_mov_b32 s31, 0x20000
  v_add_u32 v3, 0, v16
  v_lshlrev_b32 v3, 2, v3
  s_mov_b32 s48, 0
  buffer_load_dword v18, v3, s[28:31], s48 offen sc1
  s_mov_b32 s48, 1408
  buffer_load_dword v19, v3, s[28:31], s48 offen sc1
  s_mov_b32 s48, 2816
  buffer_load_dword v20, v3, s[28:31], s48 offen sc1
  s_mov_b32 s48, 4224
  buffer_load_dword v21, v3, s[28:31], s48 offen sc1
  s_mov_b32 s48, 5632
  buffer_load_dword v22, v3, s[28:31], s48 offen sc1
  s_mov_b32 s48, 7040
  buffer_load_dword v23, v3, s[28:31], s48 offen sc1
  s_mov_b32 s48, 8448
  buffer_load_dword v24, v3, s[28:31], s48 offen sc1
  s_mov_b32 s48, 9856
  buffer_load_dword v25, v3, s[28:31], s48 offen sc1
  s_waitcnt vmcnt(0)
  v_add_f32 v18, v18, v19
  v_add_f32 v18, v18, v20
  v_add_f32 v18, v18, v21
  v_add_f32 v18, v18, v22
  v_add_f32 v18, v18, v23
  v_add_f32 v18, v18, v24
  v_add_f32 v18, v18, v25
  s_mov_b32 s48, 14080
  buffer_store_dword v18, v3, s[28:31], s48 offen sc1
  s_nop 1
  v_add_u32 v3, 256, v16
  v_lshlrev_b32 v3, 2, v3
  v_cmp_le_u32 vcc, 1408, v3
  s_nop 1
  v_mov_b32 v4, 0x40000000
  v_cndmask_b32 v3, v3, v4, vcc
  s_mov_b32 s48, 0
  buffer_load_dword v18, v3, s[28:31], s48 offen sc1
  s_mov_b32 s48, 1408
  buffer_load_dword v19, v3, s[28:31], s48 offen sc1
  s_mov_b32 s48, 2816
  buffer_load_dword v20, v3, s[28:31], s48 offen sc1
  s_mov_b32 s48, 4224
  buffer_load_dword v21, v3, s[28:31], s48 offen sc1
  s_mov_b32 s48, 5632
  buffer_load_dword v22, v3, s[28:31], s48 offen sc1
  s_mov_b32 s48, 7040
  buffer_load_dword v23, v3, s[28:31], s48 offen sc1
  s_mov_b32 s48, 8448
  buffer_load_dword v24, v3, s[28:31], s48 offen sc1
  s_mov_b32 s48, 9856
  buffer_load_dword v25, v3, s[28:31], s48 offen sc1
  s_waitcnt vmcnt(0)
  v_add_f32 v18, v18, v19
  v_add_f32 v18, v18, v20
  v_add_f32 v18, v18, v21
  v_add_f32 v18, v18, v22
  v_add_f32 v18, v18, v23
  v_add_f32 v18, v18, v24
  v_add_f32 v18, v18, v25
  s_mov_b32 s48, 14080
  buffer_store_dword v18, v3, s[28:31], s48 offen sc1
  s_nop 1
  s_waitcnt vmcnt(0)
P2_fin:
  s_branch PH3
PH3:
  s_mov_b32 s4, s68
  s_mov_b32 s5, s69
  s_mov_b32 s6, s92
  s_mov_b32 s7, s93
  s_mov_b32 s8, s88
  s_mov_b32 s9, s89
  s_and_b32 s14, s2, 7
  s_lshr_b32 s15, s2, 3
  s_lshl_b32 s17, s14, 2
  s_lshr_b32 s18, s15, 3
  s_add_u32 s17, s17, s18
  s_and_b32 s18, s15, 7
  v_readfirstlane_b32 s98, v0
  s_nop 3
  s_cmp_ge_u32 s98, 256
  s_cbranch_scc1 P3_ld
  v_and_b32 v1, 63, v0
  v_bfe_u32 v2, v0, 6, 2
  s_nop 0
  v_readfirstlane_b32 s16, v2
  v_mov_b32 v11, 0x40000000
  v_mov_b32 v9, 0
  v_lshrrev_b32 v10, 1, v2
  v_lshlrev_b32 v10, 5, v10
  v_and_b32 v3, 15, v1
  v_add_u32 v3, v3, v9
  v_lshrrev_b32 v4, 3, v3
  v_lshlrev_b32 v4, 10, v4
  v_and_b32 v5, 7, v3
  v_lshl_add_u32 v4, v5, 4, v4
  v_lshrrev_b32 v6, 4, v1
  v_lshl_add_u32 v4, v6, 7, v4
  v_add_u32 v76, 102400, v4
  v_add_u32 v77, 49152, v4
  v_and_b32 v3, 15, v1
  v_add_u32 v3, v3, v10
  v_lshrrev_b32 v4, 3, v3
  v_lshlrev_b32 v4, 10, v4
  v_and_b32 v5, 7, v3
  v_lshl_add_u32 v4, v5, 4, v4
  v_bfe_u32 v5, v3, 4, 1
  v_lshrrev_b32 v6, 4, v1
  v_xor_b32 v5, v5, v6
  v_lshl_add_u32 v4, v5, 7, v4
  v_add_u32 v78, 0, v4
  v_xor_b32 v79, 128, v78
  v_and_b32 v3, 15, v1
  v_add_u32 v3, v3, v10
  v_lshrrev_b32 v4, 3, v3
  v_lshlrev_b32 v4, 10, v4
  v_and_b32 v5, 7, v3
  v_lshl_add_u32 v4, v5, 4, v4
  v_bfe_u32 v5, v3, 4, 1
  v_lshrrev_b32 v6, 4, v1
  v_xor_b32 v5, v5, v6
  v_lshl_add_u32 v4, v5, 7, v4
  v_add_u32 v80, 8192, v4
  v_xor_b32 v81, 128, v80
  v_and_b32 v82, 1, v2
  v_lshlrev_b32 v82, 9, v82
  v_add_u32 v76, v76, v82
  v_add_u32 v77, v77, v82
  v_add_u32 v78, v78, v82
  v_add_u32 v79, v79, v82
  v_add_u32 v80, v80, v82
  v_add_u32 v81, v81, v82
  s_waitcnt lgkmcnt(0)
  s_mov_b32 s40, s4
  s_mov_b32 s41, s5
  s_mov_b32 s42, 2621440
  s_mov_b32 s43, 0x20000
  s_mov_b32 s44, s8
  s_mov_b32 s45, s9
  s_mov_b32 s46, 2621440
  s_mov_b32 s47, 0x20000
  s_add_u32 s48, s6, 27262976
  s_addc_u32 s49, s7, 0
  s_mov_b32 s50, 1572864
  s_mov_b32 s51, 0x20000
  s_add_u32 s52, s6, 31457280
  s_addc_u32 s53, s7, 0
  s_mov_b32 s54, 15488
  s_mov_b32 s55, 0x20000
  s_mov_b32 s57, 14080
  v_add_u32 v3, 0, v0
  v_mul_u32_u24 v4, 6554, v3
  v_lshrrev_b32 v4, 16, v4
  v_mul_u32_u24 v5, 10, v4
  v_sub_u32 v5, v3, v5
  v_mul_u32_u24 v51, 336, v4
  v_lshl_add_u32 v51, v5, 5, v51
  v_cmp_eq_u32 vcc, 9, v5
  v_cmp_eq_u32 s[60:61], 63, v1
  s_or_b64 vcc, vcc, s[60:61]
  s_nop 1
  v_cndmask_b32 v63, 0, 1, vcc
  s_lshl_b32 s56, s17, 6
  v_add_u32 v57, s56, v4
  s_mul_i32 s56, s18, 10
  v_add_u32 v5, s56, v5
  v_mul_u32_u24 v48, 1280, v57
  v_lshl_add_u32 v48, v5, 4, v48
  v_sub_u32 v6, 2048, v57
  v_cmp_lt_u32 vcc, 1024, v57
  s_nop 1
  v_cndmask_b32 v6, v57, v6, vcc
  v_cndmask_b32 v7, 0, 1, vcc
  v_cmp_le_u32 vcc, 40, v5
  s_nop 1
  v_cndmask_b32 v54, 0, 1, vcc
  v_sub_u32 v8, 80, v5
  v_cndmask_b32 v5, v5, v8, vcc
  v_xor_b32 v7, v7, v54
  v_and_b32 v8, 1, v6
  v_lshl_add_u32 v7, v7, 1, v8
  v_mul_u32_u24 v7, 393216, v7
  v_lshl_add_u32 v7, v5, 13, v7
  v_lshrrev_b32 v6, 1, v6
  v_lshl_add_u32 v7, v6, 4, v7
  v_mov_b32 v60, v7
  v_add_u32 v3, 256, v0
  v_mul_u32_u24 v4, 6554, v3
  v_lshrrev_b32 v4, 16, v4
  v_mul_u32_u24 v5, 10, v4
  v_sub_u32 v5, v3, v5
  v_mul_u32_u24 v52, 336, v4
  v_lshl_add_u32 v52, v5, 5, v52
  v_cmp_eq_u32 vcc, 9, v5
  v_cmp_eq_u32 s[60:61], 63, v1
  s_or_b64 vcc, vcc, s[60:61]
  s_nop 1
  v_cndmask_b32 v64, 0, 1, vcc
  s_lshl_b32 s56, s17, 6
  v_add_u32 v58, s56, v4
  s_mul_i32 s56, s18, 10
  v_add_u32 v5, s56, v5
  v_mul_u32_u24 v49, 1280, v58
  v_lshl_add_u32 v49, v5, 4, v49
  v_sub_u32 v6, 2048, v58
  v_cmp_lt_u32 vcc, 1024, v58
  s_nop 1
  v_cndmask_b32 v6, v58, v6, vcc
  v_cndmask_b32 v7, 0, 1, vcc
  v_cmp_le_u32 vcc, 40, v5
  s_nop 1
  v_cndmask_b32 v55, 0, 1, vcc
  v_sub_u32 v8, 80, v5
  v_cndmask_b32 v5, v5, v8, vcc
  v_xor_b32 v7, v7, v55
  v_and_b32 v8, 1, v6
  v_lshl_add_u32 v7, v7, 1, v8
  v_mul_u32_u24 v7, 393216, v7
  v_lshl_add_u32 v7, v5, 13, v7
  v_lshrrev_b32 v6, 1, v6
  v_lshl_add_u32 v7, v6, 4, v7
  v_mov_b32 v61, v7
  v_add_u32 v3, 512, v0
  v_mul_u32_u24 v4, 6554, v3
  v_lshrrev_b32 v4, 16, v4
  v_mul_u32_u24 v5, 10, v4
  v_sub_u32 v5, v3, v5
  v_mul_u32_u24 v53, 336, v4
  v_lshl_add_u32 v53, v5, 5, v53
  v_cmp_eq_u32 vcc, 9, v5
  v_cmp_eq_u32 s[60:61], 63, v1
  s_or_b64 vcc, vcc, s[60:61]
  s_nop 1
  v_cndmask_b32 v65, 0, 1, vcc
  s_lshl_b32 s56, s17, 6
  v_add_u32 v59, s56, v4
  s_mul_i32 s56, s18, 10
  v_add_u32 v5, s56, v5
  v_mul_u32_u24 v50, 1280, v59
  v_lshl_add_u32 v50, v5, 4, v50
  v_cmp_le_u32 vcc, 640, v3
  s_nop 1
  v_cndmask_b32 v50, v50, v11, vcc
  v_sub_u32 v6, 2048, v59
  v_cmp_lt_u32 vcc, 1024, v59
  s_nop 1
  v_cndmask_b32 v6, v59, v6, vcc
  v_cndmask_b32 v7, 0, 1, vcc
  v_cmp_le_u32 vcc, 40, v5
  s_nop 1
  v_cndmask_b32 v56, 0, 1, vcc
  v_sub_u32 v8, 80, v5
  v_cndmask_b32 v5, v5, v8, vcc
  v_xor_b32 v7, v7, v56
  v_and_b32 v8, 1, v6
  v_lshl_add_u32 v7, v7, 1, v8
  v_mul_u32_u24 v7, 393216, v7
  v_lshl_add_u32 v7, v5, 13, v7
  v_lshrrev_b32 v6, 1, v6
  v_lshl_add_u32 v7, v6, 4, v7
  v_mov_b32 v62, v7
  v_mov_b32 v68, 0
  v_mov_b32 v69, 0
  v_mov_b32 v70, 0
  v_mov_b32 v71, 0
  v_mov_b32 v72, 0
  v_mov_b32 v73, 0
  v_mov_b32 v74, 0
  v_mov_b32 v75, 0
  v_mov_b32 v24, 0
  v_mov_b32 v25, 0
  v_mov_b32 v26, 0
  v_mov_b32 v27, 0
  v_mov_b32 v28, 0
  v_mov_b32 v29, 0
  v_mov_b32 v30, 0
  v_mov_b32 v31, 0
  v_mov_b32 v32, 0
  v_mov_b32 v33, 0
  v_mov_b32 v34, 0
  v_mov_b32 v35, 0
  s_mov_b32 s58, 0x07060100
  s_movk_i32 s59, 1024
  s_barrier
  s_barrier
  ds_read_b128 v[160:163], v76 offset:0
  ds_read_b128 v[164:167], v78 offset:0
  ds_read_b128 v[168:171], v79 offset:2048
  ds_read_b128 v[172:175], v76 offset:2048
  ds_read_b128 v[176:179], v76 offset:4096
  ds_read_b128 v[180:183], v76 offset:6144
  ds_read_b128 v[184:187], v76 offset:8192
  ds_read_b128 v[188:191], v80 offset:0
  ds_read_b128 v[192:195], v81 offset:2048
  s_waitcnt lgkmcnt(7)
  v_mfma_f32_16x16x32_bf16 v[84:87], v[160:163], v[164:167], 0
  s_waitcnt lgkmcnt(6)
  v_mfma_f32_16x16x32_bf16 v[88:91], v[160:163], v[168:171], 0
  s_waitcnt lgkmcnt(0)
  s_barrier
  ds_read_b128 v[196:199], v76 offset:10240
  v_mfma_f32_16x16x32_bf16 v[92:95], v[172:175], v[164:167], 0
  ds_read_b128 v[200:203], v78 offset:16384
  v_mfma_f32_16x16x32_bf16 v[96:99], v[172:175], v[168:171], 0
  ds_read_b128 v[204:207], v79 offset:18432
  v_mfma_f32_16x16x32_bf16 v[100:103], v[176:179], v[164:167], 0
  ds_read_b128 v[208:211], v76 offset:12288
  v_mfma_f32_16x16x32_bf16 v[104:107], v[176:179], v[168:171], 0
  ds_read_b128 v[212:215], v76 offset:14336
  v_mfma_f32_16x16x32_bf16 v[108:111], v[180:183], v[164:167], 0
  ds_read_b128 v[216:219], v76 offset:16384
  v_mfma_f32_16x16x32_bf16 v[112:115], v[180:183], v[168:171], 0
  ds_read_b128 v[220:223], v76 offset:18432
  v_mfma_f32_16x16x32_bf16 v[116:119], v[184:187], v[164:167], 0
  ds_read_b128 v[224:227], v80 offset:16384
  v_mfma_f32_16x16x32_bf16 v[120:123], v[184:187], v[168:171], 0
  ds_read_b128 v[228:231], v81 offset:18432
  v_mfma_f32_16x16x32_bf16 v[84:87], v[160:163], v[188:191], v[84:87]
  v_mfma_f32_16x16x32_bf16 v[88:91], v[160:163], v[192:195], v[88:91]
  v_mfma_f32_16x16x32_bf16 v[92:95], v[172:175], v[188:191], v[92:95]
  v_mfma_f32_16x16x32_bf16 v[96:99], v[172:175], v[192:195], v[96:99]
  v_mfma_f32_16x16x32_bf16 v[100:103], v[176:179], v[188:191], v[100:103]
  v_mfma_f32_16x16x32_bf16 v[104:107], v[176:179], v[192:195], v[104:107]
  v_mfma_f32_16x16x32_bf16 v[108:111], v[180:183], v[188:191], v[108:111]
  v_mfma_f32_16x16x32_bf16 v[112:115], v[180:183], v[192:195], v[112:115]
  v_mfma_f32_16x16x32_bf16 v[116:119], v[184:187], v[188:191], v[116:119]
  v_mfma_f32_16x16x32_bf16 v[120:123], v[184:187], v[192:195], v[120:123]
  s_waitcnt lgkmcnt(7)
  v_mfma_f32_16x16x32_bf16 v[84:87], v[196:199], v[200:203], v[84:87]
  s_waitcnt lgkmcnt(6)
  v_mfma_f32_16x16x32_bf16 v[88:91], v[196:199], v[204:207], v[88:91]
  s_waitcnt lgkmcnt(0)
  s_barrier
  ds_read_b128 v[160:163], v76 offset:20480
  v_mfma_f32_16x16x32_bf16 v[92:95], v[208:211], v[200:203], v[92:95]
  ds_read_b128 v[164:167], v78 offset:32768
  v_mfma_f32_16x16x32_bf16 v[96:99], v[208:211], v[204:207], v[96:99]
  ds_read_b128 v[168:171], v79 offset:34816
  v_mfma_f32_16x16x32_bf16 v[100:103], v[212:215], v[200:203], v[100:103]
  ds_read_b128 v[172:175], v76 offset:22528
  v_mfma_f32_16x16x32_bf16 v[104:107], v[212:215], v[204:207], v[104:107]
  ds_read_b128 v[176:179], v76 offset:24576
  v_mfma_f32_16x16x32_bf16 v[108:111], v[216:219], v[200:203], v[108:111]
  ds_read_b128 v[180:183], v76 offset:26624
  v_mfma_f32_16x16x32_bf16 v[112:115], v[216:219], v[204:207], v[112:115]
  ds_read_b128 v[184:187], v76 offset:28672
  v_mfma_f32_16x16x32_bf16 v[116:119], v[220:223], v[200:203], v[116:119]
  ds_read_b128 v[188:191], v80 offset:32768
  v_mfma_f32_16x16x32_bf16 v[120:123], v[220:223], v[204:207], v[120:123]
  ds_read_b128 v[192:195], v81 offset:34816
  v_mfma_f32_16x16x32_bf16 v[84:87], v[196:199], v[224:227], v[84:87]
  v_mfma_f32_16x16x32_bf16 v[88:91], v[196:199], v[228:231], v[88:91]
  v_mfma_f32_16x16x32_bf16 v[92:95], v[208:211], v[224:227], v[92:95]
  v_mfma_f32_16x16x32_bf16 v[96:99], v[208:211], v[228:231], v[96:99]
  v_mfma_f32_16x16x32_bf16 v[100:103], v[212:215], v[224:227], v[100:103]
  v_mfma_f32_16x16x32_bf16 v[104:107], v[212:215], v[228:231], v[104:107]
  v_mfma_f32_16x16x32_bf16 v[108:111], v[216:219], v[224:227], v[108:111]
  v_mfma_f32_16x16x32_bf16 v[112:115], v[216:219], v[228:231], v[112:115]
  v_mfma_f32_16x16x32_bf16 v[116:119], v[220:223], v[224:227], v[116:119]
  v_mfma_f32_16x16x32_bf16 v[120:123], v[220:223], v[228:231], v[120:123]
  s_waitcnt lgkmcnt(7)
  v_mfma_f32_16x16x32_bf16 v[84:87], v[160:163], v[164:167], v[84:87]
  s_waitcnt lgkmcnt(6)
  v_mfma_f32_16x16x32_bf16 v[88:91], v[160:163], v[168:171], v[88:91]
  s_waitcnt lgkmcnt(0)
  s_barrier
  ds_read_b128 v[196:199], v76 offset:30720
  v_mfma_f32_16x16x32_bf16 v[92:95], v[172:175], v[164:167], v[92:95]
  ds_read_b128 v[200:203], v78 offset:0
  v_mfma_f32_16x16x32_bf16 v[96:99], v[172:175], v[168:171], v[96:99]
  ds_read_b128 v[204:207], v79 offset:2048
  v_mfma_f32_16x16x32_bf16 v[100:103], v[176:179], v[164:167], v[100:103]
  ds_read_b128 v[208:211], v76 offset:32768
  v_mfma_f32_16x16x32_bf16 v[104:107], v[176:179], v[168:171], v[104:107]
  ds_read_b128 v[212:215], v76 offset:34816
  v_mfma_f32_16x16x32_bf16 v[108:111], v[180:183], v[164:167], v[108:111]
  ds_read_b128 v[216:219], v76 offset:36864
  v_mfma_f32_16x16x32_bf16 v[112:115], v[180:183], v[168:171], v[112:115]
  ds_read_b128 v[220:223], v76 offset:38912
  v_mfma_f32_16x16x32_bf16 v[116:119], v[184:187], v[164:167], v[116:119]
  ds_read_b128 v[224:227], v80 offset:0
  v_mfma_f32_16x16x32_bf16 v[120:123], v[184:187], v[168:171], v[120:123]
  ds_read_b128 v[228:231], v81 offset:2048
  v_mfma_f32_16x16x32_bf16 v[84:87], v[160:163], v[188:191], v[84:87]
  v_mfma_f32_16x16x32_bf16 v[88:91], v[160:163], v[192:195], v[88:91]
  v_mfma_f32_16x16x32_bf16 v[92:95], v[172:175], v[188:191], v[92:95]
  v_mfma_f32_16x16x32_bf16 v[96:99], v[172:175], v[192:195], v[96:99]
  v_mfma_f32_16x16x32_bf16 v[100:103], v[176:179], v[188:191], v[100:103]
  v_mfma_f32_16x16x32_bf16 v[104:107], v[176:179], v[192:195], v[104:107]
  v_mfma_f32_16x16x32_bf16 v[108:111], v[180:183], v[188:191], v[108:111]
  v_mfma_f32_16x16x32_bf16 v[112:115], v[180:183], v[192:195], v[112:115]
  v_mfma_f32_16x16x32_bf16 v[116:119], v[184:187], v[188:191], v[116:119]
  v_mfma_f32_16x16x32_bf16 v[120:123], v[184:187], v[192:195], v[120:123]
  s_waitcnt lgkmcnt(7)
  v_mfma_f32_16x16x32_bf16 v[84:87], v[196:199], v[200:203], v[84:87]
  s_waitcnt lgkmcnt(6)
  v_mfma_f32_16x16x32_bf16 v[88:91], v[196:199], v[204:207], v[88:91]
  s_waitcnt lgkmcnt(0)
  s_barrier
  ds_read_b128 v[160:163], v76 offset:40960
  v_mfma_f32_16x16x32_bf16 v[92:95], v[208:211], v[200:203], v[92:95]
  ds_read_b128 v[164:167], v78 offset:16384
  v_mfma_f32_16x16x32_bf16 v[96:99], v[208:211], v[204:207], v[96:99]
  ds_read_b128 v[168:171], v79 offset:18432
  v_mfma_f32_16x16x32_bf16 v[100:103], v[212:215], v[200:203], v[100:103]
  ds_read_b128 v[172:175], v76 offset:43008
  v_mfma_f32_16x16x32_bf16 v[104:107], v[212:215], v[204:207], v[104:107]
  ds_read_b128 v[176:179], v76 offset:45056
  v_mfma_f32_16x16x32_bf16 v[108:111], v[216:219], v[200:203], v[108:111]
  ds_read_b128 v[180:183], v76 offset:47104
  v_mfma_f32_16x16x32_bf16 v[112:115], v[216:219], v[204:207], v[112:115]
  ds_read_b128 v[184:187], v76 offset:49152
  v_mfma_f32_16x16x32_bf16 v[116:119], v[220:223], v[200:203], v[116:119]
  ds_read_b128 v[188:191], v80 offset:16384
  v_mfma_f32_16x16x32_bf16 v[120:123], v[220:223], v[204:207], v[120:123]
  ds_read_b128 v[192:195], v81 offset:18432
  v_mfma_f32_16x16x32_bf16 v[84:87], v[196:199], v[224:227], v[84:87]
  v_mfma_f32_16x16x32_bf16 v[88:91], v[196:199], v[228:231], v[88:91]
  v_mfma_f32_16x16x32_bf16 v[92:95], v[208:211], v[224:227], v[92:95]
  v_mfma_f32_16x16x32_bf16 v[96:99], v[208:211], v[228:231], v[96:99]
  v_mfma_f32_16x16x32_bf16 v[100:103], v[212:215], v[224:227], v[100:103]
  v_mfma_f32_16x16x32_bf16 v[104:107], v[212:215], v[228:231], v[104:107]
  v_mfma_f32_16x16x32_bf16 v[108:111], v[216:219], v[224:227], v[108:111]
  v_mfma_f32_16x16x32_bf16 v[112:115], v[216:219], v[228:231], v[112:115]
  v_mfma_f32_16x16x32_bf16 v[116:119], v[220:223], v[224:227], v[116:119]
  v_mfma_f32_16x16x32_bf16 v[120:123], v[220:223], v[228:231], v[120:123]
  s_waitcnt lgkmcnt(7)
  v_mfma_f32_16x16x32_bf16 v[84:87], v[160:163], v[164:167], v[84:87]
  s_waitcnt lgkmcnt(6)
  v_mfma_f32_16x16x32_bf16 v[88:91], v[160:163], v[168:171], v[88:91]
  s_waitcnt lgkmcnt(0)
  s_barrier
  ds_read_b128 v[196:199], v76 offset:51200
  v_mfma_f32_16x16x32_bf16 v[92:95], v[172:175], v[164:167], v[92:95]
  ds_read_b128 v[200:203], v78 offset:32768
  v_mfma_f32_16x16x32_bf16 v[96:99], v[172:175], v[168:171], v[96:99]
  ds_read_b128 v[204:207], v79 offset:34816
  v_mfma_f32_16x16x32_bf16 v[100:103], v[176:179], v[164:167], v[100:103]
  ds_read_b128 v[208:211], v76 offset:53248
  v_mfma_f32_16x16x32_bf16 v[104:107], v[176:179], v[168:171], v[104:107]
  ds_read_b128 v[212:215], v76 offset:55296
  v_mfma_f32_16x16x32_bf16 v[108:111], v[180:183], v[164:167], v[108:111]
  ds_read_b128 v[216:219], v76 offset:57344
  v_mfma_f32_16x16x32_bf16 v[112:115], v[180:183], v[168:171], v[112:115]
  ds_read_b128 v[220:223], v76 offset:59392
  v_mfma_f32_16x16x32_bf16 v[116:119], v[184:187], v[164:167], v[116:119]
  ds_read_b128 v[224:227], v80 offset:32768
  v_mfma_f32_16x16x32_bf16 v[120:123], v[184:187], v[168:171], v[120:123]
  ds_read_b128 v[228:231], v81 offset:34816
  v_mfma_f32_16x16x32_bf16 v[84:87], v[160:163], v[188:191], v[84:87]
  v_mfma_f32_16x16x32_bf16 v[88:91], v[160:163], v[192:195], v[88:91]
  v_mfma_f32_16x16x32_bf16 v[92:95], v[172:175], v[188:191], v[92:95]
  v_mfma_f32_16x16x32_bf16 v[96:99], v[172:175], v[192:195], v[96:99]
  v_mfma_f32_16x16x32_bf16 v[100:103], v[176:179], v[188:191], v[100:103]
  v_mfma_f32_16x16x32_bf16 v[104:107], v[176:179], v[192:195], v[104:107]
  v_mfma_f32_16x16x32_bf16 v[108:111], v[180:183], v[188:191], v[108:111]
  v_mfma_f32_16x16x32_bf16 v[112:115], v[180:183], v[192:195], v[112:115]
  v_mfma_f32_16x16x32_bf16 v[116:119], v[184:187], v[188:191], v[116:119]
  v_mfma_f32_16x16x32_bf16 v[120:123], v[184:187], v[192:195], v[120:123]
  s_waitcnt lgkmcnt(7)
  v_mfma_f32_16x16x32_bf16 v[84:87], v[196:199], v[200:203], v[84:87]
  s_waitcnt lgkmcnt(6)
  v_mfma_f32_16x16x32_bf16 v[88:91], v[196:199], v[204:207], v[88:91]
  s_waitcnt lgkmcnt(0)
  s_barrier
  ds_read_b128 v[160:163], v77 offset:0
  v_mfma_f32_16x16x32_bf16 v[92:95], v[208:211], v[200:203], v[92:95]
  ds_read_b128 v[164:167], v78 offset:0
  v_mfma_f32_16x16x32_bf16 v[96:99], v[208:211], v[204:207], v[96:99]
  ds_read_b128 v[168:171], v79 offset:2048
  v_mfma_f32_16x16x32_bf16 v[100:103], v[212:215], v[200:203], v[100:103]
  ds_read_b128 v[172:175], v77 offset:2048
  v_mfma_f32_16x16x32_bf16 v[104:107], v[212:215], v[204:207], v[104:107]
  ds_read_b128 v[176:179], v77 offset:4096
  v_mfma_f32_16x16x32_bf16 v[108:111], v[216:219], v[200:203], v[108:111]
  ds_read_b128 v[180:183], v77 offset:6144
  v_mfma_f32_16x16x32_bf16 v[112:115], v[216:219], v[204:207], v[112:115]
  ds_read_b128 v[184:187], v77 offset:8192
  v_mfma_f32_16x16x32_bf16 v[116:119], v[220:223], v[200:203], v[116:119]
  ds_read_b128 v[188:191], v80 offset:0
  v_mfma_f32_16x16x32_bf16 v[120:123], v[220:223], v[204:207], v[120:123]
  ds_read_b128 v[192:195], v81 offset:2048
  v_mfma_f32_16x16x32_bf16 v[84:87], v[196:199], v[224:227], v[84:87]
  v_mfma_f32_16x16x32_bf16 v[88:91], v[196:199], v[228:231], v[88:91]
  v_mfma_f32_16x16x32_bf16 v[92:95], v[208:211], v[224:227], v[92:95]
  v_mfma_f32_16x16x32_bf16 v[96:99], v[208:211], v[228:231], v[96:99]
  v_mfma_f32_16x16x32_bf16 v[100:103], v[212:215], v[224:227], v[100:103]
  v_mfma_f32_16x16x32_bf16 v[104:107], v[212:215], v[228:231], v[104:107]
  v_mfma_f32_16x16x32_bf16 v[108:111], v[216:219], v[224:227], v[108:111]
  v_mfma_f32_16x16x32_bf16 v[112:115], v[216:219], v[228:231], v[112:115]
  v_mfma_f32_16x16x32_bf16 v[116:119], v[220:223], v[224:227], v[116:119]
  v_mfma_f32_16x16x32_bf16 v[120:123], v[220:223], v[228:231], v[120:123]
  s_waitcnt lgkmcnt(7)
  v_mfma_f32_16x16x32_bf16 v[84:87], v[160:163], v[164:167], v[84:87]
  s_waitcnt lgkmcnt(6)
  v_mfma_f32_16x16x32_bf16 v[88:91], v[160:163], v[168:171], v[88:91]
  s_waitcnt lgkmcnt(0)
  s_barrier
  ds_read_b128 v[196:199], v77 offset:10240
  v_mfma_f32_16x16x32_bf16 v[92:95], v[172:175], v[164:167], v[92:95]
  ds_read_b128 v[200:203], v78 offset:16384
  v_mfma_f32_16x16x32_bf16 v[96:99], v[172:175], v[168:171], v[96:99]
  ds_read_b128 v[204:207], v79 offset:18432
  v_mfma_f32_16x16x32_bf16 v[100:103], v[176:179], v[164:167], v[100:103]
  ds_read_b128 v[208:211], v77 offset:12288
  v_mfma_f32_16x16x32_bf16 v[104:107], v[176:179], v[168:171], v[104:107]
  ds_read_b128 v[212:215], v77 offset:14336
  v_mfma_f32_16x16x32_bf16 v[108:111], v[180:183], v[164:167], v[108:111]
  ds_read_b128 v[216:219], v77 offset:16384
  v_mfma_f32_16x16x32_bf16 v[112:115], v[180:183], v[168:171], v[112:115]
  ds_read_b128 v[220:223], v77 offset:18432
  v_mfma_f32_16x16x32_bf16 v[116:119], v[184:187], v[164:167], v[116:119]
  ds_read_b128 v[224:227], v80 offset:16384
  v_mfma_f32_16x16x32_bf16 v[120:123], v[184:187], v[168:171], v[120:123]
  ds_read_b128 v[228:231], v81 offset:18432
  v_mfma_f32_16x16x32_bf16 v[84:87], v[160:163], v[188:191], v[84:87]
  v_mfma_f32_16x16x32_bf16 v[88:91], v[160:163], v[192:195], v[88:91]
  v_mfma_f32_16x16x32_bf16 v[92:95], v[172:175], v[188:191], v[92:95]
  v_mfma_f32_16x16x32_bf16 v[96:99], v[172:175], v[192:195], v[96:99]
  v_mfma_f32_16x16x32_bf16 v[100:103], v[176:179], v[188:191], v[100:103]
  v_mfma_f32_16x16x32_bf16 v[104:107], v[176:179], v[192:195], v[104:107]
  v_mfma_f32_16x16x32_bf16 v[108:111], v[180:183], v[188:191], v[108:111]
  v_mfma_f32_16x16x32_bf16 v[112:115], v[180:183], v[192:195], v[112:115]
  v_mfma_f32_16x16x32_bf16 v[116:119], v[184:187], v[188:191], v[116:119]
  v_mfma_f32_16x16x32_bf16 v[120:123], v[184:187], v[192:195], v[120:123]
  s_waitcnt lgkmcnt(7)
  v_mfma_f32_16x16x32_bf16 v[84:87], v[196:199], v[200:203], v[84:87]
  s_waitcnt lgkmcnt(6)
  v_mfma_f32_16x16x32_bf16 v[88:91], v[196:199], v[204:207], v[88:91]
  s_waitcnt lgkmcnt(0)
  s_barrier
  ds_read_b128 v[160:163], v77 offset:20480
  v_mfma_f32_16x16x32_bf16 v[92:95], v[208:211], v[200:203], v[92:95]
  ds_read_b128 v[164:167], v78 offset:32768
  v_mfma_f32_16x16x32_bf16 v[96:99], v[208:211], v[204:207], v[96:99]
  ds_read_b128 v[168:171], v79 offset:34816
  v_mfma_f32_16x16x32_bf16 v[100:103], v[212:215], v[200:203], v[100:103]
  ds_read_b128 v[172:175], v77 offset:22528
  v_mfma_f32_16x16x32_bf16 v[104:107], v[212:215], v[204:207], v[104:107]
  ds_read_b128 v[176:179], v77 offset:24576
  v_mfma_f32_16x16x32_bf16 v[108:111], v[216:219], v[200:203], v[108:111]
  ds_read_b128 v[180:183], v77 offset:26624
  v_mfma_f32_16x16x32_bf16 v[112:115], v[216:219], v[204:207], v[112:115]
  ds_read_b128 v[184:187], v77 offset:28672
  v_mfma_f32_16x16x32_bf16 v[116:119], v[220:223], v[200:203], v[116:119]
  ds_read_b128 v[188:191], v80 offset:32768
  v_mfma_f32_16x16x32_bf16 v[120:123], v[220:223], v[204:207], v[120:123]
  ds_read_b128 v[192:195], v81 offset:34816
  v_mfma_f32_16x16x32_bf16 v[84:87], v[196:199], v[224:227], v[84:87]
  v_mfma_f32_16x16x32_bf16 v[88:91], v[196:199], v[228:231], v[88:91]
  v_mfma_f32_16x16x32_bf16 v[92:95], v[208:211], v[224:227], v[92:95]
  v_mfma_f32_16x16x32_bf16 v[96:99], v[208:211], v[228:231], v[96:99]
  v_mfma_f32_16x16x32_bf16 v[100:103], v[212:215], v[224:227], v[100:103]
  v_mfma_f32_16x16x32_bf16 v[104:107], v[212:215], v[228:231], v[104:107]
  v_mfma_f32_16x16x32_bf16 v[108:111], v[216:219], v[224:227], v[108:111]
  v_mfma_f32_16x16x32_bf16 v[112:115], v[216:219], v[228:231], v[112:115]
  v_mfma_f32_16x16x32_bf16 v[116:119], v[220:223], v[224:227], v[116:119]
  v_mfma_f32_16x16x32_bf16 v[120:123], v[220:223], v[228:231], v[120:123]
  s_waitcnt lgkmcnt(7)
  v_mfma_f32_16x16x32_bf16 v[84:87], v[160:163], v[164:167], v[84:87]
  s_waitcnt lgkmcnt(6)
  v_mfma_f32_16x16x32_bf16 v[88:91], v[160:163], v[168:171], v[88:91]
  s_waitcnt lgkmcnt(0)
  s_barrier
  ds_read_b128 v[196:199], v77 offset:30720
  v_mfma_f32_16x16x32_bf16 v[92:95], v[172:175], v[164:167], v[92:95]
  ds_read_b128 v[200:203], v78 offset:0
  v_mfma_f32_16x16x32_bf16 v[96:99], v[172:175], v[168:171], v[96:99]
  ds_read_b128 v[204:207], v79 offset:2048
  v_mfma_f32_16x16x32_bf16 v[100:103], v[176:179], v[164:167], v[100:103]
  ds_read_b128 v[208:211], v77 offset:32768
  v_mfma_f32_16x16x32_bf16 v[104:107], v[176:179], v[168:171], v[104:107]
  ds_read_b128 v[212:215], v77 offset:34816
  v_mfma_f32_16x16x32_bf16 v[108:111], v[180:183], v[164:167], v[108:111]
  ds_read_b128 v[216:219], v77 offset:36864
  v_mfma_f32_16x16x32_bf16 v[112:115], v[180:183], v[168:171], v[112:115]
  ds_read_b128 v[220:223], v77 offset:38912
  v_mfma_f32_16x16x32_bf16 v[116:119], v[184:187], v[164:167], v[116:119]
  ds_read_b128 v[224:227], v80 offset:0
  v_mfma_f32_16x16x32_bf16 v[120:123], v[184:187], v[168:171], v[120:123]
  ds_read_b128 v[228:231], v81 offset:2048
  v_mfma_f32_16x16x32_bf16 v[84:87], v[160:163], v[188:191], v[84:87]
  v_mfma_f32_16x16x32_bf16 v[88:91], v[160:163], v[192:195], v[88:91]
  v_mfma_f32_16x16x32_bf16 v[92:95], v[172:175], v[188:191], v[92:95]
  v_mfma_f32_16x16x32_bf16 v[96:99], v[172:175], v[192:195], v[96:99]
  v_mfma_f32_16x16x32_bf16 v[100:103], v[176:179], v[188:191], v[100:103]
  v_mfma_f32_16x16x32_bf16 v[104:107], v[176:179], v[192:195], v[104:107]
  v_mfma_f32_16x16x32_bf16 v[108:111], v[180:183], v[188:191], v[108:111]
  v_mfma_f32_16x16x32_bf16 v[112:115], v[180:183], v[192:195], v[112:115]
  v_mfma_f32_16x16x32_bf16 v[116:119], v[184:187], v[188:191], v[116:119]
  v_mfma_f32_16x16x32_bf16 v[120:123], v[184:187], v[192:195], v[120:123]
  buffer_load_dwordx4 v[12:15], v48, s[40:43], 0 offen
  buffer_load_dwordx4 v[36:39], v60, s[48:51], 0 offen sc1
  buffer_load_dwordx4 v[16:19], v49, s[40:43], 0 offen
  buffer_load_dwordx4 v[40:43], v61, s[48:51], 0 offen sc1
  buffer_load_dwordx4 v[20:23], v50, s[40:43], 0 offen
  buffer_load_dwordx4 v[44:47], v62, s[48:51], 0 offen sc1
  s_cmp_lt_u32 s18, 4
  s_cbranch_scc1 p3nomir_27
  v_subrev_u32 v7, 8192, v60
  v_cmp_eq_u32 vcc, 1, v63
  s_nop 1
  v_cndmask_b32 v7, v11, v7, vcc
  buffer_load_dwordx4 v[24:27], v7, s[48:51], 0 offen sc1
  v_subrev_u32 v7, 8192, v61
  v_cmp_eq_u32 vcc, 1, v64
  s_nop 1
  v_cndmask_b32 v7, v11, v7, vcc
  buffer_load_dwordx4 v[28:31], v7, s[48:51], 0 offen sc1
  v_subrev_u32 v7, 8192, v62
  v_cmp_eq_u32 vcc, 1, v65
  s_nop 1
  v_cndmask_b32 v7, v11, v7, vcc
  buffer_load_dwordx4 v[32:35], v7, s[48:51], 0 offen sc1
p3nomir_27:
  s_cmp_lg_u32 s17, 16
  s_cbranch_scc1 p3noy_28
  v_subrev_u32 v3, 1310720, v48
  v_lshrrev_b32 v3, 1, v3
  v_cmp_eq_u32 vcc, 1024, v57
  v_add_u32 v4, 0, v3
  v_sub_u32 v5, 640, v4
  v_min_u32 v4, v4, v5
  v_lshlrev_b32 v4, 2, v4
  v_cndmask_b32 v4, v11, v4, vcc
  buffer_load_dword v68, v4, s[52:55], s57 offen sc1
  v_add_u32 v4, 1, v3
  v_sub_u32 v5, 640, v4
  v_min_u32 v4, v4, v5
  v_lshlrev_b32 v4, 2, v4
  v_cndmask_b32 v4, v11, v4, vcc
  buffer_load_dword v69, v4, s[52:55], s57 offen sc1
  v_add_u32 v4, 2, v3
  v_sub_u32 v5, 640, v4
  v_min_u32 v4, v4, v5
  v_lshlrev_b32 v4, 2, v4
  v_cndmask_b32 v4, v11, v4, vcc
  buffer_load_dword v70, v4, s[52:55], s57 offen sc1
  v_add_u32 v4, 3, v3
  v_sub_u32 v5, 640, v4
  v_min_u32 v4, v4, v5
  v_lshlrev_b32 v4, 2, v4
  v_cndmask_b32 v4, v11, v4, vcc
  buffer_load_dword v71, v4, s[52:55], s57 offen sc1
  v_add_u32 v4, 4, v3
  v_sub_u32 v5, 640, v4
  v_min_u32 v4, v4, v5
  v_lshlrev_b32 v4, 2, v4
  v_cndmask_b32 v4, v11, v4, vcc
  buffer_load_dword v72, v4, s[52:55], s57 offen sc1
  v_add_u32 v4, 5, v3
  v_sub_u32 v5, 640, v4
  v_min_u32 v4, v4, v5
  v_lshlrev_b32 v4, 2, v4
  v_cndmask_b32 v4, v11, v4, vcc
  buffer_load_dword v73, v4, s[52:55], s57 offen sc1
  v_add_u32 v4, 6, v3
  v_sub_u32 v5, 640, v4
  v_min_u32 v4, v4, v5
  v_lshlrev_b32 v4, 2, v4
  v_cndmask_b32 v4, v11, v4, vcc
  buffer_load_dword v74, v4, s[52:55], s57 offen sc1
  v_add_u32 v4, 7, v3
  v_sub_u32 v5, 640, v4
  v_min_u32 v4, v4, v5
  v_lshlrev_b32 v4, 2, v4
  v_cndmask_b32 v4, v11, v4, vcc
  buffer_load_dword v75, v4, s[52:55], s57 offen sc1
p3noy_28:
  s_waitcnt lgkmcnt(7)
  v_mfma_f32_16x16x32_bf16 v[84:87], v[196:199], v[200:203], v[84:87]
  s_waitcnt lgkmcnt(6)
  v_mfma_f32_16x16x32_bf16 v[88:91], v[196:199], v[204:207], v[88:91]
  s_waitcnt lgkmcnt(0)
  s_barrier
  ds_read_b128 v[160:163], v76 offset:0
  v_mfma_f32_16x16x32_bf16 v[92:95], v[208:211], v[200:203], v[92:95]
  ds_read_b128 v[164:167], v78 offset:16384
  v_mfma_f32_16x16x32_bf16 v[96:99], v[208:211], v[204:207], v[96:99]
  ds_read_b128 v[168:171], v79 offset:18432
  v_mfma_f32_16x16x32_bf16 v[100:103], v[212:215], v[200:203], v[100:103]
  ds_read_b128 v[172:175], v76 offset:2048
  v_mfma_f32_16x16x32_bf16 v[104:107], v[212:215], v[204:207], v[104:107]
  ds_read_b128 v[176:179], v76 offset:4096
  v_mfma_f32_16x16x32_bf16 v[108:111], v[216:219], v[200:203], v[108:111]
  ds_read_b128 v[180:183], v76 offset:6144
  v_mfma_f32_16x16x32_bf16 v[112:115], v[216:219], v[204:207], v[112:115]
  ds_read_b128 v[184:187], v76 offset:8192
  v_mfma_f32_16x16x32_bf16 v[116:119], v[220:223], v[200:203], v[116:119]
  ds_read_b128 v[188:191], v80 offset:16384
  v_mfma_f32_16x16x32_bf16 v[120:123], v[220:223], v[204:207], v[120:123]
  ds_read_b128 v[192:195], v81 offset:18432
  v_mfma_f32_16x16x32_bf16 v[84:87], v[196:199], v[224:227], v[84:87]
  v_mfma_f32_16x16x32_bf16 v[88:91], v[196:199], v[228:231], v[88:91]
  v_mfma_f32_16x16x32_bf16 v[92:95], v[208:211], v[224:227], v[92:95]
  v_mfma_f32_16x16x32_bf16 v[96:99], v[208:211], v[228:231], v[96:99]
  v_mfma_f32_16x16x32_bf16 v[100:103], v[212:215], v[224:227], v[100:103]
  v_mfma_f32_16x16x32_bf16 v[104:107], v[212:215], v[228:231], v[104:107]
  v_mfma_f32_16x16x32_bf16 v[108:111], v[216:219], v[224:227], v[108:111]
  v_mfma_f32_16x16x32_bf16 v[112:115], v[216:219], v[228:231], v[112:115]
  v_mfma_f32_16x16x32_bf16 v[116:119], v[220:223], v[224:227], v[116:119]
  v_mfma_f32_16x16x32_bf16 v[120:123], v[220:223], v[228:231], v[120:123]
  s_waitcnt lgkmcnt(7)
  v_mfma_f32_16x16x32_bf16 v[84:87], v[160:163], v[164:167], v[84:87]
  s_waitcnt lgkmcnt(6)
  v_mfma_f32_16x16x32_bf16 v[88:91], v[160:163], v[168:171], v[88:91]
  s_waitcnt lgkmcnt(0)
  s_barrier
  ds_read_b128 v[196:199], v76 offset:10240
  v_mfma_f32_16x16x32_bf16 v[92:95], v[172:175], v[164:167], v[92:95]
  ds_read_b128 v[200:203], v78 offset:32768
  v_mfma_f32_16x16x32_bf16 v[96:99], v[172:175], v[168:171], v[96:99]
  ds_read_b128 v[204:207], v79 offset:34816
  v_mfma_f32_16x16x32_bf16 v[100:103], v[176:179], v[164:167], v[100:103]
  ds_read_b128 v[208:211], v76 offset:12288
  v_mfma_f32_16x16x32_bf16 v[104:107], v[176:179], v[168:171], v[104:107]
  ds_read_b128 v[212:215], v76 offset:14336
  v_mfma_f32_16x16x32_bf16 v[108:111], v[180:183], v[164:167], v[108:111]
  ds_read_b128 v[216:219], v76 offset:16384
  v_mfma_f32_16x16x32_bf16 v[112:115], v[180:183], v[168:171], v[112:115]
  ds_read_b128 v[220:223], v76 offset:18432
  v_mfma_f32_16x16x32_bf16 v[116:119], v[184:187], v[164:167], v[116:119]
  ds_read_b128 v[224:227], v80 offset:32768
  v_mfma_f32_16x16x32_bf16 v[120:123], v[184:187], v[168:171], v[120:123]
  ds_read_b128 v[228:231], v81 offset:34816
  v_mfma_f32_16x16x32_bf16 v[84:87], v[160:163], v[188:191], v[84:87]
  v_mfma_f32_16x16x32_bf16 v[88:91], v[160:163], v[192:195], v[88:91]
  v_mfma_f32_16x16x32_bf16 v[92:95], v[172:175], v[188:191], v[92:95]
  v_mfma_f32_16x16x32_bf16 v[96:99], v[172:175], v[192:195], v[96:99]
  v_mfma_f32_16x16x32_bf16 v[100:103], v[176:179], v[188:191], v[100:103]
  v_mfma_f32_16x16x32_bf16 v[104:107], v[176:179], v[192:195], v[104:107]
  v_mfma_f32_16x16x32_bf16 v[108:111], v[180:183], v[188:191], v[108:111]
  v_mfma_f32_16x16x32_bf16 v[112:115], v[180:183], v[192:195], v[112:115]
  v_mfma_f32_16x16x32_bf16 v[116:119], v[184:187], v[188:191], v[116:119]
  v_mfma_f32_16x16x32_bf16 v[120:123], v[184:187], v[192:195], v[120:123]
  s_waitcnt vmcnt(0)
  s_waitcnt lgkmcnt(7)
  v_mfma_f32_16x16x32_bf16 v[84:87], v[196:199], v[200:203], v[84:87]
  v_cmp_eq_u32 s[60:61], 1, v63
  v_mov_b32_dpp v156, v36 wave_shl:1 row_mask:0xf bank_mask:0xf
  v_mov_b32_dpp v157, v37 wave_shl:1 row_mask:0xf bank_mask:0xf
  s_waitcnt lgkmcnt(6)
  v_mfma_f32_16x16x32_bf16 v[88:91], v[196:199], v[204:207], v[88:91]
  v_mov_b32_dpp v158, v38 wave_shl:1 row_mask:0xf bank_mask:0xf
  v_mov_b32_dpp v159, v39 wave_shl:1 row_mask:0xf bank_mask:0xf
  s_nop 1
  s_waitcnt lgkmcnt(0)
  s_barrier
  ds_read_b128 v[160:163], v76 offset:20480
  v_mfma_f32_16x16x32_bf16 v[92:95], v[208:211], v[200:203], v[92:95]
  v_cndmask_b32 v24, v156, v24, s[60:61]
  v_cndmask_b32 v25, v157, v25, s[60:61]
  v_cndmask_b32 v26, v158, v26, s[60:61]
  ds_read_b128 v[164:167], v78 offset:0
  v_mfma_f32_16x16x32_bf16 v[96:99], v[208:211], v[204:207], v[96:99]
  v_cndmask_b32 v27, v159, v27, s[60:61]
  v_perm_b32 v156, v27, v36, s58
  v_perm_b32 v157, v26, v27, s58
  ds_read_b128 v[168:171], v79 offset:2048
  v_mfma_f32_16x16x32_bf16 v[100:103], v[212:215], v[200:203], v[100:103]
  v_perm_b32 v158, v25, v26, s58
  v_perm_b32 v159, v24, v25, s58
  v_cmp_eq_u32 s[60:61], 1, v54
  ds_read_b128 v[172:175], v76 offset:22528
  v_mfma_f32_16x16x32_bf16 v[104:107], v[212:215], v[204:207], v[104:107]
  s_nop 1
  v_cndmask_b32 v156, v36, v156, s[60:61]
  v_cndmask_b32 v157, v37, v157, s[60:61]
  ds_read_b128 v[176:179], v76 offset:24576
  v_mfma_f32_16x16x32_bf16 v[108:111], v[216:219], v[200:203], v[108:111]
  v_cndmask_b32 v158, v38, v158, s[60:61]
  v_cndmask_b32 v159, v39, v159, s[60:61]
  v_lshlrev_b32 v124, 16, v156
  ds_read_b128 v[180:183], v76 offset:26624
  v_mfma_f32_16x16x32_bf16 v[112:115], v[216:219], v[204:207], v[112:115]
  v_and_b32 v125, 0xffff0000, v156
  v_lshlrev_b32 v126, 16, v157
  v_and_b32 v127, 0xffff0000, v157
  ds_read_b128 v[184:187], v76 offset:28672
  v_mfma_f32_16x16x32_bf16 v[116:119], v[220:223], v[200:203], v[116:119]
  v_lshlrev_b32 v128, 16, v158
  v_and_b32 v129, 0xffff0000, v158
  v_lshlrev_b32 v130, 16, v159
  ds_read_b128 v[188:191], v80 offset:0
  v_mfma_f32_16x16x32_bf16 v[120:123], v[220:223], v[204:207], v[120:123]
  v_and_b32 v131, 0xffff0000, v159
  v_cmp_eq_u32 s[60:61], s59, v57
  s_nop 1
  ds_read_b128 v[192:195], v81 offset:2048
  v_mfma_f32_16x16x32_bf16 v[84:87], v[196:199], v[224:227], v[84:87]
  v_cndmask_b32 v124, v124, v68, s[60:61]
  v_cndmask_b32 v125, v125, v69, s[60:61]
  v_cndmask_b32 v126, v126, v70, s[60:61]
  v_mfma_f32_16x16x32_bf16 v[88:91], v[196:199], v[228:231], v[88:91]
  v_cndmask_b32 v127, v127, v71, s[60:61]
  v_cndmask_b32 v128, v128, v72, s[60:61]
  v_cndmask_b32 v129, v129, v73, s[60:61]
  v_mfma_f32_16x16x32_bf16 v[92:95], v[208:211], v[224:227], v[92:95]
  v_cndmask_b32 v130, v130, v74, s[60:61]
  v_cndmask_b32 v131, v131, v75, s[60:61]
  v_lshlrev_b32 v148, 16, v12
  v_mfma_f32_16x16x32_bf16 v[96:99], v[208:211], v[228:231], v[96:99]
  v_and_b32 v149, 0xffff0000, v12
  v_lshlrev_b32 v150, 16, v13
  v_and_b32 v151, 0xffff0000, v13
  v_mfma_f32_16x16x32_bf16 v[100:103], v[212:215], v[224:227], v[100:103]
  v_lshlrev_b32 v152, 16, v14
  v_and_b32 v153, 0xffff0000, v14
  v_lshlrev_b32 v154, 16, v15
  v_mfma_f32_16x16x32_bf16 v[104:107], v[212:215], v[228:231], v[104:107]
  v_and_b32 v155, 0xffff0000, v15
  v_pk_add_f32 v[124:125], v[124:125], v[148:149]
  v_pk_add_f32 v[126:127], v[126:127], v[150:151]
  v_mfma_f32_16x16x32_bf16 v[108:111], v[216:219], v[224:227], v[108:111]
  v_pk_add_f32 v[128:129], v[128:129], v[152:153]
  v_pk_add_f32 v[130:131], v[130:131], v[154:155]
  v_cmp_eq_u32 s[60:61], 1, v64
  v_mfma_f32_16x16x32_bf16 v[112:115], v[216:219], v[228:231], v[112:115]
  v_mov_b32_dpp v156, v40 wave_shl:1 row_mask:0xf bank_mask:0xf
  v_mov_b32_dpp v157, v41 wave_shl:1 row_mask:0xf bank_mask:0xf
  v_mov_b32_dpp v158, v42 wave_shl:1 row_mask:0xf bank_mask:0xf
  v_mfma_f32_16x16x32_bf16 v[116:119], v[220:223], v[224:227], v[116:119]
  v_mov_b32_dpp v159, v43 wave_shl:1 row_mask:0xf bank_mask:0xf
  s_nop 1
  v_cndmask_b32 v28, v156, v28, s[60:61]
  v_mfma_f32_16x16x32_bf16 v[120:123], v[220:223], v[228:231], v[120:123]
  v_cndmask_b32 v29, v157, v29, s[60:61]
  v_cndmask_b32 v30, v158, v30, s[60:61]
  v_cndmask_b32 v31, v159, v31, s[60:61]
  s_waitcnt lgkmcnt(7)
  v_mfma_f32_16x16x32_bf16 v[84:87], v[160:163], v[164:167], v[84:87]
  v_perm_b32 v156, v31, v40, s58
  v_perm_b32 v157, v30, v31, s58
  v_perm_b32 v158, v29, v30, s58
  s_waitcnt lgkmcnt(6)
  v_mfma_f32_16x16x32_bf16 v[88:91], v[160:163], v[168:171], v[88:91]
  v_perm_b32 v159, v28, v29, s58
  v_cmp_eq_u32 s[60:61], 1, v55
  s_nop 1
  s_waitcnt lgkmcnt(0)
  s_barrier
  ds_read_b128 v[196:199], v76 offset:30720
  v_mfma_f32_16x16x32_bf16 v[92:95], v[172:175], v[164:167], v[92:95]
  v_cndmask_b32 v156, v40, v156, s[60:61]
  v_cndmask_b32 v157, v41, v157, s[60:61]
  v_cndmask_b32 v158, v42, v158, s[60:61]
  ds_read_b128 v[200:203], v78 offset:16384
  v_mfma_f32_16x16x32_bf16 v[96:99], v[172:175], v[168:171], v[96:99]
  v_cndmask_b32 v159, v43, v159, s[60:61]
  v_lshlrev_b32 v132, 16, v156
  v_and_b32 v133, 0xffff0000, v156
  ds_read_b128 v[204:207], v79 offset:18432
  v_mfma_f32_16x16x32_bf16 v[100:103], v[176:179], v[164:167], v[100:103]
  v_lshlrev_b32 v134, 16, v157
  v_and_b32 v135, 0xffff0000, v157
  v_lshlrev_b32 v136, 16, v158
  ds_read_b128 v[208:211], v76 offset:32768
  v_mfma_f32_16x16x32_bf16 v[104:107], v[176:179], v[168:171], v[104:107]
  v_and_b32 v137, 0xffff0000, v158
  v_lshlrev_b32 v138, 16, v159
  v_and_b32 v139, 0xffff0000, v159
  ds_read_b128 v[212:215], v76 offset:34816
  v_mfma_f32_16x16x32_bf16 v[108:111], v[180:183], v[164:167], v[108:111]
  v_lshlrev_b32 v148, 16, v16
  v_and_b32 v149, 0xffff0000, v16
  v_lshlrev_b32 v150, 16, v17
  ds_read_b128 v[216:219], v76 offset:36864
  v_mfma_f32_16x16x32_bf16 v[112:115], v[180:183], v[168:171], v[112:115]
  v_and_b32 v151, 0xffff0000, v17
  v_lshlrev_b32 v152, 16, v18
  v_and_b32 v153, 0xffff0000, v18
  ds_read_b128 v[220:223], v76 offset:38912
  v_mfma_f32_16x16x32_bf16 v[116:119], v[184:187], v[164:167], v[116:119]
  v_lshlrev_b32 v154, 16, v19
  v_and_b32 v155, 0xffff0000, v19
  v_pk_add_f32 v[132:133], v[132:133], v[148:149]
  ds_read_b128 v[224:227], v80 offset:16384
  v_mfma_f32_16x16x32_bf16 v[120:123], v[184:187], v[168:171], v[120:123]
  v_pk_add_f32 v[134:135], v[134:135], v[150:151]
  v_pk_add_f32 v[136:137], v[136:137], v[152:153]
  v_pk_add_f32 v[138:139], v[138:139], v[154:155]
  ds_read_b128 v[228:231], v81 offset:18432
  v_mfma_f32_16x16x32_bf16 v[84:87], v[160:163], v[188:191], v[84:87]
  v_cmp_eq_u32 s[60:61], 1, v65
  v_mov_b32_dpp v156, v44 wave_shl:1 row_mask:0xf bank_mask:0xf
  v_mov_b32_dpp v157, v45 wave_shl:1 row_mask:0xf bank_mask:0xf
  v_mfma_f32_16x16x32_bf16 v[88:91], v[160:163], v[192:195], v[88:91]
  v_mov_b32_dpp v158, v46 wave_shl:1 row_mask:0xf bank_mask:0xf
  v_mov_b32_dpp v159, v47 wave_shl:1 row_mask:0xf bank_mask:0xf
  s_nop 1
  v_mfma_f32_16x16x32_bf16 v[92:95], v[172:175], v[188:191], v[92:95]
  v_cndmask_b32 v32, v156, v32, s[60:61]
  v_cndmask_b32 v33, v157, v33, s[60:61]
  v_cndmask_b32 v34, v158, v34, s[60:61]
  v_mfma_f32_16x16x32_bf16 v[96:99], v[172:175], v[192:195], v[96:99]
  v_cndmask_b32 v35, v159, v35, s[60:61]
  v_perm_b32 v156, v35, v44, s58
  v_perm_b32 v157, v34, v35, s58
  v_mfma_f32_16x16x32_bf16 v[100:103], v[176:179], v[188:191], v[100:103]
  v_perm_b32 v158, v33, v34, s58
  v_perm_b32 v159, v32, v33, s58
  v_cmp_eq_u32 s[60:61], 1, v56
  v_mfma_f32_16x16x32_bf16 v[104:107], v[176:179], v[192:195], v[104:107]
  s_nop 1
  v_cndmask_b32 v156, v44, v156, s[60:61]
  v_cndmask_b32 v157, v45, v157, s[60:61]
  v_mfma_f32_16x16x32_bf16 v[108:111], v[180:183], v[188:191], v[108:111]
  v_cndmask_b32 v158, v46, v158, s[60:61]
  v_cndmask_b32 v159, v47, v159, s[60:61]
  v_lshlrev_b32 v140, 16, v156
  v_mfma_f32_16x16x32_bf16 v[112:115], v[180:183], v[192:195], v[112:115]
  v_and_b32 v141, 0xffff0000, v156
  v_lshlrev_b32 v142, 16, v157
  v_and_b32 v143, 0xffff0000, v157
  v_mfma_f32_16x16x32_bf16 v[116:119], v[184:187], v[188:191], v[116:119]
  v_lshlrev_b32 v144, 16, v158
  v_and_b32 v145, 0xffff0000, v158
  v_lshlrev_b32 v146, 16, v159
  v_mfma_f32_16x16x32_bf16 v[120:123], v[184:187], v[192:195], v[120:123]
  v_and_b32 v147, 0xffff0000, v159
  v_lshlrev_b32 v148, 16, v20
  v_and_b32 v149, 0xffff0000, v20
  s_waitcnt lgkmcnt(7)
  v_mfma_f32_16x16x32_bf16 v[84:87], v[196:199], v[200:203], v[84:87]
  v_lshlrev_b32 v150, 16, v21
  v_and_b32 v151, 0xffff0000, v21
  v_lshlrev_b32 v152, 16, v22
  s_waitcnt lgkmcnt(6)
  v_mfma_f32_16x16x32_bf16 v[88:91], v[196:199], v[204:207], v[88:91]
  v_and_b32 v153, 0xffff0000, v22
  v_lshlrev_b32 v154, 16, v23
  v_and_b32 v155, 0xffff0000, v23
  s_waitcnt lgkmcnt(5)
  v_mfma_f32_16x16x32_bf16 v[92:95], v[208:211], v[200:203], v[92:95]
  v_pk_add_f32 v[140:141], v[140:141], v[148:149]
  v_pk_add_f32 v[142:143], v[142:143], v[150:151]
  v_pk_add_f32 v[144:145], v[144:145], v[152:153]
  v_mfma_f32_16x16x32_bf16 v[96:99], v[208:211], v[204:207], v[96:99]
  v_pk_add_f32 v[146:147], v[146:147], v[154:155]
  s_waitcnt lgkmcnt(4)
  v_mfma_f32_16x16x32_bf16 v[100:103], v[212:215], v[200:203], v[100:103]
  v_mfma_f32_16x16x32_bf16 v[104:107], v[212:215], v[204:207], v[104:107]
  s_waitcnt lgkmcnt(3)
  v_mfma_f32_16x16x32_bf16 v[108:111], v[216:219], v[200:203], v[108:111]
  v_mfma_f32_16x16x32_bf16 v[112:115], v[216:219], v[204:207], v[112:115]
  s_waitcnt lgkmcnt(2)
  v_mfma_f32_16x16x32_bf16 v[116:119], v[220:223], v[200:203], v[116:119]
  v_mfma_f32_16x16x32_bf16 v[120:123], v[220:223], v[204:207], v[120:123]
  s_waitcnt lgkmcnt(1)
  v_mfma_f32_16x16x32_bf16 v[84:87], v[196:199], v[224:227], v[84:87]
  s_waitcnt lgkmcnt(0)
  v_mfma_f32_16x16x32_bf16 v[88:91], v[196:199], v[228:231], v[88:91]
  v_mfma_f32_16x16x32_bf16 v[92:95], v[208:211], v[224:227], v[92:95]
  v_mfma_f32_16x16x32_bf16 v[96:99], v[208:211], v[228:231], v[96:99]
  v_mfma_f32_16x16x32_bf16 v[100:103], v[212:215], v[224:227], v[100:103]
  v_mfma_f32_16x16x32_bf16 v[104:107], v[212:215], v[228:231], v[104:107]
  v_mfma_f32_16x16x32_bf16 v[108:111], v[216:219], v[224:227], v[108:111]
  v_mfma_f32_16x16x32_bf16 v[112:115], v[216:219], v[228:231], v[112:115]
  v_mfma_f32_16x16x32_bf16 v[116:119], v[220:223], v[224:227], v[116:119]
  v_mfma_f32_16x16x32_bf16 v[120:123], v[220:223], v[228:231], v[120:123]
  s_nop 7
  s_barrier
  v_and_b32 v3, 15, v1
  v_add_u32 v3, v3, v10
  v_mul_u32_u24 v3, 336, v3
  v_lshrrev_b32 v4, 4, v1
  v_lshl_add_u32 v3, v4, 4, v3
  v_and_b32 v4, 1, v2
  v_mul_u32_u24 v4, 21504, v4
  v_add_u32 v3, v3, v4
  ds_write_b128 v3, v[84:87] offset:0
  ds_write_b128 v3, v[88:91] offset:5376
  ds_write_b128 v3, v[92:95] offset:64
  ds_write_b128 v3, v[96:99] offset:5440
  ds_write_b128 v3, v[100:103] offset:128
  ds_write_b128 v3, v[104:107] offset:5504
  ds_write_b128 v3, v[108:111] offset:192
  ds_write_b128 v3, v[112:115] offset:5568
  ds_write_b128 v3, v[116:119] offset:256
  ds_write_b128 v3, v[120:123] offset:5632
  s_waitcnt lgkmcnt(0)
  s_barrier
  ds_read_b128 v[160:163], v51
  ds_read_b128 v[164:167], v51 offset:16
  ds_read_b128 v[184:187], v51 offset:21504
  ds_read_b128 v[188:191], v51 offset:21520
  ds_read_b128 v[168:171], v52
  ds_read_b128 v[172:175], v52 offset:16
  ds_read_b128 v[192:195], v52 offset:21504
  ds_read_b128 v[196:199], v52 offset:21520
  ds_read_b128 v[176:179], v53
  ds_read_b128 v[180:183], v53 offset:16
  ds_read_b128 v[200:203], v53 offset:21504
  ds_read_b128 v[204:207], v53 offset:21520
  s_waitcnt lgkmcnt(8)
  v_pk_add_f32 v[160:161], v[160:161], v[184:185]
  v_pk_add_f32 v[162:163], v[162:163], v[186:187]
  v_pk_add_f32 v[164:165], v[164:165], v[188:189]
  v_pk_add_f32 v[166:167], v[166:167], v[190:191]
  v_pk_add_f32 v[160:161], v[160:161], v[124:125]
  v_pk_add_f32 v[162:163], v[162:163], v[126:127]
  v_pk_add_f32 v[164:165], v[164:165], v[128:129]
  v_pk_add_f32 v[166:167], v[166:167], v[130:131]
  v_cvt_pk_bf16_f32 v208, v160, v161
  v_cvt_pk_bf16_f32 v209, v162, v163
  v_cvt_pk_bf16_f32 v210, v164, v165
  v_cvt_pk_bf16_f32 v211, v166, v167
  buffer_store_dwordx4 v[208:211], v48, s[44:47], 0 offen
  s_waitcnt lgkmcnt(4)
  v_pk_add_f32 v[168:169], v[168:169], v[192:193]
  v_pk_add_f32 v[170:171], v[170:171], v[194:195]
  v_pk_add_f32 v[172:173], v[172:173], v[196:197]
  v_pk_add_f32 v[174:175], v[174:175], v[198:199]
  v_pk_add_f32 v[168:169], v[168:169], v[132:133]
  v_pk_add_f32 v[170:171], v[170:171], v[134:135]
  v_pk_add_f32 v[172:173], v[172:173], v[136:137]
  v_pk_add_f32 v[174:175], v[174:175], v[138:139]
  v_cvt_pk_bf16_f32 v212, v168, v169
  v_cvt_pk_bf16_f32 v213, v170, v171
  v_cvt_pk_bf16_f32 v214, v172, v173
  v_cvt_pk_bf16_f32 v215, v174, v175
  buffer_store_dwordx4 v[212:215], v49, s[44:47], 0 offen
  s_waitcnt lgkmcnt(0)
  v_pk_add_f32 v[176:177], v[176:177], v[200:201]
  v_pk_add_f32 v[178:179], v[178:179], v[202:203]
  v_pk_add_f32 v[180:181], v[180:181], v[204:205]
  v_pk_add_f32 v[182:183], v[182:183], v[206:207]
  v_pk_add_f32 v[176:177], v[176:177], v[140:141]
  v_pk_add_f32 v[178:179], v[178:179], v[142:143]
  v_pk_add_f32 v[180:181], v[180:181], v[144:145]
  v_pk_add_f32 v[182:183], v[182:183], v[146:147]
  v_cvt_pk_bf16_f32 v216, v176, v177
  v_cvt_pk_bf16_f32 v217, v178, v179
  v_cvt_pk_bf16_f32 v218, v180, v181
  v_cvt_pk_bf16_f32 v219, v182, v183
  buffer_store_dwordx4 v[216:219], v50, s[44:47], 0 offen
  s_waitcnt vmcnt(0)
  s_endpgm
P3_ld:
  v_and_b32 v1, 63, v0
  v_bfe_u32 v2, v0, 6, 2
  s_nop 0
  v_readfirstlane_b32 s16, v2
  v_mov_b32 v9, 0x40000000
  s_lshl_b32 s20, s17, 10
  v_mul_u32_u24 v3, 2, v2
  v_bfe_u32 v5, v3, 1, 1
  v_lshrrev_b32 v4, 3, v1
  v_xor_b32 v4, v4, v5
  v_and_b32 v5, 7, v1
  v_lshl_add_u32 v3, v3, 3, v5
  v_mul_u32_u24 v10, 34816, v4
  v_lshl_add_u32 v10, v3, 4, v10
  v_add_u32 v10, s20, v10
  v_mul_u32_u24 v3, 2, v2
  v_add_u32 v3, 1, v3
  v_bfe_u32 v5, v3, 1, 1
  v_lshrrev_b32 v4, 3, v1
  v_xor_b32 v4, v4, v5
  v_and_b32 v5, 7, v1
  v_lshl_add_u32 v3, v3, 3, v5
  v_mul_u32_u24 v11, 34816, v4
  v_lshl_add_u32 v11, v3, 4, v11
  v_add_u32 v11, s20, v11
  v_lshrrev_b32 v3, 3, v1
  v_mul_u32_u24 v12, 10240, v3
  v_and_b32 v3, 7, v1
  v_lshl_add_u32 v12, v3, 4, v12
  s_mul_i32 s21, s18, 1280
  v_add_u32 v12, s21, v12
  s_lshr_b32 s41, s16, 1
  s_and_b32 s42, s16, 1
  s_mul_i32 s33, s41, 81920
  s_mul_i32 s43, s42, 640
  s_add_u32 s33, s33, s43
  s_mul_i32 s35, s41, 10240
  s_mul_i32 s43, s42, 5120
  s_add_u32 s35, s35, s43
  s_mul_i32 s34, s16, 2048
  s_mov_b32 s32, 0
  s_mov_b32 s40, 0
  s_waitcnt lgkmcnt(0)
  s_add_u32 s24, s6, 16777216
  s_addc_u32 s25, s7, 0
  s_mov_b32 s26, 3760128
  s_mov_b32 s27, 0x20000
  s_add_u32 s28, s6, 20971520
  s_addc_u32 s29, s7, 0
  s_mov_b32 s30, 3760128
  s_mov_b32 s31, 0x20000
  s_add_u32 s36, s6, 25165824
  s_addc_u32 s37, s7, 0
  s_mov_b32 s38, 1105920
  s_mov_b32 s39, 0x20000
  s_mov_b32 s97, 1
  s_cmp_lg_u32 s16, 0
  s_cbranch_scc1 pre_29
  s_add_u32 s64, s92, 33030144
  s_addc_u32 s65, s93, 0
  s_mov_b32 s66, 20480
  s_mov_b32 s67, 0x20000
  v_lshlrev_b32 v20, 4, v1
  s_and_b32 s98, s2, 15
  s_mul_i32 s98, s98, 1280
  v_add_u32 v20, s98, v20
  s_add_u32 s98, s94, 3
  s_mov_b32 s97, 0
pre_29:
  s_barrier
  s_add_u32 m0, s35, 102400
  s_add_u32 s43, s33, 0
  buffer_load_dwordx4 v12, s[36:39], s43 offen sc1 lds
  s_add_u32 m0, s35, 103424
  s_add_u32 s43, s33, 128
  buffer_load_dwordx4 v12, s[36:39], s43 offen sc1 lds
  s_add_u32 m0, s35, 104448
  s_add_u32 s43, s33, 256
  buffer_load_dwordx4 v12, s[36:39], s43 offen sc1 lds
  s_add_u32 m0, s35, 105472
  s_add_u32 s43, s33, 384
  buffer_load_dwordx4 v12, s[36:39], s43 offen sc1 lds
  s_add_u32 m0, s35, 106496
  s_add_u32 s43, s33, 512
  buffer_load_dwordx4 v12, s[36:39], s43 offen sc1 lds
  s_add_u32 m0, s35, 122880
  s_add_u32 s43, s33, 163840
  buffer_load_dwordx4 v12, s[36:39], s43 offen sc1 lds
  s_add_u32 m0, s35, 123904
  s_add_u32 s43, s33, 163968
  buffer_load_dwordx4 v12, s[36:39], s43 offen sc1 lds
  s_add_u32 m0, s35, 124928
  s_add_u32 s43, s33, 164096
  buffer_load_dwordx4 v12, s[36:39], s43 offen sc1 lds
  s_add_u32 m0, s35, 125952
  s_add_u32 s43, s33, 164224
  buffer_load_dwordx4 v12, s[36:39], s43 offen sc1 lds
  s_add_u32 m0, s35, 126976
  s_add_u32 s43, s33, 164352
  buffer_load_dwordx4 v12, s[36:39], s43 offen sc1 lds
  s_add_u32 m0, s35, 143360
  s_add_u32 s43, s33, 327680
  buffer_load_dwordx4 v12, s[36:39], s43 offen sc1 lds
  s_add_u32 m0, s35, 144384
  s_add_u32 s43, s33, 327808
  buffer_load_dwordx4 v12, s[36:39], s43 offen sc1 lds
  s_add_u32 m0, s35, 145408
  s_add_u32 s43, s33, 327936
  buffer_load_dwordx4 v12, s[36:39], s43 offen sc1 lds
  s_add_u32 m0, s35, 146432
  s_add_u32 s43, s33, 328064
  buffer_load_dwordx4 v12, s[36:39], s43 offen sc1 lds
  s_add_u32 m0, s35, 147456
  s_add_u32 s43, s33, 328192
  buffer_load_dwordx4 v12, s[36:39], s43 offen sc1 lds
  s_add_u32 m0, s35, 49152
  s_add_u32 s43, s33, 491520
  buffer_load_dwordx4 v12, s[36:39], s43 offen sc1 lds
  s_add_u32 m0, s35, 50176
  s_add_u32 s43, s33, 491648
  buffer_load_dwordx4 v12, s[36:39], s43 offen sc1 lds
  s_add_u32 m0, s35, 51200
  s_add_u32 s43, s33, 491776
  buffer_load_dwordx4 v12, s[36:39], s43 offen sc1 lds
  s_add_u32 m0, s35, 52224
  s_add_u32 s43, s33, 491904
  buffer_load_dwordx4 v12, s[36:39], s43 offen sc1 lds
  s_add_u32 m0, s35, 53248
  s_add_u32 s43, s33, 492032
  buffer_load_dwordx4 v12, s[36:39], s43 offen sc1 lds
  s_add_u32 m0, s35, 69632
  s_add_u32 s43, s33, 655360
  buffer_load_dwordx4 v12, s[36:39], s43 offen sc1 lds
  s_add_u32 m0, s35, 70656
  s_add_u32 s43, s33, 655488
  buffer_load_dwordx4 v12, s[36:39], s43 offen sc1 lds
  s_add_u32 m0, s35, 71680
  s_add_u32 s43, s33, 655616
  buffer_load_dwordx4 v12, s[36:39], s43 offen sc1 lds
  s_add_u32 m0, s35, 72704
  s_add_u32 s43, s33, 655744
  buffer_load_dwordx4 v12, s[36:39], s43 offen sc1 lds
  s_add_u32 m0, s35, 73728
  s_add_u32 s43, s33, 655872
  buffer_load_dwordx4 v12, s[36:39], s43 offen sc1 lds
  s_cmp_eq_u32 s97, 1
  s_cbranch_scc1 pollskip_31
  s_mov_b32 s99, 0
poll_30:
  buffer_load_dwordx4 v[16:19], v20, s[64:67], 0 offen sc1
  s_waitcnt vmcnt(0)
  v_subrev_u32 v16, s98, v16
  v_subrev_u32 v17, s98, v17
  v_subrev_u32 v18, s98, v18
  v_subrev_u32 v19, s98, v19
  v_max_u32 v16, v16, v17
  v_max_u32 v18, v18, v19
  v_max_u32 v16, v16, v18
  v_cmp_ge_u32 vcc, 0, v16
  s_add_u32 s99, s99, 1
  s_cmp_eq_u64 vcc, exec
  s_cbranch_scc1 pollskip_31
  s_cmp_lt_u32 s99, 40000
  s_cbranch_scc1 poll_30
pollskip_31:
  s_barrier
  s_add_u32 m0, s34, 0
  s_nop 0
  buffer_load_dwordx4 v10, s[24:27], s32 offen sc1 lds
  s_add_u32 m0, s34, 1024
  s_nop 0
  buffer_load_dwordx4 v11, s[24:27], s32 offen sc1 lds
  s_add_u32 s32, s32, 278528
  s_add_u32 m0, s34, 8192
  s_nop 0
  buffer_load_dwordx4 v10, s[28:31], s40 offen sc1 lds
  s_add_u32 m0, s34, 9216
  s_nop 0
  buffer_load_dwordx4 v11, s[28:31], s40 offen sc1 lds
  s_add_u32 s40, s40, 278528
  s_add_u32 m0, s34, 16384
  s_nop 0
  buffer_load_dwordx4 v10, s[24:27], s32 offen sc1 lds
  s_add_u32 m0, s34, 17408
  s_nop 0
  buffer_load_dwordx4 v11, s[24:27], s32 offen sc1 lds
  s_add_u32 s32, s32, 278528
  s_add_u32 m0, s34, 24576
  s_nop 0
  buffer_load_dwordx4 v10, s[28:31], s40 offen sc1 lds
  s_add_u32 m0, s34, 25600
  s_nop 0
  buffer_load_dwordx4 v11, s[28:31], s40 offen sc1 lds
  s_add_u32 s40, s40, 278528
  s_waitcnt vmcnt(4)
  s_barrier
  s_add_u32 m0, s34, 32768
  s_nop 0
  buffer_load_dwordx4 v10, s[24:27], s32 offen sc1 lds
  s_add_u32 m0, s34, 33792
  s_nop 0
  buffer_load_dwordx4 v11, s[24:27], s32 offen sc1 lds
  s_add_u32 s32, s32, 278528
  s_add_u32 m0, s34, 40960
  s_nop 0
  buffer_load_dwordx4 v10, s[28:31], s40 offen sc1 lds
  s_add_u32 m0, s34, 41984
  s_nop 0
  buffer_load_dwordx4 v11, s[28:31], s40 offen sc1 lds
  s_add_u32 s40, s40, 278528
  s_waitcnt vmcnt(4)
  s_barrier
  s_add_u32 m0, s34, 0
  s_nop 0
  buffer_load_dwordx4 v10, s[24:27], s32 offen sc1 lds
  s_add_u32 m0, s34, 1024
  s_nop 0
  buffer_load_dwordx4 v11, s[24:27], s32 offen sc1 lds
  s_add_u32 s32, s32, 278528
  s_add_u32 m0, s34, 8192
  s_nop 0
  buffer_load_dwordx4 v10, s[28:31], s40 offen sc1 lds
  s_add_u32 m0, s34, 9216
  s_nop 0
  buffer_load_dwordx4 v11, s[28:31], s40 offen sc1 lds
  s_add_u32 s40, s40, 278528
  s_waitcnt vmcnt(4)
  s_barrier
  s_add_u32 m0, s34, 16384
  s_nop 0
  buffer_load_dwordx4 v10, s[24:27], s32 offen sc1 lds
  s_add_u32 m0, s34, 17408
  s_nop 0
  buffer_load_dwordx4 v11, s[24:27], s32 offen sc1 lds
  s_add_u32 s32, s32, 278528
  s_add_u32 m0, s34, 24576
  s_nop 0
  buffer_load_dwordx4 v10, s[28:31], s40 offen sc1 lds
  s_add_u32 m0, s34, 25600
  s_nop 0
  buffer_load_dwordx4 v11, s[28:31], s40 offen sc1 lds
  s_add_u32 s40, s40, 278528
  s_add_u32 m0, s35, 102400
  s_add_u32 s43, s33, 819200
  buffer_load_dwordx4 v12, s[36:39], s43 offen sc1 lds
  s_add_u32 m0, s35, 103424
  s_add_u32 s43, s33, 819328
  buffer_load_dwordx4 v12, s[36:39], s43 offen sc1 lds
  s_add_u32 m0, s35, 104448
  s_add_u32 s43, s33, 819456
  buffer_load_dwordx4 v12, s[36:39], s43 offen sc1 lds
  s_add_u32 m0, s35, 105472
  s_add_u32 s43, s33, 819584
  buffer_load_dwordx4 v12, s[36:39], s43 offen sc1 lds
  s_add_u32 m0, s35, 106496
  s_add_u32 s43, s33, 819712
  buffer_load_dwordx4 v12, s[36:39], s43 offen sc1 lds
  s_waitcnt vmcnt(9)
  s_barrier
  s_add_u32 m0, s34, 32768
  s_nop 0
  buffer_load_dwordx4 v10, s[24:27], s32 offen sc1 lds
  s_add_u32 m0, s34, 33792
  s_nop 0
  buffer_load_dwordx4 v11, s[24:27], s32 offen sc1 lds
  s_add_u32 s32, s32, 278528
  s_add_u32 m0, s34, 40960
  s_nop 0
  buffer_load_dwordx4 v10, s[28:31], s40 offen sc1 lds
  s_add_u32 m0, s34, 41984
  s_nop 0
  buffer_load_dwordx4 v11, s[28:31], s40 offen sc1 lds
  s_add_u32 s40, s40, 278528
  s_waitcnt vmcnt(9)
  s_barrier
  s_add_u32 m0, s34, 0
  s_nop 0
  buffer_load_dwordx4 v10, s[24:27], s32 offen sc1 lds
  s_add_u32 m0, s34, 1024
  s_nop 0
  buffer_load_dwordx4 v11, s[24:27], s32 offen sc1 lds
  s_add_u32 s32, s32, 278528
  s_add_u32 m0, s34, 8192
  s_nop 0
  buffer_load_dwordx4 v10, s[28:31], s40 offen sc1 lds
  s_add_u32 m0, s34, 9216
  s_nop 0
  buffer_load_dwordx4 v11, s[28:31], s40 offen sc1 lds
  s_add_u32 s40, s40, 278528
  s_add_u32 m0, s35, 122880
  s_add_u32 s43, s33, 983040
  buffer_load_dwordx4 v12, s[36:39], s43 offen sc1 lds
  s_add_u32 m0, s35, 123904
  s_add_u32 s43, s33, 983168
  buffer_load_dwordx4 v12, s[36:39], s43 offen sc1 lds
  s_add_u32 m0, s35, 124928
  s_add_u32 s43, s33, 983296
  buffer_load_dwordx4 v12, s[36:39], s43 offen sc1 lds
  s_add_u32 m0, s35, 125952
  s_add_u32 s43, s33, 983424
  buffer_load_dwordx4 v12, s[36:39], s43 offen sc1 lds
  s_add_u32 m0, s35, 126976
  s_add_u32 s43, s33, 983552
  buffer_load_dwordx4 v12, s[36:39], s43 offen sc1 lds
  s_waitcnt vmcnt(9)
  s_barrier
  s_add_u32 m0, s34, 16384
  s_nop 0
  buffer_load_dwordx4 v10, s[24:27], s32 offen sc1 lds
  s_add_u32 m0, s34, 17408
  s_nop 0
  buffer_load_dwordx4 v11, s[24:27], s32 offen sc1 lds
  s_add_u32 s32, s32, 278528
  s_add_u32 m0, s34, 24576
  s_nop 0
  buffer_load_dwordx4 v10, s[28:31], s40 offen sc1 lds
  s_add_u32 m0, s34, 25600
  s_nop 0
  buffer_load_dwordx4 v11, s[28:31], s40 offen sc1 lds
  s_add_u32 s40, s40, 278528
  s_waitcnt vmcnt(9)
  s_barrier
  s_add_u32 m0, s34, 32768
  s_nop 0
  buffer_load_dwordx4 v10, s[24:27], s32 offen sc1 lds
  s_add_u32 m0, s34, 33792
  s_nop 0
  buffer_load_dwordx4 v11, s[24:27], s32 offen sc1 lds
  s_add_u32 s32, s32, 278528
  s_add_u32 m0, s34, 40960
  s_nop 0
  buffer_load_dwordx4 v10, s[28:31], s40 offen sc1 lds
  s_add_u32 m0, s34, 41984
  s_nop 0
  buffer_load_dwordx4 v11, s[28:31], s40 offen sc1 lds
  s_add_u32 s40, s40, 278528
  s_waitcnt vmcnt(4)
  s_barrier
  s_add_u32 m0, s34, 0
  s_nop 0
  buffer_load_dwordx4 v10, s[24:27], s32 offen sc1 lds
  s_add_u32 m0, s34, 1024
  s_nop 0
  buffer_load_dwordx4 v11, s[24:27], s32 offen sc1 lds
  s_add_u32 s32, s32, 278528
  s_add_u32 m0, s34, 8192
  s_nop 0
  buffer_load_dwordx4 v10, s[28:31], s40 offen sc1 lds
  s_add_u32 m0, s34, 9216
  s_nop 0
  buffer_load_dwordx4 v11, s[28:31], s40 offen sc1 lds
  s_add_u32 s40, s40, 278528
  s_waitcnt vmcnt(4)
  s_barrier
  s_add_u32 m0, s34, 16384
  s_nop 0
  buffer_load_dwordx4 v10, s[24:27], s32 offen sc1 lds
  s_add_u32 m0, s34, 17408
  s_nop 0
  buffer_load_dwordx4 v11, s[24:27], s32 offen sc1 lds
  s_add_u32 s32, s32, 278528
  s_add_u32 m0, s34, 24576
  s_nop 0
  buffer_load_dwordx4 v10, s[28:31], s40 offen sc1 lds
  s_add_u32 m0, s34, 25600
  s_nop 0
  buffer_load_dwordx4 v11, s[28:31], s40 offen sc1 lds
  s_add_u32 s40, s40, 278528
  s_waitcnt vmcnt(4)
  s_barrier
  s_add_u32 m0, s34, 32768
  s_nop 0
  buffer_load_dwordx4 v10, s[24:27], s32 offen sc1 lds
  s_add_u32 m0, s34, 33792
  s_nop 0
  buffer_load_dwordx4 v11, s[24:27], s32 offen sc1 lds
  s_add_u32 s32, s32, 278528
  s_add_u32 m0, s34, 40960
  s_nop 0
  buffer_load_dwordx4 v10, s[28:31], s40 offen sc1 lds
  s_add_u32 m0, s34, 41984
  s_nop 0
  buffer_load_dwordx4 v11, s[28:31], s40 offen sc1 lds
  s_add_u32 s40, s40, 278528
  s_waitcnt vmcnt(4)
  s_barrier
  s_add_u32 m0, s34, 0
  s_nop 0
  buffer_load_dwordx4 v10, s[24:27], s32 offen sc1 lds
  s_add_u32 m0, s34, 1024
  s_nop 0
  buffer_load_dwordx4 v11, s[24:27], s32 offen sc1 lds
  s_add_u32 s32, s32, 278528
  s_add_u32 m0, s34, 8192
  s_nop 0
  buffer_load_dwordx4 v10, s[28:31], s40 offen sc1 lds
  s_add_u32 m0, s34, 9216
  s_nop 0
  buffer_load_dwordx4 v11, s[28:31], s40 offen sc1 lds
  s_add_u32 s40, s40, 278528
  s_waitcnt vmcnt(4)
  s_barrier
  s_add_u32 m0, s34, 16384
  s_nop 0
  buffer_load_dwordx4 v10, s[24:27], s32 offen sc1 lds
  s_add_u32 m0, s34, 17408
  s_nop 0
  buffer_load_dwordx4 v11, s[24:27], s32 offen sc1 lds
  s_add_u32 s32, s32, 278528
  s_add_u32 m0, s34, 24576
  s_nop 0
  buffer_load_dwordx4 v10, s[28:31], s40 offen sc1 lds
  s_add_u32 m0, s34, 25600
  s_nop 0
  buffer_load_dwordx4 v11, s[28:31], s40 offen sc1 lds
  s_add_u32 s40, s40, 278528
  s_waitcnt vmcnt(4)
  s_barrier
  s_waitcnt vmcnt(0)
  s_barrier
  s_waitcnt vmcnt(0)
  s_endpgm
K_end:
  s_endpgm
CODE_END:
  s_endpgm
.section .rodata,"a"
.p2align 6
.amdhsa_kernel parallel_sum__spectral_fnet__mixer_gmlp__prompt_kernel
  .amdhsa_next_free_vgpr 248
  .amdhsa_next_free_sgpr 102
  .amdhsa_accum_offset 248
  .amdhsa_group_segment_fixed_size 0
  .amdhsa_kernarg_size 104
  .amdhsa_user_sgpr_count 2
  .amdhsa_user_sgpr_kernarg_segment_ptr 1
  .amdhsa_system_sgpr_workgroup_id_x 1

  .amdhsa_float_denorm_mode_32 3
  .amdhsa_float_denorm_mode_16_64 3
.end_amdhsa_kernel
```
